```python
import torch

def _softmax(x, axis=-1):
    return torch.softmax(x, dim=axis)
def _gelu(x):
    return torch.nn.functional.gelu(x, approximate="tanh")
def _silu(x):
    return torch.nn.functional.silu(x)
def _sigmoid(x):
    return torch.sigmoid(x)
def _layernorm(x, axis=-1, eps=1e-5):
    m = x.mean(dim=axis, keepdim=True)
    v = x.var(dim=axis, keepdim=True, unbiased=False)
    return (x - m) / torch.sqrt(v + eps)
def _scatter_add(tgt, idx, src, axis=0):
    return tgt.clone().index_add_(axis, idx, src)
def _segment_sum(src, seg, n):
    out = torch.zeros((n,) + src.shape[1:], dtype=src.dtype)
    return out.index_add_(0, seg, src)
def _pad(x, pw):
    flat = tuple(v for pair in reversed(pw) for v in pair)
    return torch.nn.functional.pad(x, flat)

kernel_name = 'interleave_layers__ssm_conv_s4d__mixer_token_mlp__prompt'

def setup_inputs():

    _w = (lambda a: (lambda t: t.to(torch.bfloat16) if t.is_floating_point() else t)(torch.as_tensor(a)))
    def _A_setup():
        Bsz, L, D, N = 1, 2048, 512, 128
        return {
            "u": _w((lambda *s: torch.randn(*s, dtype=torch.bfloat16) * 0.05)(Bsz, L, D)),
            "log_A_real": _w((lambda *s: torch.randn(*s, dtype=torch.bfloat16) * 3.2)(D, N) * 0.5),
            "A_imag": _w((lambda *s: torch.randn(*s, dtype=torch.bfloat16) * 0.05)(D, N) * 3.14),
            "C_real": _w((lambda *s: torch.randn(*s, dtype=torch.bfloat16) * 0.05)(D, N) / N ** 0.5),
            "C_imag": _w((lambda *s: torch.randn(*s, dtype=torch.bfloat16) * 0.1)(D, N) / N ** 0.5),
            "log_dt": _w((lambda *s: torch.randn(*s, dtype=torch.bfloat16) * 0.05)(D) * 0.5 - 4.0),
            "D_skip": _w((lambda *s: torch.randn(*s, dtype=torch.bfloat16) * 0.05)(D)),
        }
    _A_in = _A_setup()

    def _B_setup():
        B, S, D, F = 1, 2048, 512, 1792
        return {
            "x": _w((lambda *s: torch.randn(*s, dtype=torch.bfloat16) * 0.05)(B, S, D)),
            "w1": _w((lambda *s: torch.randn(*s, dtype=torch.bfloat16) * 0.4)(S, F) * (S ** -0.5)),
            "b1": _w((lambda *s: torch.randn(*s, dtype=torch.bfloat16) * 12.8)(F) * 0.02),
            "w2": _w((lambda *s: torch.randn(*s, dtype=torch.bfloat16) * 0.4)(F, S) * (F ** -0.5)),
            "b2": _w((lambda *s: torch.randn(*s, dtype=torch.bfloat16) * 6.4)(S) * 0.02),
        }
    _B_in = _B_setup()

    return {
        "A_u": _A_in["u"],
        "A_log_A_real": _A_in["log_A_real"],
        "A_A_imag": _A_in["A_imag"],
        "A_C_real": _A_in["C_real"],
        "A_C_imag": _A_in["C_imag"],
        "A_log_dt": _A_in["log_dt"],
        "A_D_skip": _A_in["D_skip"],
        "B_x": _B_in["x"],
        "B_w1": _B_in["w1"],
        "B_b1": _B_in["b1"],
        "B_w2": _B_in["w2"],
        "B_b2": _B_in["b2"],
    }

def reference(A_u, A_log_A_real, A_A_imag, A_C_real, A_C_imag, A_log_dt, A_D_skip, B_x, B_w1, B_b1, B_w2, B_b2):
    def _A_ref(u, log_A_real, A_imag, C_real, C_imag, log_dt, D_skip):
        L = u.shape[1]
        dt = torch.exp(log_dt)
        A = -torch.exp(log_A_real) + 1j * A_imag
        C = (C_real + 1j * C_imag) * dt[:, None]
        pos = (lambda x, dt: x.to(dt))(torch.arange(L), log_dt.dtype)
        P = torch.exp((A * dt[:, None])[:, :, None] * pos[None, None, :])
        K = 2.0 * torch.einsum("dn,dnl->dl", C, P).real
        L2 = 2 * L
        u_t = (lambda x, *d: x.permute(*d))(u, 0, 2, 1)
        Kf = (lambda x, *a, **k: torch.fft.rfft(x.float(), *a, **k))(K, L2)
        Uf = (lambda x, *a, **k: torch.fft.rfft(x.float(), *a, **k))(u_t, L2)
        y = (lambda x, *a, **k: torch.fft.irfft(x, *a, **k).to(torch.bfloat16))(Uf * Kf[None, :, :], L2)[:, :, :L]
        y = (lambda x, *d: x.permute(*d))(y, 0, 2, 1)
        return y + u * D_skip[None, None, :]

    def _B_ref(x, w1, b1, w2, b2):
        B, S, D = x.shape
        h = _layernorm(x, axis=-1)
        u = torch.einsum("bsd,sf->bdf", h, w1) + b1
        u = _gelu(u)
        y = torch.einsum("bdf,fs->bds", u, w2) + b2
        return (lambda x, *d: x.permute(*d))(y, 0, 2, 1)

    x = A_u
    x = x + _A_ref(_layernorm(x, axis=-1), A_log_A_real, A_A_imag, A_C_real, A_C_imag, A_log_dt, A_D_skip)
    x = x + _B_ref(_layernorm(x, axis=-1), B_w1, B_b1, B_w2, B_b2)
    x = x + _A_ref(_layernorm(x, axis=-1), A_log_A_real, A_A_imag, A_C_real, A_C_imag, A_log_dt, A_D_skip)
    x = x + _B_ref(_layernorm(x, axis=-1), B_w1, B_b1, B_w2, B_b2)
    return x
```

```asm
; @launch grid=(256,1,1) block=(256,1,1) lds=163840
.amdgcn_target "amdgcn-amd-amdhsa--gfx950"
.text
.p2align 12
.globl interleave_layers__ssm_conv_s4d__mixer_token_mlp__prompt_kernel
.p2align 8
.type interleave_layers__ssm_conv_s4d__mixer_token_mlp__prompt_kernel,@function
interleave_layers__ssm_conv_s4d__mixer_token_mlp__prompt_kernel:
    s_cmp_ge_u32 s2, 256
    s_cbranch_scc1 .Lend
    s_getreg_b32 s3, hwreg(HW_REG_XCC_ID)
    s_mov_b32 s59, 0
    s_sub_u32 s3, s3, s2
    s_and_b32 s67, s3, 3
.Lrole:
    s_load_dwordx16 s[20:35], s[0:1], 0
    s_load_dwordx2 s[4:5], s[0:1], 112
    s_load_dwordx8 s[8:15], s[0:1], 64
    s_load_dwordx2 s[16:17], s[0:1], 96
    v_lshrrev_b32 v1, 6, v0
    s_add_u32 s42, s2, s67
    v_readfirstlane_b32 s44, v1
    s_and_b32 s45, s42, 4
    s_bfe_u32 s3, s2, 0x20003
    s_add_u32 s45, s45, s3
    s_lshr_b32 s49, s2, 5
    s_and_b32 s3, s42, 3
    s_lshl3_add_u32 s46, s3, s49
    s_sub_u32 s48, s46, s3
    s_lshl_b32 s42, s46, 4
    s_add_u32 s42, s42, 1
    s_lshl_b32 s42, s42, 12
    s_lshl_b32 s3, s45, 7
    v_and_b32 v7, 31, v0
    v_lshl_add_u32 v7, v7, 2, s3
    v_lshrrev_b32 v3, 5, v0
    v_lshl_add_u32 v3, v3, 13, v7
    v_add_u32 v3, s42, v3
    s_getpc_b64 s[40:41]
.Lcode_here:
    s_lshr_b32 s3, s2, 3
    s_lshl_b32 s3, s3, 9
    v_and_b32 v32, 3, v0
    v_lshlrev_b32 v32, 13, v32
    v_and_b32 v33, 0xc0, v0
    v_add_lshl_u32 v32, v32, v33, 1
    v_add_u32 v32, s3, v32
    v_min_u32 v32, .Lcode_end-.Lcode_here, v32
    v_mov_b32 v33, s41
    v_add_co_u32 v32, vcc, s40, v32
    s_mov_b64 exec, 15
    s_nop 0
    v_addc_co_u32 v33, vcc, 0, v33, vcc
    global_load_dword v249, v[32:33], off
    s_mov_b64 exec, -1
    s_waitcnt lgkmcnt(0)
    global_load_dword v56, v3, s[20:21] offset:-4096
    global_load_dword v57, v3, s[20:21] offset:-3072
    global_load_dword v58, v3, s[20:21] offset:-2048
    global_load_dword v59, v3, s[20:21] offset:-1024
    global_load_dword v60, v3, s[20:21] offset:0
    global_load_dword v61, v3, s[20:21] offset:1024
    global_load_dword v62, v3, s[20:21] offset:2048
    global_load_dword v63, v3, s[20:21] offset:3072
    s_mov_b32 s3, 78643200
    s_or_b32 s42, s44, s59
    s_cselect_b32 s62, 64, s2
    s_cmp_lt_u32 s62, 16
    s_cbranch_scc0 .Lnl0
    s_mul_i32 s42, s62, 512
    s_add_u32 s43, s42, 35627008
    s_add_u32 s42, s42, 35618816
    s_load_dword s60, s[4:5], s42 glc
    s_load_dword s61, s[4:5], s43 glc
    s_branch .Lnl0b
.Lnl0:
    s_load_dword s47, s[4:5], s3
.Lnl0b:
    v_mov_b32 v128, v0
    v_and_b32 v2, 63, v0
    s_and_b32 s42, s46, 15
    s_lshl_b32 s42, s42, 2
    s_lshr_b32 s3, s46, 4
    s_add_u32 s42, s42, s3
    s_lshl_b32 s3, s45, 6
    s_add_u32 s42, s42, s3
    s_lshl_b32 s3, s42, 8
    v_and_b32 v129, 0x80, v128
    v_add_u32 v129, v129, v128
    v_lshl_add_u32 v129, v129, 1, s3
    s_lshl_b32 s3, s42, 1
    v_lshrrev_b32 v130, 7, v128
    v_lshl_add_u32 v130, v130, 2, s3
    global_load_ushort v148, v130, s[30:31]
    global_load_ushort v144, v129, s[22:23]
    global_load_ushort v145, v129, s[24:25]
    global_load_ushort v146, v129, s[26:27]
    global_load_ushort v147, v129, s[28:29]
    global_load_dword v0, v7, s[32:33]
    s_mov_b64 s[36:37], s[10:11]
    s_mov_b64 s[38:39], s[14:15]
    s_mov_b32 s64, 78647296
    s_cmp_lt_u32 s49, 7
    s_cselect_b32 s10, 7340032, 0
    s_mov_b32 s11, 0x20000
    s_mov_b32 s14, 7340032
    s_mov_b32 s15, 0x20000
    s_mov_b32 s18, 2097152
    s_mov_b32 s19, 0x20000
    s_mov_b32 s6, 81788928
    s_mov_b32 s7, 0x20000
    s_mul_i32 s55, s44, 24576
    s_add_u32 s55, s55, 65536
    v_lshrrev_b32 v4, 3, v2
    v_bfe_u32 v5, v2, 4, 1
    v_lshlrev_b32 v5, 2, v5
    v_and_b32 v6, 7, v2
    v_xor_b32 v5, v5, v6
    v_lshlrev_b32 v5, 4, v5
    v_mul_u32_u24 v6, 3584, v4
    v_add_u32 v250, v6, v5
    v_add_u32 v251, 27648, v250
    v_lshl_add_u32 v252, v4, 12, v5
    v_add_u32 v253, 31744, v252
    s_mul_i32 s51, s44, 1835008
    s_lshl_b32 s3, s48, 7
    s_add_u32 s51, s51, s3
    s_add_u32 s52, s51, 1835008
    s_and_b32 s58, s45, 3
    s_lshl_b32 s58, s58, 1
    s_lshr_b32 s3, s45, 2
    s_add_u32 s58, s58, s3
    s_mul_i32 s50, s58, 229376
    s_add_u32 s50, s50, s51
    s_mul_i32 s58, s58, 7
    s_lshr_b32 s58, s58, 3
    s_lshl_b32 s58, s58, 2
    s_mul_i32 s53, s44, 1835008
    s_lshl_b32 s3, s46, 7
    s_add_u32 s53, s53, s3
    s_add_u32 s54, s53, 1835008
    s_lshl_b32 s3, s58, 16
    s_add_u32 s53, s53, s3
    s_add_u32 m0, s55, 0
    s_add_u32 s43, s50, 57344
    buffer_load_dwordx4 v250, s[8:11], s50 offen lds
    buffer_load_dwordx4 v251, s[8:11], s50 offen offset:1024 lds
    s_cmp_eq_u32 s43, s52
    s_cselect_b32 s50, s51, s43
    s_add_u32 m0, s55, 2048
    s_add_u32 s43, s50, 57344
    buffer_load_dwordx4 v250, s[8:11], s50 offen lds
    buffer_load_dwordx4 v251, s[8:11], s50 offen offset:1024 lds
    s_cmp_eq_u32 s43, s52
    s_cselect_b32 s50, s51, s43
    s_add_u32 s31, s45, 1
    s_lshl_b32 s31, s31, 23
    s_lshr_b32 s3, s45, 2
    s_lshl_b32 s3, s3, 13
    s_add_u32 s31, s31, s3
    s_xor_b32 s42, s31, 2105344
    s_and_b32 s3, s46, 24
    s_add_u32 s3, s3, s46
    s_lshl2_add_u32 s3, s3, s44
    s_lshl_b32 s3, s3, 8
    s_add_u32 s57, s3, s42
    s_lshl_b32 s56, s44, 6
    s_lshr_b32 s3, s46, 3
    s_add_u32 s56, s56, s3
    s_lshl_b32 s56, s56, 8
    s_add_u32 s56, s56, s42
    s_and_b32 s3, s49, 4
    s_mul_i32 s3, s3, 7
    s_add_u32 s3, s3, s49
    s_lshl2_add_u32 s56, s3, s56
    v_mov_b64 v[64:65], 0
    v_mov_b64 v[66:67], 0
    v_mbcnt_lo_u32_b32 v4, -1, 0
    v_mbcnt_hi_u32_b32 v4, -1, v4
    v_lshrrev_b32 v5, 5, v4
    v_and_b32 v6, 31, v4
    v_lshlrev_b32 v1, 10, v5
    v_lshl_add_u32 v1, v6, 4, v1
    v_lshlrev_b32 v2, 2, v4
    v_and_b32 v6, 7, v4
    v_lshlrev_b32 v3, 4, v6
    v_lshl_add_u32 v3, v5, 7, v3
    v_bfe_u32 v6, v4, 3, 2
    v_lshl_add_u32 v3, v6, 8, v3
    s_lshl_b32 s22, s46, 3
    s_add_u32 s22, s22, s44
    s_lshl_b32 s22, s22, 11
    s_add_u32 s20, s22, 79691776
    s_lshl_b32 s21, s45, 8
    s_add_u32 s21, s21, s20
    s_and_b32 s42, s46, 1
    s_lshl_b32 s42, s42, 13
    s_lshl_b32 s41, s67, 19
    s_add_u32 s42, s42, s41
    s_add_u32 s20, s20, s42
    s_add_u32 s21, s21, s42
    s_add_u32 s22, s22, s31
    s_add_u32 s23, s22, 0
    s_add_u32 s22, s22, 0
    s_mov_b32 s24, 0x11111111
    s_mov_b32 s25, s24
    s_mov_b32 s26, 0xbb000000
    s_mov_b32 s27, 0x3b000000
    v_min_u32 v76, 15, v4
    v_lshlrev_b32 v76, 7, v76
    s_cmp_lt_u32 s62, 16
    s_cbranch_scc0 .Lnl2
    s_getreg_b32 s42, hwreg(HW_REG_IB_STS, 8, 4)
    s_cmp_ge_u32 s42, 2
    s_cbranch_scc1 .Lnl3
    s_mul_i32 s42, s62, 512
    s_add_u32 s43, s42, 35627008
    s_add_u32 s42, s42, 35618816
    s_waitcnt lgkmcnt(0)
    s_load_dword s60, s[4:5], s42 glc
    s_load_dword s61, s[4:5], s43 glc
.Lnl3:
    s_waitcnt lgkmcnt(1)
    s_mov_b32 s3, 78643200
    s_lshl_b32 s41, s2, 7
    s_add_u32 s41, s41, s64
    v_lshlrev_b32 v71, 4, v4
    v_mov_b32 v73, 0
    v_mov_b32 v74, 0
    v_mov_b32 v75, 0
    s_getreg_b32 s42, hwreg(HW_REG_IB_STS, 8, 4)
    s_cmp_lg_u32 s42, 0
    s_load_dword s47, s[4:5], s3
    s_cselect_b32 s63, 4, 0
    s_or_b32 s63, s63, s67
    s_waitcnt lgkmcnt(0)
    s_add_u32 s3, s47, 0x9e3779b9
    s_max_u32 s3, s3, 8
    s_andn2_b32 s3, s3, 7
    s_or_b32 s3, s3, s63
    v_mov_b32 v72, s3
    s_mov_b64 exec, 0xff
    buffer_store_dwordx4 v[72:75], v71, s[4:7], s41 offen sc1
    s_mov_b64 exec, -1
.Lnl2:
    v_mbcnt_lo_u32_b32 v149, -1, 0
    v_mbcnt_hi_u32_b32 v149, -1, v149
    v_bfe_u32 v150, v149, 2, 2
    v_lshrrev_b32 v254, 5, v149
    v_lshl_add_u32 v254, v254, 3, v150
    v_lshlrev_b32 v254, 7, v254
    v_and_b32 v150, 2, v150
    v_bfe_u32 v255, v149, 4, 1
    v_xor_b32 v150, v150, v255
    v_xor_b32 v150, s44, v150
    v_lshl_add_u32 v254, v150, 5, v254
    v_and_b32 v150, 1, v149
    v_lshl_add_u32 v254, v150, 4, v254
    v_bfe_u32 v150, v149, 1, 1
    v_lshl_add_u32 v254, v150, 3, v254
    v_add_u32 v254, s55, v254
    v_xor_b32 v255, 64, v254
    v_and_b32 v69, 15, v4
    v_lshlrev_b32 v69, 4, v69
    v_lshrrev_b32 v70, 4, v4
    v_lshl_add_u32 v69, v70, 19, v69
    v_add_u32 v70, 8192, v69
    s_lshl_b32 s66, s46, 3
    s_add_u32 s66, s66, s44
    s_lshl_b32 s66, s66, 3
    s_add_u32 s66, s66, s45
    s_lshl_b32 s66, s66, 8
    s_add_u32 s66, s66, 76021760
    s_branch .Lpage0
.p2alignl 12, 0xbf810000
.Lpage0:
    s_waitcnt lgkmcnt(0)
    s_add_u32 s47, s47, 0x9e3779b9
    s_max_u32 s47, s47, 8
    s_mov_b32 s32, s47
    s_mov_b32 s33, s47
    s_waitcnt vmcnt(14)
    v_lshlrev_b32 v8, 16, v56
    v_and_b32 v16, 0xffff0000, v56
    v_lshlrev_b32 v9, 16, v57
    v_and_b32 v17, 0xffff0000, v57
    v_lshlrev_b32 v10, 16, v58
    v_and_b32 v18, 0xffff0000, v58
    v_lshlrev_b32 v11, 16, v59
    v_and_b32 v19, 0xffff0000, v59
    s_waitcnt vmcnt(10)
    v_lshlrev_b32 v12, 16, v60
    v_and_b32 v20, 0xffff0000, v60
    v_lshlrev_b32 v13, 16, v61
    v_and_b32 v21, 0xffff0000, v61
    v_lshlrev_b32 v14, 16, v62
    v_and_b32 v22, 0xffff0000, v62
    v_lshlrev_b32 v15, 16, v63
    v_and_b32 v23, 0xffff0000, v63
    v_pk_mul_f32 v[32:33], v[8:9], v[8:9]
    v_pk_mul_f32 v[34:35], v[10:11], v[10:11]
    v_pk_mul_f32 v[36:37], v[12:13], v[12:13]
    v_pk_mul_f32 v[38:39], v[14:15], v[14:15]
    v_pk_add_f32 v[24:25], v[8:9], v[16:17]
    v_pk_add_f32 v[26:27], v[10:11], v[18:19]
    v_pk_add_f32 v[28:29], v[12:13], v[20:21]
    v_pk_add_f32 v[30:31], v[14:15], v[22:23]
    v_pk_fma_f32 v[32:33], v[16:17], v[16:17], v[32:33]
    v_pk_fma_f32 v[34:35], v[18:19], v[18:19], v[34:35]
    v_pk_fma_f32 v[36:37], v[20:21], v[20:21], v[36:37]
    v_pk_fma_f32 v[38:39], v[22:23], v[22:23], v[38:39]
    v_permlane16_swap_b32 v24, v28
    v_permlane16_swap_b32 v25, v29
    v_permlane16_swap_b32 v26, v30
    v_permlane16_swap_b32 v27, v31
    v_permlane16_swap_b32 v32, v36
    v_permlane16_swap_b32 v33, v37
    v_permlane16_swap_b32 v34, v38
    v_permlane16_swap_b32 v35, v39
    v_pk_add_f32 v[24:25], v[24:25], v[28:29]
    v_pk_add_f32 v[26:27], v[26:27], v[30:31]
    v_pk_add_f32 v[32:33], v[32:33], v[36:37]
    v_pk_add_f32 v[34:35], v[34:35], v[38:39]
    v_add_f32_dpp v24, v24, v24 row_mirror row_mask:0xf bank_mask:0x3
    v_add_f32_dpp v25, v25, v25 row_mirror row_mask:0xf bank_mask:0x3
    v_add_f32_dpp v32, v32, v32 row_mirror row_mask:0xf bank_mask:0x3
    v_add_f32_dpp v33, v33, v33 row_mirror row_mask:0xf bank_mask:0x3
    v_add_f32_dpp v24, v26, v26 row_mirror row_mask:0xf bank_mask:0xc
    v_add_f32_dpp v25, v27, v27 row_mirror row_mask:0xf bank_mask:0xc
    v_add_f32_dpp v32, v34, v34 row_mirror row_mask:0xf bank_mask:0xc
    v_add_f32_dpp v33, v35, v35 row_mirror row_mask:0xf bank_mask:0xc
    v_add_f32_dpp v24, v24, v24 row_half_mirror row_mask:0xf bank_mask:0x5
    v_add_f32_dpp v32, v32, v32 row_half_mirror row_mask:0xf bank_mask:0x5
    v_add_f32_dpp v24, v25, v25 row_half_mirror row_mask:0xf bank_mask:0xa
    v_add_f32_dpp v32, v33, v33 row_half_mirror row_mask:0xf bank_mask:0xa
    v_mov_b32 v25, s47
    v_add_f32_dpp v24, v24, v24 quad_perm:[2,3,0,1] row_mask:0xf bank_mask:0xf
    v_add_f32_dpp v32, v32, v32 quad_perm:[2,3,0,1] row_mask:0xf bank_mask:0xf
    v_mov_b32 v27, s47
    v_add_f32_dpp v24, v24, v24 quad_perm:[1,0,3,2] row_mask:0xf bank_mask:0xf
    v_add_f32_dpp v26, v32, v32 quad_perm:[1,0,3,2] row_mask:0xf bank_mask:0xf
    s_mov_b64 exec, s[24:25]
    buffer_store_dwordx4 v[24:27], v2, s[4:7], s21 offen sc1
    s_mov_b64 exec, -1
    s_xor_b32 s42, s57, 8192
    s_load_dword s60, s[4:5], s57 glc
    s_load_dword s61, s[4:5], s42 glc
    s_load_dword s60, s[4:5], s57 offset:128 glc
    s_load_dword s61, s[4:5], s42 offset:128 glc
    s_waitcnt vmcnt(5)
    s_add_u32 m0, s55, 4096
    s_add_u32 s43, s50, 57344
    buffer_load_dwordx4 v250, s[8:11], s50 offen lds
    buffer_load_dwordx4 v251, s[8:11], s50 offen offset:1024 lds
    s_cmp_eq_u32 s43, s52
    s_cselect_b32 s50, s51, s43
    s_lshr_b32 s42, s44, 1
    s_mul_i32 s42, s42, 29696
    s_lshl_b32 s41, s44, 8
    s_add_u32 s40, s42, s41
    v_lshlrev_b32 v148, 16, v148
    v_lshlrev_b32 v144, 16, v144
    v_lshlrev_b32 v145, 16, v145
    v_lshlrev_b32 v146, 16, v146
    v_lshlrev_b32 v147, 16, v147
    v_mul_f32 v148, 0x3fb8aa3b, v148
    v_mul_f32 v144, 0x3fb8aa3b, v144
    v_exp_f32 v148, v148
    v_exp_f32 v144, v144
    s_nop 0
    v_cvt_pk_bf16_f32 v148, v148, v148
    v_cvt_pk_bf16_f32 v144, v144, v144
    v_lshlrev_b32 v148, 16, v148
    v_lshlrev_b32 v144, 16, v144
    v_mul_f32 v144, v144, v148
    v_mul_f32 v144, 0xbfb8aa3b, v144
    v_mul_f32 v145, v145, v148
    v_mul_f32 v145, 0.15915494, v145
    v_add_f32 v148, v148, v148
    v_mul_f32 v158, v146, v148
    v_mul_f32 v159, v147, v148
    s_add_u32 m0, s55, 6144
    s_add_u32 s43, s50, 57344
    buffer_load_dwordx4 v250, s[8:11], s50 offen lds
    buffer_load_dwordx4 v251, s[8:11], s50 offen offset:1024 lds
    s_cmp_eq_u32 s43, s52
    s_cselect_b32 s50, s51, s43
    v_mul_f32 v150, 0x3f800000, v144
    v_mul_f32 v151, 0x3f800000, v145
    v_exp_f32 v150, v150
    v_rndne_f32 v152, v151
    v_sub_f32 v151, v151, v152
    v_cos_f32 v152, v151
    v_sin_f32 v153, v151
    s_nop 0
    v_mul_f32 v168, v150, v152
    v_mul_f32 v169, v150, v153
    v_mul_f32 v150, 0x41000000, v144
    v_mul_f32 v151, 0x41000000, v145
    v_exp_f32 v150, v150
    v_rndne_f32 v152, v151
    v_sub_f32 v151, v151, v152
    v_cos_f32 v152, v151
    v_sin_f32 v153, v151
    s_nop 0
    v_mul_f32 v162, v150, v152
    v_mul_f32 v163, v150, v153
    v_mul_f32 v150, 0x43000000, v144
    v_mul_f32 v151, 0x43000000, v145
    v_exp_f32 v150, v150
    v_rndne_f32 v152, v151
    v_sub_f32 v151, v151, v152
    v_cos_f32 v152, v151
    v_sin_f32 v153, v151
    s_nop 0
    v_mul_f32 v164, v150, v152
    v_mul_f32 v165, v150, v153
    v_mov_b32 v214, 0x3f80
    v_cvt_pk_bf16_f32 v136, v168, v169
    v_cvt_pk_bf16_f32 v137, v164, v165
    v_pk_mul_f32 v[170:171], v[168:169], v[168:169] op_sel:[0,0] op_sel_hi:[1,0]
    v_pk_fma_f32 v[170:171], v[168:169], v[168:169], v[170:171] op_sel:[1,1,0] op_sel_hi:[0,1,1] neg_lo:[1,0,0]
    v_pk_mul_f32 v[184:185], v[164:165], v[164:165] op_sel:[0,0] op_sel_hi:[1,0]
    v_pk_fma_f32 v[184:185], v[164:165], v[164:165], v[184:185] op_sel:[1,1,0] op_sel_hi:[0,1,1] neg_lo:[1,0,0]
    v_cvt_pk_bf16_f32 v138, v170, v171
    v_cvt_pk_bf16_f32 v139, v184, v185
    v_pk_mul_f32 v[172:173], v[170:171], v[168:169] op_sel:[0,0] op_sel_hi:[1,0]
    v_pk_fma_f32 v[172:173], v[170:171], v[168:169], v[172:173] op_sel:[1,1,0] op_sel_hi:[0,1,1] neg_lo:[1,0,0]
    v_pk_mul_f32 v[186:187], v[184:185], v[164:165] op_sel:[0,0] op_sel_hi:[1,0]
    v_pk_fma_f32 v[186:187], v[184:185], v[164:165], v[186:187] op_sel:[1,1,0] op_sel_hi:[0,1,1] neg_lo:[1,0,0]
    v_cvt_pk_bf16_f32 v140, v172, v173
    v_cvt_pk_bf16_f32 v141, v186, v187
    v_pk_mul_f32 v[174:175], v[172:173], v[168:169] op_sel:[0,0] op_sel_hi:[1,0]
    v_pk_fma_f32 v[174:175], v[172:173], v[168:169], v[174:175] op_sel:[1,1,0] op_sel_hi:[0,1,1] neg_lo:[1,0,0]
    v_pk_mul_f32 v[188:189], v[186:187], v[164:165] op_sel:[0,0] op_sel_hi:[1,0]
    v_pk_fma_f32 v[188:189], v[186:187], v[164:165], v[188:189] op_sel:[1,1,0] op_sel_hi:[0,1,1] neg_lo:[1,0,0]
    v_cvt_pk_bf16_f32 v142, v174, v175
    v_cvt_pk_bf16_f32 v143, v188, v189
    v_pk_mul_f32 v[176:177], v[174:175], v[168:169] op_sel:[0,0] op_sel_hi:[1,0]
    v_pk_fma_f32 v[176:177], v[174:175], v[168:169], v[176:177] op_sel:[1,1,0] op_sel_hi:[0,1,1] neg_lo:[1,0,0]
    v_pk_mul_f32 v[190:191], v[188:189], v[164:165] op_sel:[0,0] op_sel_hi:[1,0]
    v_pk_fma_f32 v[190:191], v[188:189], v[164:165], v[190:191] op_sel:[1,1,0] op_sel_hi:[0,1,1] neg_lo:[1,0,0]
    v_cvt_pk_bf16_f32 v240, v176, v177
    v_cvt_pk_bf16_f32 v241, v190, v191
    v_pk_mul_f32 v[178:179], v[176:177], v[168:169] op_sel:[0,0] op_sel_hi:[1,0]
    v_pk_fma_f32 v[178:179], v[176:177], v[168:169], v[178:179] op_sel:[1,1,0] op_sel_hi:[0,1,1] neg_lo:[1,0,0]
    v_pk_mul_f32 v[192:193], v[190:191], v[164:165] op_sel:[0,0] op_sel_hi:[1,0]
    v_pk_fma_f32 v[192:193], v[190:191], v[164:165], v[192:193] op_sel:[1,1,0] op_sel_hi:[0,1,1] neg_lo:[1,0,0]
    v_cvt_pk_bf16_f32 v242, v178, v179
    v_cvt_pk_bf16_f32 v243, v192, v193
    v_pk_mul_f32 v[180:181], v[178:179], v[168:169] op_sel:[0,0] op_sel_hi:[1,0]
    v_pk_fma_f32 v[180:181], v[178:179], v[168:169], v[180:181] op_sel:[1,1,0] op_sel_hi:[0,1,1] neg_lo:[1,0,0]
    v_pk_mul_f32 v[194:195], v[192:193], v[164:165] op_sel:[0,0] op_sel_hi:[1,0]
    v_pk_fma_f32 v[194:195], v[192:193], v[164:165], v[194:195] op_sel:[1,1,0] op_sel_hi:[0,1,1] neg_lo:[1,0,0]
    s_mov_b32 m0, s40
    v_cvt_pk_bf16_f32 v244, v180, v181
    v_cvt_pk_bf16_f32 v245, v194, v195
    ds_write_addtid_b32 v214 offset:8448
    ds_write_addtid_b32 v136 offset:8976
    ds_write_addtid_b32 v137 offset:12672
    ds_write_addtid_b32 v138 offset:9504
    ds_write_addtid_b32 v139 offset:16896
    ds_write_addtid_b32 v140 offset:10032
    ds_write_addtid_b32 v141 offset:19008
    ds_write_addtid_b32 v142 offset:10560
    ds_write_addtid_b32 v143 offset:21120
    ds_write_addtid_b32 v240 offset:11088
    ds_write_addtid_b32 v241 offset:22176
    ds_write_addtid_b32 v242 offset:11616
    ds_write_addtid_b32 v243 offset:23232
    ds_write_addtid_b32 v244 offset:12144
    ds_write_addtid_b32 v245 offset:24288
    v_pk_mul_f32 v[196:197], v[194:195], v[164:165] op_sel:[0,0] op_sel_hi:[1,0]
    v_pk_fma_f32 v[196:197], v[194:195], v[164:165], v[196:197] op_sel:[1,1,0] op_sel_hi:[0,1,1] neg_lo:[1,0,0]
    v_cvt_pk_bf16_f32 v136, v158, -v159
    v_cvt_pk_bf16_f32 v137, v196, v197
    v_pk_mul_f32 v[160:161], v[158:159], v[162:163] op_sel:[0,0] op_sel_hi:[1,0]
    v_pk_fma_f32 v[160:161], v[158:159], v[162:163], v[160:161] op_sel:[1,1,0] op_sel_hi:[0,1,1] neg_lo:[1,0,0]
    v_pk_mul_f32 v[198:199], v[196:197], v[164:165] op_sel:[0,0] op_sel_hi:[1,0]
    v_pk_fma_f32 v[198:199], v[196:197], v[164:165], v[198:199] op_sel:[1,1,0] op_sel_hi:[0,1,1] neg_lo:[1,0,0]
    v_cvt_pk_bf16_f32 v138, v160, -v161
    v_cvt_pk_bf16_f32 v139, v198, v199
    v_pk_mul_f32 v[158:159], v[160:161], v[162:163] op_sel:[0,0] op_sel_hi:[1,0]
    v_pk_fma_f32 v[158:159], v[160:161], v[162:163], v[158:159] op_sel:[1,1,0] op_sel_hi:[0,1,1] neg_lo:[1,0,0]
    v_pk_mul_f32 v[200:201], v[198:199], v[164:165] op_sel:[0,0] op_sel_hi:[1,0]
    v_pk_fma_f32 v[200:201], v[198:199], v[164:165], v[200:201] op_sel:[1,1,0] op_sel_hi:[0,1,1] neg_lo:[1,0,0]
    v_cvt_pk_bf16_f32 v140, v158, -v159
    v_cvt_pk_bf16_f32 v141, v200, v201
    v_pk_mul_f32 v[160:161], v[158:159], v[162:163] op_sel:[0,0] op_sel_hi:[1,0]
    v_pk_fma_f32 v[160:161], v[158:159], v[162:163], v[160:161] op_sel:[1,1,0] op_sel_hi:[0,1,1] neg_lo:[1,0,0]
    v_pk_mul_f32 v[202:203], v[200:201], v[164:165] op_sel:[0,0] op_sel_hi:[1,0]
    v_pk_fma_f32 v[202:203], v[200:201], v[164:165], v[202:203] op_sel:[1,1,0] op_sel_hi:[0,1,1] neg_lo:[1,0,0]
    v_cvt_pk_bf16_f32 v142, v160, -v161
    v_cvt_pk_bf16_f32 v143, v202, v203
    v_pk_mul_f32 v[158:159], v[160:161], v[162:163] op_sel:[0,0] op_sel_hi:[1,0]
    v_pk_fma_f32 v[158:159], v[160:161], v[162:163], v[158:159] op_sel:[1,1,0] op_sel_hi:[0,1,1] neg_lo:[1,0,0]
    v_pk_mul_f32 v[204:205], v[202:203], v[164:165] op_sel:[0,0] op_sel_hi:[1,0]
    v_pk_fma_f32 v[204:205], v[202:203], v[164:165], v[204:205] op_sel:[1,1,0] op_sel_hi:[0,1,1] neg_lo:[1,0,0]
    v_cvt_pk_bf16_f32 v240, v158, -v159
    v_cvt_pk_bf16_f32 v241, v204, v205
    v_pk_mul_f32 v[160:161], v[158:159], v[162:163] op_sel:[0,0] op_sel_hi:[1,0]
    v_pk_fma_f32 v[160:161], v[158:159], v[162:163], v[160:161] op_sel:[1,1,0] op_sel_hi:[0,1,1] neg_lo:[1,0,0]
    v_pk_mul_f32 v[206:207], v[204:205], v[164:165] op_sel:[0,0] op_sel_hi:[1,0]
    v_pk_fma_f32 v[206:207], v[204:205], v[164:165], v[206:207] op_sel:[1,1,0] op_sel_hi:[0,1,1] neg_lo:[1,0,0]
    v_cvt_pk_bf16_f32 v242, v160, -v161
    v_cvt_pk_bf16_f32 v243, v206, v207
    v_pk_mul_f32 v[158:159], v[160:161], v[162:163] op_sel:[0,0] op_sel_hi:[1,0]
    v_pk_fma_f32 v[158:159], v[160:161], v[162:163], v[158:159] op_sel:[1,1,0] op_sel_hi:[0,1,1] neg_lo:[1,0,0]
    v_pk_mul_f32 v[208:209], v[206:207], v[164:165] op_sel:[0,0] op_sel_hi:[1,0]
    v_pk_fma_f32 v[208:209], v[206:207], v[164:165], v[208:209] op_sel:[1,1,0] op_sel_hi:[0,1,1] neg_lo:[1,0,0]
    v_cvt_pk_bf16_f32 v244, v158, -v159
    v_cvt_pk_bf16_f32 v245, v208, v209
    ds_write_addtid_b32 v136 offset:0
    ds_write_addtid_b32 v137 offset:25344
    ds_write_addtid_b32 v138 offset:528
    ds_write_addtid_b32 v139 offset:25872
    ds_write_addtid_b32 v140 offset:1056
    ds_write_addtid_b32 v141 offset:26400
    ds_write_addtid_b32 v142 offset:1584
    ds_write_addtid_b32 v143 offset:26928
    ds_write_addtid_b32 v240 offset:2112
    ds_write_addtid_b32 v241 offset:27456
    ds_write_addtid_b32 v242 offset:2640
    ds_write_addtid_b32 v243 offset:27984
    ds_write_addtid_b32 v244 offset:3168
    ds_write_addtid_b32 v245 offset:28512
    v_pk_mul_f32 v[160:161], v[158:159], v[162:163] op_sel:[0,0] op_sel_hi:[1,0]
    v_pk_fma_f32 v[160:161], v[158:159], v[162:163], v[160:161] op_sel:[1,1,0] op_sel_hi:[0,1,1] neg_lo:[1,0,0]
    v_pk_mul_f32 v[210:211], v[208:209], v[164:165] op_sel:[0,0] op_sel_hi:[1,0]
    v_pk_fma_f32 v[210:211], v[208:209], v[164:165], v[210:211] op_sel:[1,1,0] op_sel_hi:[0,1,1] neg_lo:[1,0,0]
    v_cvt_pk_bf16_f32 v136, v160, -v161
    v_cvt_pk_bf16_f32 v137, v210, v211
    v_pk_mul_f32 v[158:159], v[160:161], v[162:163] op_sel:[0,0] op_sel_hi:[1,0]
    v_pk_fma_f32 v[158:159], v[160:161], v[162:163], v[158:159] op_sel:[1,1,0] op_sel_hi:[0,1,1] neg_lo:[1,0,0]
    v_pk_mul_f32 v[212:213], v[210:211], v[164:165] op_sel:[0,0] op_sel_hi:[1,0]
    v_pk_fma_f32 v[212:213], v[210:211], v[164:165], v[212:213] op_sel:[1,1,0] op_sel_hi:[0,1,1] neg_lo:[1,0,0]
    v_cvt_pk_bf16_f32 v138, v158, -v159
    v_cvt_pk_bf16_f32 v139, v212, v213
    v_pk_mul_f32 v[160:161], v[158:159], v[162:163] op_sel:[0,0] op_sel_hi:[1,0]
    v_pk_fma_f32 v[160:161], v[158:159], v[162:163], v[160:161] op_sel:[1,1,0] op_sel_hi:[0,1,1] neg_lo:[1,0,0]
    v_pk_mul_f32 v[216:217], v[164:165], v[168:169] op_sel:[0,0] op_sel_hi:[1,0]
    v_pk_fma_f32 v[216:217], v[164:165], v[168:169], v[216:217] op_sel:[1,1,0] op_sel_hi:[0,1,1] neg_lo:[1,0,0]
    v_cvt_pk_bf16_f32 v140, v160, -v161
    v_cvt_pk_bf16_f32 v141, v216, v217
    v_pk_mul_f32 v[158:159], v[160:161], v[162:163] op_sel:[0,0] op_sel_hi:[1,0]
    v_pk_fma_f32 v[158:159], v[160:161], v[162:163], v[158:159] op_sel:[1,1,0] op_sel_hi:[0,1,1] neg_lo:[1,0,0]
    v_pk_mul_f32 v[218:219], v[164:165], v[170:171] op_sel:[0,0] op_sel_hi:[1,0]
    v_pk_fma_f32 v[218:219], v[164:165], v[170:171], v[218:219] op_sel:[1,1,0] op_sel_hi:[0,1,1] neg_lo:[1,0,0]
    v_cvt_pk_bf16_f32 v142, v158, -v159
    v_cvt_pk_bf16_f32 v143, v218, v219
    v_pk_mul_f32 v[160:161], v[158:159], v[162:163] op_sel:[0,0] op_sel_hi:[1,0]
    v_pk_fma_f32 v[160:161], v[158:159], v[162:163], v[160:161] op_sel:[1,1,0] op_sel_hi:[0,1,1] neg_lo:[1,0,0]
    v_pk_mul_f32 v[216:217], v[164:165], v[172:173] op_sel:[0,0] op_sel_hi:[1,0]
    v_pk_fma_f32 v[216:217], v[164:165], v[172:173], v[216:217] op_sel:[1,1,0] op_sel_hi:[0,1,1] neg_lo:[1,0,0]
    v_cvt_pk_bf16_f32 v240, v160, -v161
    v_cvt_pk_bf16_f32 v241, v216, v217
    v_pk_mul_f32 v[158:159], v[160:161], v[162:163] op_sel:[0,0] op_sel_hi:[1,0]
    v_pk_fma_f32 v[158:159], v[160:161], v[162:163], v[158:159] op_sel:[1,1,0] op_sel_hi:[0,1,1] neg_lo:[1,0,0]
    v_pk_mul_f32 v[218:219], v[164:165], v[174:175] op_sel:[0,0] op_sel_hi:[1,0]
    v_pk_fma_f32 v[218:219], v[164:165], v[174:175], v[218:219] op_sel:[1,1,0] op_sel_hi:[0,1,1] neg_lo:[1,0,0]
    v_cvt_pk_bf16_f32 v242, v158, -v159
    v_cvt_pk_bf16_f32 v243, v218, v219
    v_pk_mul_f32 v[160:161], v[158:159], v[162:163] op_sel:[0,0] op_sel_hi:[1,0]
    v_pk_fma_f32 v[160:161], v[158:159], v[162:163], v[160:161] op_sel:[1,1,0] op_sel_hi:[0,1,1] neg_lo:[1,0,0]
    v_pk_mul_f32 v[216:217], v[164:165], v[176:177] op_sel:[0,0] op_sel_hi:[1,0]
    v_pk_fma_f32 v[216:217], v[164:165], v[176:177], v[216:217] op_sel:[1,1,0] op_sel_hi:[0,1,1] neg_lo:[1,0,0]
    v_cvt_pk_bf16_f32 v244, v160, -v161
    v_cvt_pk_bf16_f32 v245, v216, v217
    ds_write_addtid_b32 v136 offset:3696
    ds_write_addtid_b32 v137 offset:29040
    ds_write_addtid_b32 v138 offset:4224
    ds_write_addtid_b32 v139 offset:29568
    ds_write_addtid_b32 v140 offset:4752
    ds_write_addtid_b32 v141 offset:13200
    ds_write_addtid_b32 v142 offset:5280
    ds_write_addtid_b32 v143 offset:13728
    ds_write_addtid_b32 v240 offset:5808
    ds_write_addtid_b32 v241 offset:14256
    ds_write_addtid_b32 v242 offset:6336
    ds_write_addtid_b32 v243 offset:14784
    ds_write_addtid_b32 v244 offset:6864
    ds_write_addtid_b32 v245 offset:15312
    v_pk_mul_f32 v[158:159], v[160:161], v[162:163] op_sel:[0,0] op_sel_hi:[1,0]
    v_pk_fma_f32 v[158:159], v[160:161], v[162:163], v[158:159] op_sel:[1,1,0] op_sel_hi:[0,1,1] neg_lo:[1,0,0]
    v_pk_mul_f32 v[218:219], v[164:165], v[178:179] op_sel:[0,0] op_sel_hi:[1,0]
    v_pk_fma_f32 v[218:219], v[164:165], v[178:179], v[218:219] op_sel:[1,1,0] op_sel_hi:[0,1,1] neg_lo:[1,0,0]
    v_cvt_pk_bf16_f32 v136, v158, -v159
    v_cvt_pk_bf16_f32 v137, v218, v219
    v_pk_mul_f32 v[160:161], v[158:159], v[162:163] op_sel:[0,0] op_sel_hi:[1,0]
    v_pk_fma_f32 v[160:161], v[158:159], v[162:163], v[160:161] op_sel:[1,1,0] op_sel_hi:[0,1,1] neg_lo:[1,0,0]
    v_pk_mul_f32 v[216:217], v[164:165], v[180:181] op_sel:[0,0] op_sel_hi:[1,0]
    v_pk_fma_f32 v[216:217], v[164:165], v[180:181], v[216:217] op_sel:[1,1,0] op_sel_hi:[0,1,1] neg_lo:[1,0,0]
    v_cvt_pk_bf16_f32 v138, v160, -v161
    v_cvt_pk_bf16_f32 v139, v216, v217
    v_pk_mul_f32 v[222:223], v[186:187], v[178:179] op_sel:[0,0] op_sel_hi:[1,0]
    v_pk_fma_f32 v[222:223], v[186:187], v[178:179], v[222:223] op_sel:[1,1,0] op_sel_hi:[0,1,1] neg_lo:[1,0,0]
    v_pk_mul_f32 v[218:219], v[184:185], v[170:171] op_sel:[0,0] op_sel_hi:[1,0]
    v_pk_fma_f32 v[218:219], v[184:185], v[170:171], v[218:219] op_sel:[1,1,0] op_sel_hi:[0,1,1] neg_lo:[1,0,0]
    v_cvt_pk_bf16_f32 v140, v222, v223
    v_cvt_pk_bf16_f32 v141, v218, v219
    v_pk_mul_f32 v[220:221], v[188:189], v[174:175] op_sel:[0,0] op_sel_hi:[1,0]
    v_pk_fma_f32 v[220:221], v[188:189], v[174:175], v[220:221] op_sel:[1,1,0] op_sel_hi:[0,1,1] neg_lo:[1,0,0]
    v_pk_mul_f32 v[216:217], v[184:185], v[174:175] op_sel:[0,0] op_sel_hi:[1,0]
    v_pk_fma_f32 v[216:217], v[184:185], v[174:175], v[216:217] op_sel:[1,1,0] op_sel_hi:[0,1,1] neg_lo:[1,0,0]
    v_cvt_pk_bf16_f32 v142, v220, v221
    v_cvt_pk_bf16_f32 v143, v216, v217
    v_pk_mul_f32 v[222:223], v[190:191], v[174:175] op_sel:[0,0] op_sel_hi:[1,0]
    v_pk_fma_f32 v[222:223], v[190:191], v[174:175], v[222:223] op_sel:[1,1,0] op_sel_hi:[0,1,1] neg_lo:[1,0,0]
    v_pk_mul_f32 v[218:219], v[184:185], v[178:179] op_sel:[0,0] op_sel_hi:[1,0]
    v_pk_fma_f32 v[218:219], v[184:185], v[178:179], v[218:219] op_sel:[1,1,0] op_sel_hi:[0,1,1] neg_lo:[1,0,0]
    v_cvt_pk_bf16_f32 v240, v222, v223
    v_cvt_pk_bf16_f32 v241, v218, v219
    v_pk_mul_f32 v[220:221], v[192:193], v[174:175] op_sel:[0,0] op_sel_hi:[1,0]
    v_pk_fma_f32 v[220:221], v[192:193], v[174:175], v[220:221] op_sel:[1,1,0] op_sel_hi:[0,1,1] neg_lo:[1,0,0]
    v_pk_mul_f32 v[216:217], v[186:187], v[170:171] op_sel:[0,0] op_sel_hi:[1,0]
    v_pk_fma_f32 v[216:217], v[186:187], v[170:171], v[216:217] op_sel:[1,1,0] op_sel_hi:[0,1,1] neg_lo:[1,0,0]
    v_cvt_pk_bf16_f32 v242, v220, v221
    v_cvt_pk_bf16_f32 v243, v216, v217
    v_pk_mul_f32 v[222:223], v[194:195], v[174:175] op_sel:[0,0] op_sel_hi:[1,0]
    v_pk_fma_f32 v[222:223], v[194:195], v[174:175], v[222:223] op_sel:[1,1,0] op_sel_hi:[0,1,1] neg_lo:[1,0,0]
    v_pk_mul_f32 v[218:219], v[186:187], v[174:175] op_sel:[0,0] op_sel_hi:[1,0]
    v_pk_fma_f32 v[218:219], v[186:187], v[174:175], v[218:219] op_sel:[1,1,0] op_sel_hi:[0,1,1] neg_lo:[1,0,0]
    v_cvt_pk_bf16_f32 v244, v222, v223
    v_cvt_pk_bf16_f32 v245, v218, v219
    ds_write_addtid_b32 v136 offset:7392
    ds_write_addtid_b32 v137 offset:15840
    ds_write_addtid_b32 v138 offset:7920
    ds_write_addtid_b32 v139 offset:16368
    ds_write_addtid_b32 v140 offset:20592
    ds_write_addtid_b32 v141 offset:17424
    ds_write_addtid_b32 v142 offset:21648
    ds_write_addtid_b32 v143 offset:17952
    ds_write_addtid_b32 v240 offset:22704
    ds_write_addtid_b32 v241 offset:18480
    ds_write_addtid_b32 v242 offset:23760
    ds_write_addtid_b32 v243 offset:19536
    ds_write_addtid_b32 v244 offset:24816
    ds_write_addtid_b32 v245 offset:20064
    s_waitcnt vmcnt(4)
    buffer_load_dwordx4 v[40:43], v3, s[4:7], s20 offen sc1
    buffer_load_dwordx4 v[44:47], v3, s[4:7], s20 offen offset:1024 sc1
    buffer_load_dword v48, v76, s[4:7], s64 offen sc1
    v_and_b32 v133, 63, v128
    v_and_b32 v134, 15, v133
    v_lshrrev_b32 v135, 4, v133
    v_lshrrev_b32 v131, 7, v128
    v_bfe_u32 v149, v128, 6, 1
    v_mul_u32_u24 v150, 30208, v131
    v_and_b32 v151, 1, v135
    v_lshlrev_b32 v151, 8, v151
    v_lshrrev_b32 v152, 1, v135
    v_lshl_add_u32 v151, v152, 7, v151
    v_add_u32 v151, v151, v150
    v_mul_u32_u24 v152, 528, v134
    v_add_u32 v233, v151, v152
    v_mul_u32_u24 v152, 8448, v149
    v_add_u32 v234, v233, v152
    v_min_u32 v152, 8, v134
    v_mul_u32_u24 v152, 528, v152
    v_add_u32 v235, v151, v152
    v_lshrrev_b32 v151, 1, v135
    v_lshlrev_b32 v151, 7, v151
    v_and_b32 v152, 1, v135
    v_lshl_add_u32 v151, v152, 2, v151
    v_lshl_add_u32 v151, v134, 3, v151
    v_lshlrev_b32 v152, 6, v135
    v_add_u32 v152, 256, v152
    v_lshlrev_b32 v153, 2, v134
    v_lshlrev_b32 v154, 1, v134
    v_cmp_lt_u32 vcc, 1, v135
    s_nop 1
    v_cndmask_b32 v153, v153, v154, vcc
    v_cndmask_b32 v155, 2, 32, vcc
    v_add_u32 v152, v152, v153
    v_cmp_eq_u32 vcc, 1, v149
    s_nop 1
    v_cndmask_b32 v151, v151, v152, vcc
    v_cndmask_b32 v155, 2, v155, vcc
    v_mul_u32_u24 v152, 768, v131
    v_add_u32 v151, v151, v152
    v_lshlrev_b32 v236, 1, v151
    v_lshl_add_u32 v237, v155, 1, v236
    v_lshlrev_b32 v151, 6, v135
    v_add3_u32 v151, v151, v134, v152
    v_lshlrev_b32 v238, 1, v151
    v_lshlrev_b32 v239, 4, v128
    s_branch .Lgat1_chk
.p2alignl 12, 0xbf810000
.Lpage2:
.Lgat1:
    buffer_load_dwordx4 v[40:43], v3, s[4:7], s20 offen sc1
    buffer_load_dwordx4 v[44:47], v3, s[4:7], s20 offen offset:1024 sc1
    buffer_load_dword v48, v76, s[4:7], s64 offen sc1
    s_addk_i32 s59, 0x2000
    s_cbranch_scc1 .Lend
.Lgat1_chk:
    s_waitcnt vmcnt(0)
    v_xor_b32 v49, s47, v48
    v_and_b32 v50, 4, v48
    v_readfirstlane_b32 s41, v48
    v_cmp_ne_u32 s[42:43], 0, v50
    v_cmp_lt_u32 vcc, 7, v49
    s_cbranch_vccnz .Lgat1
    s_and_b32 s41, s41, 3
    s_cmp_eq_u32 s41, s67
    s_cbranch_scc0 .Lredo
    v_add_f32 v40, v40, v44
    v_add_f32 v42, v42, v46
    v_bitop3_b32 v41, v41, v43, s47 bitop3:0x7e
    v_bitop3_b32 v43, v45, v47, s47 bitop3:0x7e
    v_add_f32_dpp v44, v40, v40 row_ror:8 row_mask:0xf bank_mask:0xf
    v_add_f32_dpp v46, v40, v40 row_ror:8 row_mask:0xf bank_mask:0xf
    v_add_f32_dpp v45, v42, v42 row_ror:8 row_mask:0xf bank_mask:0xf
    v_add_f32_dpp v47, v42, v42 row_ror:8 row_mask:0xf bank_mask:0xf
    v_permlane16_swap_b32 v44, v46
    v_or_b32 v41, v41, v43
    v_permlane16_swap_b32 v45, v47
    v_cmp_ne_u32 vcc, 0, v41
    v_pk_add_f32 v[40:41], v[44:45], v[46:47]
    v_pk_mul_f32 v[40:41], v[40:41], s[26:27]
    v_fma_f32 v41, -v40, v40, v41
    v_max_f32 v41, 0, v41
    v_add_f32 v42, 0x3727c5ac, v41
    v_rsq_f32 v42, v42
    s_cbranch_vccnz .Lgat1
    s_and_b32 s42, s42, 0xffff
    s_lshr_b32 s43, 0xf0f0f0f0, s67
    s_and_b32 s41, s42, s43
    s_andn2_b32 s42, s42, s43
    s_bcnt1_i32_b32 s41, s41
    s_bcnt1_i32_b32 s42, s42
    s_cmp_gt_u32 s41, s42
    s_cselect_b32 s42, 8192, 0
    s_xor_b32 s22, s22, s42
    s_xor_b32 s31, s31, s42
    s_xor_b32 s56, s56, s42
    s_xor_b32 s57, s57, s42
    v_mul_f32 v40, v40, v42
    v_mov_b32_dpp v24, v42 row_newbcast:0 row_mask:0xf bank_mask:0xf
    v_mov_b32_dpp v25, v42 row_newbcast:1 row_mask:0xf bank_mask:0xf
    v_mov_b32_dpp v26, v42 row_newbcast:2 row_mask:0xf bank_mask:0xf
    v_mov_b32_dpp v27, v42 row_newbcast:3 row_mask:0xf bank_mask:0xf
    v_mov_b32_dpp v28, v42 row_newbcast:4 row_mask:0xf bank_mask:0xf
    v_mov_b32_dpp v29, v42 row_newbcast:5 row_mask:0xf bank_mask:0xf
    v_mov_b32_dpp v30, v42 row_newbcast:6 row_mask:0xf bank_mask:0xf
    v_mov_b32_dpp v31, v42 row_newbcast:7 row_mask:0xf bank_mask:0xf
    v_mov_b32_dpp v32, v40 row_newbcast:0 row_mask:0xf bank_mask:0xf
    v_mov_b32_dpp v33, v40 row_newbcast:1 row_mask:0xf bank_mask:0xf
    v_mov_b32_dpp v34, v40 row_newbcast:2 row_mask:0xf bank_mask:0xf
    v_mov_b32_dpp v35, v40 row_newbcast:3 row_mask:0xf bank_mask:0xf
    v_mov_b32_dpp v36, v40 row_newbcast:4 row_mask:0xf bank_mask:0xf
    v_mov_b32_dpp v37, v40 row_newbcast:5 row_mask:0xf bank_mask:0xf
    v_mov_b32_dpp v38, v40 row_newbcast:6 row_mask:0xf bank_mask:0xf
    v_mov_b32_dpp v39, v40 row_newbcast:7 row_mask:0xf bank_mask:0xf
    v_pk_fma_f32 v[40:41], v[8:9], v[24:25], v[32:33]
    v_pk_fma_f32 v[42:43], v[10:11], v[26:27], v[34:35]
    v_pk_fma_f32 v[44:45], v[12:13], v[28:29], v[36:37]
    v_pk_fma_f32 v[46:47], v[14:15], v[30:31], v[38:39]
    v_cvt_pk_bf16_f32 v56, v40, v44
    v_cvt_pk_bf16_f32 v57, v41, v45
    v_cvt_pk_bf16_f32 v58, v42, v46
    v_cvt_pk_bf16_f32 v59, v43, v47
    buffer_store_dwordx4 v[56:59], v1, s[4:7], s22 offen offset:0 sc1
    v_pk_fma_f32 v[48:49], v[16:17], v[24:25], v[32:33]
    v_pk_fma_f32 v[50:51], v[18:19], v[26:27], v[34:35]
    v_pk_fma_f32 v[52:53], v[20:21], v[28:29], v[36:37]
    v_pk_fma_f32 v[54:55], v[22:23], v[30:31], v[38:39]
    v_cvt_pk_bf16_f32 v60, v48, v52
    v_cvt_pk_bf16_f32 v61, v49, v53
    v_cvt_pk_bf16_f32 v62, v50, v54
    v_cvt_pk_bf16_f32 v63, v51, v55
    buffer_store_dwordx4 v[60:63], v1, s[4:7], s22 offen offset:512 sc1
    s_mov_b32 exec_hi, 0xffff
    buffer_store_dwordx4 v[64:67], v69, s[4:7], s66 offen sc1
    buffer_store_dwordx4 v[64:67], v70, s[4:7], s66 offen sc1
    s_mov_b32 exec_hi, -1
    v_lshlrev_b32 v24, 16, v0
    v_and_b32 v26, 0xffff0000, v0
    v_pk_fma_f32 v[8:9], v[40:41], v[24:25], v[8:9] op_sel_hi:[1,0,1]
    v_pk_fma_f32 v[10:11], v[42:43], v[24:25], v[10:11] op_sel_hi:[1,0,1]
    v_pk_fma_f32 v[12:13], v[44:45], v[24:25], v[12:13] op_sel_hi:[1,0,1]
    v_pk_fma_f32 v[14:15], v[46:47], v[24:25], v[14:15] op_sel_hi:[1,0,1]
    v_pk_fma_f32 v[16:17], v[48:49], v[26:27], v[16:17] op_sel_hi:[1,0,1]
    v_pk_fma_f32 v[18:19], v[50:51], v[26:27], v[18:19] op_sel_hi:[1,0,1]
    v_pk_fma_f32 v[20:21], v[52:53], v[26:27], v[20:21] op_sel_hi:[1,0,1]
    v_pk_fma_f32 v[22:23], v[54:55], v[26:27], v[22:23] op_sel_hi:[1,0,1]
    s_add_u32 m0, s55, 8192
    s_add_u32 s43, s50, 57344
    buffer_load_dwordx4 v250, s[8:11], s50 offen lds
    buffer_load_dwordx4 v251, s[8:11], s50 offen offset:1024 lds
    s_cmp_eq_u32 s43, s52
    s_cselect_b32 s50, s51, s43
    s_add_u32 m0, s55, 10240
    s_add_u32 s43, s50, 57344
    buffer_load_dwordx4 v250, s[8:11], s50 offen lds
    buffer_load_dwordx4 v251, s[8:11], s50 offen offset:1024 lds
    s_cmp_eq_u32 s43, s52
    s_cselect_b32 s50, s51, s43
    v_cmp_gt_u32 vcc, 16, v128
    v_lshlrev_b32 v149, 3, v128
    v_mov_b32 v151, 0x800080
    v_cndmask_b32 v151, 0, v151, vcc
    v_and_b32 v150, 0x80, v151
    v_add_u32 v149, v149, v150
    v_cvt_f32_u32 v152, v149
    v_add_f32 v153, 1.0, v152
    v_cvt_pk_bf16_f32 v150, v152, v153
    v_pk_add_f32 v[152:153], v[152:153], 2.0 op_sel_hi:[1,0]
    v_sub_u32 v150, v150, v151
    v_lshlrev_b32_sdwa v224, 1, v150 dst_sel:DWORD dst_unused:UNUSED_PAD src0_sel:DWORD src1_sel:WORD_0
    v_lshlrev_b32_sdwa v225, 1, v150 dst_sel:DWORD dst_unused:UNUSED_PAD src0_sel:DWORD src1_sel:WORD_1
    v_cvt_pk_bf16_f32 v150, v152, v153
    v_pk_add_f32 v[152:153], v[152:153], 2.0 op_sel_hi:[1,0]
    v_sub_u32 v150, v150, v151
    v_lshlrev_b32_sdwa v226, 1, v150 dst_sel:DWORD dst_unused:UNUSED_PAD src0_sel:DWORD src1_sel:WORD_0
    v_lshlrev_b32_sdwa v227, 1, v150 dst_sel:DWORD dst_unused:UNUSED_PAD src0_sel:DWORD src1_sel:WORD_1
    v_cvt_pk_bf16_f32 v150, v152, v153
    v_pk_add_f32 v[152:153], v[152:153], 2.0 op_sel_hi:[1,0]
    v_sub_u32 v150, v150, v151
    v_lshlrev_b32_sdwa v228, 1, v150 dst_sel:DWORD dst_unused:UNUSED_PAD src0_sel:DWORD src1_sel:WORD_0
    v_lshlrev_b32_sdwa v229, 1, v150 dst_sel:DWORD dst_unused:UNUSED_PAD src0_sel:DWORD src1_sel:WORD_1
    v_cvt_pk_bf16_f32 v150, v152, v153
    v_sub_u32 v150, v150, v151
    v_lshlrev_b32_sdwa v230, 1, v150 dst_sel:DWORD dst_unused:UNUSED_PAD src0_sel:DWORD src1_sel:WORD_0
    v_lshlrev_b32_sdwa v231, 1, v150 dst_sel:DWORD dst_unused:UNUSED_PAD src0_sel:DWORD src1_sel:WORD_1
    s_waitcnt lgkmcnt(0)
    s_barrier
    ds_read_b128 v[24:27], v233 offset:0
    ds_read_b128 v[28:31], v233 offset:16
    ds_read_b128 v[32:35], v233 offset:32
    ds_read_b128 v[36:39], v233 offset:48
    ds_read_b128 v[40:43], v233 offset:64
    ds_read_b128 v[44:47], v233 offset:80
    ds_read_b128 v[48:51], v233 offset:96
    ds_read_b128 v[52:55], v233 offset:112
    s_waitcnt lgkmcnt(4)
    ds_read_b128 v[56:59], v234 offset:8448
    ds_read_b128 v[60:63], v234 offset:8464
    ds_read_b128 v[64:67], v234 offset:8480
    ds_read_b128 v[68:71], v234 offset:8496
    ds_read_b128 v[72:75], v234 offset:8512
    ds_read_b128 v[76:79], v234 offset:8528
    ds_read_b128 v[80:83], v234 offset:8544
    ds_read_b128 v[84:87], v234 offset:8560
    s_waitcnt lgkmcnt(4)
    ds_read_b128 v[88:91], v235 offset:25344
    ds_read_b128 v[92:95], v235 offset:25360
    ds_read_b128 v[96:99], v235 offset:25376
    ds_read_b128 v[100:103], v235 offset:25392
    ds_read_b128 v[104:107], v235 offset:25408
    ds_read_b128 v[108:111], v235 offset:25424
    ds_read_b128 v[112:115], v235 offset:25440
    ds_read_b128 v[116:119], v235 offset:25456
    s_waitcnt lgkmcnt(8)
    v_mfma_f32_16x16x32_bf16 v[120:123], v[56:59], v[24:27], 0
    v_mfma_f32_16x16x32_bf16 v[120:123], v[60:63], v[28:31], v[120:123]
    v_mfma_f32_16x16x32_bf16 v[120:123], v[64:67], v[32:35], v[120:123]
    v_mfma_f32_16x16x32_bf16 v[120:123], v[68:71], v[36:39], v[120:123]
    v_mfma_f32_16x16x32_bf16 v[120:123], v[72:75], v[40:43], v[120:123]
    v_mfma_f32_16x16x32_bf16 v[120:123], v[76:79], v[44:47], v[120:123]
    v_mfma_f32_16x16x32_bf16 v[120:123], v[80:83], v[48:51], v[120:123]
    v_mfma_f32_16x16x32_bf16 v[120:123], v[84:87], v[52:55], v[120:123]
    s_waitcnt lgkmcnt(0)
    v_mfma_f32_16x16x32_bf16 v[124:127], v[88:91], v[24:27], 0
    v_mfma_f32_16x16x32_bf16 v[124:127], v[92:95], v[28:31], v[124:127]
    v_mfma_f32_16x16x32_bf16 v[124:127], v[96:99], v[32:35], v[124:127]
    v_mfma_f32_16x16x32_bf16 v[124:127], v[100:103], v[36:39], v[124:127]
    v_mfma_f32_16x16x32_bf16 v[124:127], v[104:107], v[40:43], v[124:127]
    v_mfma_f32_16x16x32_bf16 v[124:127], v[108:111], v[44:47], v[124:127]
    v_mfma_f32_16x16x32_bf16 v[124:127], v[112:115], v[48:51], v[124:127]
    v_mfma_f32_16x16x32_bf16 v[124:127], v[116:119], v[52:55], v[124:127]
    v_cvt_pk_bf16_f32 v150, v120, v121
    v_cvt_pk_bf16_f32 v151, v122, v123
    ds_write_b32 v236, v150 offset:60416
    ds_write_b32 v237, v151 offset:60416
    s_nop 3
    v_cvt_pk_bf16_f32 v152, v124, v125
    v_cvt_pk_bf16_f32 v153, v126, v127
    ds_write_b16 v238, v152 offset:61440
    ds_write_b16_d16_hi v238, v152 offset:61472
    ds_write_b16 v238, v153 offset:61504
    ds_write_b16_d16_hi v238, v153 offset:61536
    v_mbcnt_lo_u32_b32 v156, -1, 0
    v_mbcnt_hi_u32_b32 v156, -1, v156
    v_lshlrev_b32 v156, 10, v156
    v_mov_b32 v157, s47
    s_waitcnt lgkmcnt(0)
    s_waitcnt vmcnt(6)
    s_barrier
    s_mov_b64 exec, 0xff
    buffer_store_dword v157, v156, s[4:7], s56 offen sc1
    s_mov_b64 exec, -1
    s_add_u32 s56, s56, 16
    s_load_dword s60, s[4:5], s57 offset:64 glc
    s_load_dword s61, s[4:5], s57 offset:192 glc
    ds_read_b64_tr_b16 a[0:1], v254 offset:0
    ds_read_b64_tr_b16 a[2:3], v254 offset:512
    ds_read_b64_tr_b16 a[4:5], v255 offset:0
    ds_read_b64_tr_b16 a[6:7], v255 offset:512
    ds_read_b64_tr_b16 a[8:9], v254 offset:2048
    ds_read_b64_tr_b16 a[10:11], v254 offset:2560
    ds_read_b64_tr_b16 a[12:13], v255 offset:2048
    ds_read_b64_tr_b16 a[14:15], v255 offset:2560
    ds_read_b64_tr_b16 a[16:17], v254 offset:4096
    ds_read_b64_tr_b16 a[18:19], v254 offset:4608
    ds_read_b64_tr_b16 a[20:21], v255 offset:4096
    ds_read_b64_tr_b16 a[22:23], v255 offset:4608
    ds_read_b64_tr_b16 a[24:25], v254 offset:6144
    ds_read_b64_tr_b16 a[26:27], v254 offset:6656
    ds_read_b64_tr_b16 a[28:29], v255 offset:6144
    ds_read_b64_tr_b16 a[30:31], v255 offset:6656
    s_add_u32 m0, s55, 12288
    s_add_u32 s43, s50, 57344
    buffer_load_dwordx4 v250, s[8:11], s50 offen lds
    buffer_load_dwordx4 v251, s[8:11], s50 offen offset:1024 lds
    s_cmp_eq_u32 s43, s52
    s_cselect_b32 s50, s51, s43
    s_add_u32 m0, s55, 14336
    s_add_u32 s43, s50, 57344
    buffer_load_dwordx4 v250, s[8:11], s50 offen lds
    buffer_load_dwordx4 v251, s[8:11], s50 offen offset:1024 lds
    s_cmp_eq_u32 s43, s52
    s_cselect_b32 s50, s51, s43
    s_add_u32 m0, s55, 16384
    s_add_u32 s43, s50, 57344
    buffer_load_dwordx4 v250, s[8:11], s50 offen lds
    buffer_load_dwordx4 v251, s[8:11], s50 offen offset:1024 lds
    s_cmp_eq_u32 s43, s52
    s_cselect_b32 s50, s51, s43
    s_add_u32 m0, s55, 18432
    s_add_u32 s43, s50, 57344
    buffer_load_dwordx4 v250, s[8:11], s50 offen lds
    buffer_load_dwordx4 v251, s[8:11], s50 offen offset:1024 lds
    s_cmp_eq_u32 s43, s52
    s_cselect_b32 s50, s51, s43
    s_add_u32 s43, s53, 0
    s_sub_u32 s41, s43, 1835008
    s_add_u32 m0, s55, 20480
    s_cmp_ge_u32 s43, s54
    s_cselect_b32 s43, s41, s43
    buffer_load_dwordx4 v252, s[12:15], s43 offen lds
    buffer_load_dwordx4 v253, s[12:15], s43 offen offset:1024 lds
    s_add_u32 s43, s53, 65536
    s_sub_u32 s41, s43, 1835008
    s_add_u32 m0, s55, 22528
    s_cmp_ge_u32 s43, s54
    s_cselect_b32 s43, s41, s43
    buffer_load_dwordx4 v252, s[12:15], s43 offen lds
    buffer_load_dwordx4 v253, s[12:15], s43 offen offset:1024 lds
    v_mbcnt_lo_u32_b32 v60, -1, 0
    v_mbcnt_hi_u32_b32 v60, -1, v60
    s_lshr_b32 s28, s44, 1
    v_lshrrev_b32 v61, 1, v60
    v_and_b32 v62, 1, v60
    v_lshlrev_b32 v1, 10, v61
    v_lshl_add_u32 v1, v62, 4, v1
    v_lshrrev_b32 v63, 4, v60
    v_lshl_add_u32 v1, v63, 13, v1
    s_lshl_b32 s20, s44, 17
    s_add_u32 s20, s20, s31
    s_lshl_b32 s42, s46, 5
    s_add_u32 s20, s20, s42
    s_add_u32 s20, s20, 0
    s_add_u32 s21, s20, 65536
    v_lshrrev_b32 v63, 3, v60
    v_lshlrev_b32 v2, 6, v63
    v_and_b32 v63, 3, v61
    v_lshl_add_u32 v2, v63, 2, v2
    v_mul_u32_u24 v63, 4640, v62
    s_lshl_b32 s42, s44, 10
    s_add_u32 s42, s42, 8832
    v_add3_u32 v2, v2, v63, s42
    v_and_b32 v63, 31, v60
    v_lshlrev_b32 v3, 4, v63
    v_lshrrev_b32 v63, 5, v60
    v_lshlrev_b32 v63, 6, v63
    v_sub_u32 v3, v3, v63
    s_mul_i32 s42, s28, 4640
    s_add_u32 s42, s42, 8448
    v_add_u32 v3, s42, v3
    v_bfe_u32 v63, v60, 2, 2
    v_and_b32 v4, 3, v60
    v_sub_u32 v4, v4, v63
    v_lshlrev_b32 v4, 3, v4
    v_lshrrev_b32 v63, 4, v60
    v_lshl_add_u32 v4, v63, 5, v4
    s_mul_i32 s42, s28, 4160
    s_add_u32 s42, s42, 32
    v_add_u32 v4, s42, v4
    v_lshrrev_b32 v63, 2, v60
    v_lshlrev_b32 v5, 6, v63
    v_lshl_add_u32 v5, v62, 5, v5
    v_lshlrev_b32 v7, 11, v63
    v_and_b32 v63, 3, v60
    v_lshl_add_u32 v7, v63, 4, v7
    v_lshrrev_b32 v63, 4, v60
    v_lshl_add_u32 v7, v63, 13, v7
    v_and_b32 v61, 1, v61
    v_mul_u32_u24 v63, 10640, v61
    s_lshl_b32 s42, s44, 11
    s_add_u32 s42, s42, 17600
    v_add3_u32 v5, v5, v63, s42
    s_mul_i32 s42, s44, 544
    s_add_u32 s42, s42, 26048
    v_add_u32 v6, s42, v63
    s_lshl_b32 s22, s44, 17
    s_add_u32 s22, s22, s31
    s_lshl_b32 s42, s46, 6
    s_add_u32 s22, s22, s42
    s_add_u32 s22, s22, 524288
    s_add_u32 s23, s22, 65536
    s_mul_i32 s29, s28, 10640
    v_mbcnt_lo_u32_b32 v60, -1, 0
    v_mbcnt_hi_u32_b32 v60, -1, v60
    v_mov_b32 v61, 0
    s_mul_i32 s42, s28, 4128
    s_lshl_b32 s41, s44, 8
    s_add_u32 s42, s42, s41
    v_lshl_add_u32 v63, v60, 2, s42
    ds_write_b32 v63, v61 offset:8320
    v_and_b32 v63, 3, v60
    v_lshl_add_u32 v63, v63, 2, s29
    ds_write_b32 v63, v61 offset:26048
.Lpoll2:
    s_load_dwordx4 s[60:63], s[4:5], s57 glc
    s_load_dwordx4 s[64:67], s[4:5], s57 offset:128 glc
    s_addk_i32 s59, 0x2000
    s_cbranch_scc1 .Lend
.Lpoll2_chk:
    s_waitcnt lgkmcnt(0)
    s_xor_b64 s[60:61], s[60:61], s[32:33]
    s_xor_b64 s[62:63], s[62:63], s[32:33]
    s_xor_b64 s[64:65], s[64:65], s[32:33]
    s_xor_b64 s[66:67], s[66:67], s[32:33]
    s_or_b64 s[60:61], s[60:61], s[62:63]
    s_or_b64 s[64:65], s[64:65], s[66:67]
    s_or_b64 s[60:61], s[60:61], s[64:65]
    s_cbranch_scc1 .Lpoll2
    s_add_u32 s57, s57, 16
    buffer_load_dwordx4 v[24:27], v1, s[4:7], s20 offen sc1
    buffer_load_dwordx4 v[28:31], v1, s[4:7], s21 offen sc1
    ds_read_u16 v64, v224 offset:26368
    ds_read_u16 v65, v225 offset:26368
    ds_read_u16 v66, v226 offset:26368
    ds_read_u16 v67, v227 offset:26368
    ds_read_u16 v68, v228 offset:26368
    ds_read_u16 v69, v229 offset:26368
    ds_read_u16 v70, v230 offset:26368
    ds_read_u16 v71, v231 offset:26368
    ds_read_u16 v72, v224 offset:27904
    ds_read_u16 v73, v225 offset:27904
    ds_read_u16 v74, v226 offset:27904
    ds_read_u16 v75, v227 offset:27904
    ds_read_u16 v76, v228 offset:27904
    ds_read_u16 v77, v229 offset:27904
    ds_read_u16 v78, v230 offset:27904
    ds_read_u16 v79, v231 offset:27904
    v_mul_u32_u24 v150, 4160, v131
    v_lshl_add_u32 v150, v134, 2, v150
    v_mov_b32 v151, 0
    ds_write_b32 v150, v151 offset:0
    s_waitcnt lgkmcnt(9)
    v_lshl_or_b32 v80, v65, 16, v64
    v_lshl_or_b32 v81, v67, 16, v66
    v_lshl_or_b32 v82, v69, 16, v68
    v_lshl_or_b32 v83, v71, 16, v70
    ds_write_b128 v239, v[80:83] offset:64
    s_waitcnt lgkmcnt(2)
    v_lshl_or_b32 v84, v73, 16, v72
    v_lshl_or_b32 v85, v75, 16, v74
    v_lshl_or_b32 v86, v77, 16, v76
    v_lshl_or_b32 v87, v79, 16, v78
    ds_write_b128 v239, v[84:87] offset:4224
    s_waitcnt vmcnt(17)
    ds_read_b64_tr_b16 a[32:33], v254 offset:8192
    ds_read_b64_tr_b16 a[34:35], v254 offset:8704
    ds_read_b64_tr_b16 a[36:37], v255 offset:8192
    ds_read_b64_tr_b16 a[38:39], v255 offset:8704
    s_waitcnt vmcnt(15)
    ds_read_b64_tr_b16 a[40:41], v254 offset:10240
    ds_read_b64_tr_b16 a[42:43], v254 offset:10752
    ds_read_b64_tr_b16 a[44:45], v255 offset:10240
    ds_read_b64_tr_b16 a[46:47], v255 offset:10752
    s_waitcnt vmcnt(12)
    ds_read_b64_tr_b16 a[48:49], v254 offset:12288
    ds_read_b64_tr_b16 a[50:51], v254 offset:12800
    ds_read_b64_tr_b16 a[52:53], v255 offset:12288
    ds_read_b64_tr_b16 a[54:55], v255 offset:12800
    s_waitcnt vmcnt(10)
    ds_read_b64_tr_b16 a[56:57], v254 offset:14336
    ds_read_b64_tr_b16 a[58:59], v254 offset:14848
    ds_read_b64_tr_b16 a[60:61], v255 offset:14336
    ds_read_b64_tr_b16 a[62:63], v255 offset:14848
    s_waitcnt vmcnt(8)
    ds_read_b64_tr_b16 a[64:65], v254 offset:16384
    ds_read_b64_tr_b16 a[66:67], v254 offset:16896
    ds_read_b64_tr_b16 a[68:69], v255 offset:16384
    ds_read_b64_tr_b16 a[70:71], v255 offset:16896
    s_waitcnt vmcnt(6)
    ds_read_b64_tr_b16 a[72:73], v254 offset:18432
    ds_read_b64_tr_b16 a[74:75], v254 offset:18944
    ds_read_b64_tr_b16 a[76:77], v255 offset:18432
    ds_read_b64_tr_b16 a[78:79], v255 offset:18944
    s_waitcnt vmcnt(4)
    ds_read_b64_tr_b16 v[128:129], v254 offset:20480
    ds_read_b64_tr_b16 v[130:131], v254 offset:20992
    ds_read_b64_tr_b16 v[132:133], v255 offset:20480
    ds_read_b64_tr_b16 v[134:135], v255 offset:20992
    s_waitcnt vmcnt(2)
    ds_read_b64_tr_b16 v[136:137], v254 offset:22528
    ds_read_b64_tr_b16 v[138:139], v254 offset:23040
    ds_read_b64_tr_b16 v[140:141], v255 offset:22528
    ds_read_b64_tr_b16 v[142:143], v255 offset:23040
    s_add_u32 s43, s53, 131072
    s_sub_u32 s41, s43, 1835008
    s_add_u32 m0, s55, 0
    s_cmp_ge_u32 s43, s54
    s_cselect_b32 s43, s41, s43
    buffer_load_dwordx4 v252, s[12:15], s43 offen lds
    buffer_load_dwordx4 v253, s[12:15], s43 offen offset:1024 lds
    s_add_u32 s43, s53, 196608
    s_sub_u32 s41, s43, 1835008
    s_add_u32 m0, s55, 2048
    s_cmp_ge_u32 s43, s54
    s_cselect_b32 s43, s41, s43
    buffer_load_dwordx4 v252, s[12:15], s43 offen lds
    buffer_load_dwordx4 v253, s[12:15], s43 offen offset:1024 lds
    s_bitcmp1_b32 s44, 0
    s_cbranch_scc1 .Lcv0_odd
    s_branch .Lpage4
.p2alignl 12, 0xbf810000
.Lpage4:
    s_waitcnt vmcnt(5)
    ds_write2_b32 v2, v24, v25 offset0:0 offset1:4
    ds_write2_b32 v2, v26, v27 offset0:8 offset1:12
    s_waitcnt vmcnt(4)
    ds_write2_b32 v2, v28, v29 offset0:128 offset1:132
    ds_write2_b32 v2, v30, v31 offset0:136 offset1:140
    s_waitcnt lgkmcnt(0)
    s_barrier
    ds_read_b64_tr_b16 v[24:25], v4 offset:32
    ds_read_b64_tr_b16 v[26:27], v4 offset:0
    ds_read_b128 v[28:31], v3 offset:384
    ds_read_b128 v[32:35], v3 offset:1408
    ds_read_b128 v[36:39], v3 offset:2944
    ds_read_b128 v[40:43], v3 offset:3968
    ds_read_b64_tr_b16 v[44:45], v4 offset:544
    ds_read_b64_tr_b16 v[46:47], v4 offset:512
    ds_read_b128 v[48:51], v3 offset:896
    ds_read_b128 v[52:55], v3 offset:2432
    ds_read_b128 v[56:59], v3 offset:3456
    s_waitcnt lgkmcnt(8)
    v_mfma_f32_32x32x16_bf16 v[64:79], v[28:31], v[24:27], 0
    s_add_u32 m0, s55, 4096
    s_add_u32 s43, s50, 57344
    ds_read_b64_tr_b16 v[208:209], v4 offset:1056
    ds_read_b64_tr_b16 v[210:211], v4 offset:1024
    s_waitcnt lgkmcnt(9)
    v_mfma_f32_32x32x16_bf16 v[80:95], v[32:35], v[24:27], 0
    buffer_load_dwordx4 v250, s[8:11], s50 offen lds
    ds_read_b128 v[212:215], v3 offset:1920
    s_waitcnt lgkmcnt(9)
    v_mfma_f32_32x32x16_bf16 v[96:111], v[36:39], v[24:27], 0
    buffer_load_dwordx4 v251, s[8:11], s50 offen offset:1024 lds
    s_waitcnt lgkmcnt(8)
    v_mfma_f32_32x32x16_bf16 v[112:127], v[40:43], v[24:27], 0
    s_cmp_eq_u32 s43, s52
    s_cselect_b32 s50, s51, s43
    ds_read_b64_tr_b16 v[216:217], v4 offset:1568
    ds_read_b64_tr_b16 v[218:219], v4 offset:1536
    s_waitcnt lgkmcnt(7)
    v_mfma_f32_32x32x16_bf16 v[80:95], v[48:51], v[44:47], v[80:95]
    s_waitcnt lgkmcnt(6)
    v_mfma_f32_32x32x16_bf16 v[96:111], v[52:55], v[44:47], v[96:111]
    ds_read_b64_tr_b16 v[220:221], v4 offset:2080
    ds_read_b64_tr_b16 v[222:223], v4 offset:2048
    s_waitcnt lgkmcnt(7)
    v_mfma_f32_32x32x16_bf16 v[112:127], v[56:59], v[44:47], v[112:127]
    s_waitcnt lgkmcnt(5)
    v_mfma_f32_32x32x16_bf16 v[80:95], v[28:31], v[208:211], v[80:95]
    s_add_u32 m0, s55, 6144
    s_add_u32 s43, s50, 57344
    ds_read_b64_tr_b16 v[224:225], v4 offset:2592
    ds_read_b64_tr_b16 v[226:227], v4 offset:2560
    s_waitcnt lgkmcnt(6)
    v_mfma_f32_32x32x16_bf16 v[96:111], v[212:215], v[208:211], v[96:111]
    buffer_load_dwordx4 v250, s[8:11], s50 offen lds
    v_mfma_f32_32x32x16_bf16 v[112:127], v[36:39], v[208:211], v[112:127]
    buffer_load_dwordx4 v251, s[8:11], s50 offen offset:1024 lds
    ds_read_b64_tr_b16 v[228:229], v4 offset:3104
    ds_read_b64_tr_b16 v[230:231], v4 offset:3072
    s_waitcnt lgkmcnt(6)
    v_mfma_f32_32x32x16_bf16 v[96:111], v[32:35], v[216:219], v[96:111]
    s_cmp_eq_u32 s43, s52
    s_cselect_b32 s50, s51, s43
    ds_read_b64_tr_b16 v[232:233], v4 offset:3616
    ds_read_b64_tr_b16 v[234:235], v4 offset:3584
    v_mfma_f32_32x32x16_bf16 v[112:127], v[52:55], v[216:219], v[112:127]
    ds_read_b64_tr_b16 v[236:237], v4 offset:160
    ds_read_b64_tr_b16 v[238:239], v4 offset:128
    ds_read_b128 v[240:243], v3 offset:256
    s_waitcnt lgkmcnt(9)
    v_mfma_f32_32x32x16_bf16 v[96:111], v[48:51], v[220:223], v[96:111]
    ds_read_b128 v[244:247], v3 offset:1280
    v_mfma_f32_32x32x16_bf16 v[112:127], v[212:215], v[220:223], v[112:127]
    ds_read_b128 v[24:27], v3 offset:2816
    s_waitcnt lgkmcnt(9)
    v_mfma_f32_32x32x16_bf16 v[96:111], v[28:31], v[224:227], v[96:111]
    s_add_u32 m0, s55, 8192
    s_add_u32 s43, s50, 57344
    ds_read_b128 v[36:39], v3 offset:3840
    v_mfma_f32_32x32x16_bf16 v[112:127], v[32:35], v[224:227], v[112:127]
    buffer_load_dwordx4 v250, s[8:11], s50 offen lds
    ds_read_b64_tr_b16 v[32:33], v4 offset:672
    ds_read_b64_tr_b16 v[34:35], v4 offset:640
    ds_read_b128 v[40:43], v3 offset:768
    s_waitcnt lgkmcnt(11)
    v_mfma_f32_32x32x16_bf16 v[112:127], v[48:51], v[228:231], v[112:127]
    buffer_load_dwordx4 v251, s[8:11], s50 offen offset:1024 lds
    ds_read_b128 v[44:47], v3 offset:2304
    s_waitcnt lgkmcnt(10)
    v_mfma_f32_32x32x16_bf16 v[112:127], v[28:31], v[232:235], v[112:127]
    s_cmp_eq_u32 s43, s52
    s_cselect_b32 s50, s51, s43
    ds_read_b128 v[28:31], v3 offset:3328
    s_waitcnt lgkmcnt(8)
    v_mfma_f32_32x32x16_bf16 v[64:79], v[240:243], v[236:239], v[64:79]
    ds_read_b64_tr_b16 v[48:49], v4 offset:1184
    ds_read_b64_tr_b16 v[50:51], v4 offset:1152
    s_waitcnt lgkmcnt(9)
    v_mfma_f32_32x32x16_bf16 v[80:95], v[244:247], v[236:239], v[80:95]
    ds_read_b128 v[52:55], v3 offset:1792
    s_waitcnt lgkmcnt(9)
    v_mfma_f32_32x32x16_bf16 v[96:111], v[24:27], v[236:239], v[96:111]
    s_waitcnt lgkmcnt(8)
    v_mfma_f32_32x32x16_bf16 v[112:127], v[36:39], v[236:239], v[112:127]
    s_add_u32 m0, s55, 10240
    s_add_u32 s43, s50, 57344
    ds_read_b64_tr_b16 v[56:57], v4 offset:1696
    ds_read_b64_tr_b16 v[58:59], v4 offset:1664
    s_waitcnt lgkmcnt(7)
    v_mfma_f32_32x32x16_bf16 v[80:95], v[40:43], v[32:35], v[80:95]
    buffer_load_dwordx4 v250, s[8:11], s50 offen lds
    s_waitcnt lgkmcnt(6)
    v_mfma_f32_32x32x16_bf16 v[96:111], v[44:47], v[32:35], v[96:111]
    buffer_load_dwordx4 v251, s[8:11], s50 offen offset:1024 lds
    ds_read_b64_tr_b16 v[208:209], v4 offset:2208
    ds_read_b64_tr_b16 v[210:211], v4 offset:2176
    s_waitcnt lgkmcnt(7)
    v_mfma_f32_32x32x16_bf16 v[112:127], v[28:31], v[32:35], v[112:127]
    s_cmp_eq_u32 s43, s52
    s_cselect_b32 s50, s51, s43
    s_waitcnt lgkmcnt(5)
    v_mfma_f32_32x32x16_bf16 v[80:95], v[240:243], v[48:51], v[80:95]
    ds_read_b64_tr_b16 v[212:213], v4 offset:2720
    ds_read_b64_tr_b16 v[214:215], v4 offset:2688
    s_waitcnt lgkmcnt(6)
    v_mfma_f32_32x32x16_bf16 v[96:111], v[52:55], v[48:51], v[96:111]
    v_mfma_f32_32x32x16_bf16 v[112:127], v[24:27], v[48:51], v[112:127]
    ds_read_b64_tr_b16 v[216:217], v4 offset:3232
    ds_read_b64_tr_b16 v[218:219], v4 offset:3200
    s_waitcnt lgkmcnt(6)
    v_mfma_f32_32x32x16_bf16 v[96:111], v[244:247], v[56:59], v[96:111]
    s_add_u32 m0, s55, 12288
    s_add_u32 s43, s50, 57344
    ds_read_b64_tr_b16 v[220:221], v4 offset:3744
    ds_read_b64_tr_b16 v[222:223], v4 offset:3712
    v_mfma_f32_32x32x16_bf16 v[112:127], v[44:47], v[56:59], v[112:127]
    buffer_load_dwordx4 v250, s[8:11], s50 offen lds
    ds_read_b64_tr_b16 v[224:225], v4 offset:288
    ds_read_b64_tr_b16 v[226:227], v4 offset:256
    ds_read_b128 v[228:231], v3 offset:128
    s_waitcnt lgkmcnt(9)
    v_mfma_f32_32x32x16_bf16 v[96:111], v[40:43], v[208:211], v[96:111]
    buffer_load_dwordx4 v251, s[8:11], s50 offen offset:1024 lds
    ds_read_b128 v[232:235], v3 offset:1152
    v_mfma_f32_32x32x16_bf16 v[112:127], v[52:55], v[208:211], v[112:127]
    s_cmp_eq_u32 s43, s52
    s_cselect_b32 s50, s51, s43
    ds_read_b128 v[236:239], v3 offset:2688
    s_waitcnt lgkmcnt(9)
    v_mfma_f32_32x32x16_bf16 v[96:111], v[240:243], v[212:215], v[96:111]
    ds_read_b128 v[24:27], v3 offset:3712
    v_mfma_f32_32x32x16_bf16 v[112:127], v[244:247], v[212:215], v[112:127]
    ds_read_b64_tr_b16 v[244:245], v4 offset:800
    ds_read_b64_tr_b16 v[246:247], v4 offset:768
    ds_read_b128 v[36:39], v3 offset:640
    s_waitcnt lgkmcnt(11)
    v_mfma_f32_32x32x16_bf16 v[112:127], v[40:43], v[216:219], v[112:127]
    ds_read_b128 v[32:35], v3 offset:2176
    s_waitcnt lgkmcnt(10)
    v_mfma_f32_32x32x16_bf16 v[112:127], v[240:243], v[220:223], v[112:127]
    ds_read_b128 v[240:243], v3 offset:3200
    s_waitcnt lgkmcnt(8)
    v_mfma_f32_32x32x16_bf16 v[64:79], v[228:231], v[224:227], v[64:79]
    s_add_u32 m0, s55, 14336
    s_add_u32 s43, s50, 57344
    ds_read_b64_tr_b16 v[40:41], v4 offset:1312
    ds_read_b64_tr_b16 v[42:43], v4 offset:1280
    s_waitcnt lgkmcnt(9)
    v_mfma_f32_32x32x16_bf16 v[80:95], v[232:235], v[224:227], v[80:95]
    buffer_load_dwordx4 v250, s[8:11], s50 offen lds
    ds_read_b128 v[44:47], v3 offset:1664
    s_waitcnt lgkmcnt(9)
    v_mfma_f32_32x32x16_bf16 v[96:111], v[236:239], v[224:227], v[96:111]
    buffer_load_dwordx4 v251, s[8:11], s50 offen offset:1024 lds
    s_waitcnt lgkmcnt(8)
    v_mfma_f32_32x32x16_bf16 v[112:127], v[24:27], v[224:227], v[112:127]
    s_cmp_eq_u32 s43, s52
    s_cselect_b32 s50, s51, s43
    ds_read_b64_tr_b16 v[28:29], v4 offset:1824
    ds_read_b64_tr_b16 v[30:31], v4 offset:1792
    s_waitcnt lgkmcnt(7)
    v_mfma_f32_32x32x16_bf16 v[80:95], v[36:39], v[244:247], v[80:95]
    s_waitcnt lgkmcnt(6)
    v_mfma_f32_32x32x16_bf16 v[96:111], v[32:35], v[244:247], v[96:111]
    ds_read_b64_tr_b16 v[48:49], v4 offset:2336
    ds_read_b64_tr_b16 v[50:51], v4 offset:2304
    s_waitcnt lgkmcnt(7)
    v_mfma_f32_32x32x16_bf16 v[112:127], v[240:243], v[244:247], v[112:127]
    s_waitcnt lgkmcnt(5)
    v_mfma_f32_32x32x16_bf16 v[80:95], v[228:231], v[40:43], v[80:95]
    s_add_u32 m0, s55, 16384
    s_add_u32 s43, s50, 57344
    ds_read_b64_tr_b16 v[52:53], v4 offset:2848
    ds_read_b64_tr_b16 v[54:55], v4 offset:2816
    s_waitcnt lgkmcnt(6)
    v_mfma_f32_32x32x16_bf16 v[96:111], v[44:47], v[40:43], v[96:111]
    buffer_load_dwordx4 v250, s[8:11], s50 offen lds
    v_mfma_f32_32x32x16_bf16 v[112:127], v[236:239], v[40:43], v[112:127]
    buffer_load_dwordx4 v251, s[8:11], s50 offen offset:1024 lds
    ds_read_b64_tr_b16 v[56:57], v4 offset:3360
    ds_read_b64_tr_b16 v[58:59], v4 offset:3328
    s_waitcnt lgkmcnt(6)
    v_mfma_f32_32x32x16_bf16 v[96:111], v[232:235], v[28:31], v[96:111]
    s_cmp_eq_u32 s43, s52
    s_cselect_b32 s50, s51, s43
    ds_read_b64_tr_b16 v[208:209], v4 offset:3872
    ds_read_b64_tr_b16 v[210:211], v4 offset:3840
    v_mfma_f32_32x32x16_bf16 v[112:127], v[32:35], v[28:31], v[112:127]
    ds_read_b64_tr_b16 v[212:213], v4 offset:416
    ds_read_b64_tr_b16 v[214:215], v4 offset:384
    ds_read_b128 v[216:219], v3 offset:0
    s_waitcnt lgkmcnt(9)
    v_mfma_f32_32x32x16_bf16 v[96:111], v[36:39], v[48:51], v[96:111]
    ds_read_b128 v[220:223], v3 offset:1024
    v_mfma_f32_32x32x16_bf16 v[112:127], v[44:47], v[48:51], v[112:127]
    ds_read_b128 v[224:227], v3 offset:2560
    s_waitcnt lgkmcnt(9)
    v_mfma_f32_32x32x16_bf16 v[96:111], v[228:231], v[52:55], v[96:111]
    s_add_u32 m0, s55, 18432
    s_add_u32 s43, s50, 57344
    ds_read_b128 v[236:239], v3 offset:3584
    v_mfma_f32_32x32x16_bf16 v[112:127], v[232:235], v[52:55], v[112:127]
    buffer_load_dwordx4 v250, s[8:11], s50 offen lds
    ds_read_b64_tr_b16 v[232:233], v4 offset:928
    ds_read_b64_tr_b16 v[234:235], v4 offset:896
    ds_read_b128 v[24:27], v3 offset:512
    s_waitcnt lgkmcnt(11)
    v_mfma_f32_32x32x16_bf16 v[112:127], v[36:39], v[56:59], v[112:127]
    buffer_load_dwordx4 v251, s[8:11], s50 offen offset:1024 lds
    ds_read_b128 v[244:247], v3 offset:2048
    s_waitcnt lgkmcnt(10)
    v_mfma_f32_32x32x16_bf16 v[112:127], v[228:231], v[208:211], v[112:127]
    s_cmp_eq_u32 s43, s52
    s_cselect_b32 s50, s51, s43
    ds_read_b128 v[228:231], v3 offset:3072
    s_waitcnt lgkmcnt(8)
    v_mfma_f32_32x32x16_bf16 v[64:79], v[216:219], v[212:215], v[64:79]
    ds_read_b64_tr_b16 v[36:37], v4 offset:1440
    ds_read_b64_tr_b16 v[38:39], v4 offset:1408
    s_waitcnt lgkmcnt(9)
    v_mfma_f32_32x32x16_bf16 v[80:95], v[220:223], v[212:215], v[80:95]
    ds_read_b128 v[32:35], v3 offset:1536
    s_waitcnt lgkmcnt(9)
    v_mfma_f32_32x32x16_bf16 v[96:111], v[224:227], v[212:215], v[96:111]
    s_waitcnt lgkmcnt(8)
    v_mfma_f32_32x32x16_bf16 v[112:127], v[236:239], v[212:215], v[112:127]
    s_add_u32 m0, s55, 20480
    s_add_u32 s43, s50, 57344
    ds_read_b64_tr_b16 v[240:241], v4 offset:1952
    ds_read_b64_tr_b16 v[242:243], v4 offset:1920
    s_waitcnt lgkmcnt(7)
    v_mfma_f32_32x32x16_bf16 v[80:95], v[24:27], v[232:235], v[80:95]
    buffer_load_dwordx4 v250, s[8:11], s50 offen lds
    s_waitcnt lgkmcnt(6)
    v_mfma_f32_32x32x16_bf16 v[96:111], v[244:247], v[232:235], v[96:111]
    buffer_load_dwordx4 v251, s[8:11], s50 offen offset:1024 lds
    ds_read_b64_tr_b16 v[40:41], v4 offset:2464
    ds_read_b64_tr_b16 v[42:43], v4 offset:2432
    s_waitcnt lgkmcnt(7)
    v_mfma_f32_32x32x16_bf16 v[112:127], v[228:231], v[232:235], v[112:127]
    s_cmp_eq_u32 s43, s52
    s_cselect_b32 s50, s51, s43
    s_waitcnt lgkmcnt(5)
    v_mfma_f32_32x32x16_bf16 v[80:95], v[216:219], v[36:39], v[80:95]
    ds_read_b64_tr_b16 v[44:45], v4 offset:2976
    ds_read_b64_tr_b16 v[46:47], v4 offset:2944
    s_waitcnt lgkmcnt(6)
    v_mfma_f32_32x32x16_bf16 v[96:111], v[32:35], v[36:39], v[96:111]
    v_mfma_f32_32x32x16_bf16 v[112:127], v[224:227], v[36:39], v[112:127]
    ds_read_b64_tr_b16 v[28:29], v4 offset:3488
    ds_read_b64_tr_b16 v[30:31], v4 offset:3456
    s_waitcnt lgkmcnt(6)
    v_mfma_f32_32x32x16_bf16 v[96:111], v[220:223], v[240:243], v[96:111]
    s_add_u32 m0, s55, 22528
    s_add_u32 s43, s50, 57344
    ds_read_b64_tr_b16 v[48:49], v4 offset:4000
    ds_read_b64_tr_b16 v[50:51], v4 offset:3968
    v_mfma_f32_32x32x16_bf16 v[112:127], v[244:247], v[240:243], v[112:127]
    buffer_load_dwordx4 v250, s[8:11], s50 offen lds
    s_waitcnt lgkmcnt(6)
    v_mfma_f32_32x32x16_bf16 v[96:111], v[24:27], v[40:43], v[96:111]
    buffer_load_dwordx4 v251, s[8:11], s50 offen offset:1024 lds
    v_mfma_f32_32x32x16_bf16 v[112:127], v[32:35], v[40:43], v[112:127]
    s_cmp_eq_u32 s43, s52
    s_cselect_b32 s50, s51, s43
    s_waitcnt lgkmcnt(4)
    v_mfma_f32_32x32x16_bf16 v[96:111], v[216:219], v[44:47], v[96:111]
    v_mfma_f32_32x32x16_bf16 v[112:127], v[220:223], v[44:47], v[112:127]
    s_waitcnt lgkmcnt(2)
    v_mfma_f32_32x32x16_bf16 v[112:127], v[24:27], v[28:31], v[112:127]
    s_waitcnt lgkmcnt(0)
    v_mfma_f32_32x32x16_bf16 v[112:127], v[216:219], v[48:51], v[112:127]
    v_add_f32_dpp v60, v75, v78 wave_ror:1 row_mask:0xf bank_mask:0xf
    v_add_f32_dpp v61, v71, v74 wave_ror:1 row_mask:0xf bank_mask:0xf
    v_add_f32_dpp v62, v67, v70 wave_ror:1 row_mask:0xf bank_mask:0xf
    v_add_f32_dpp v60, v79, v78 wave_shr:1 row_mask:0xf bank_mask:0xf
    v_add_f32_dpp v61, v75, v74 wave_shr:1 row_mask:0xf bank_mask:0xf
    v_add_f32_dpp v62, v71, v70 wave_shr:1 row_mask:0xf bank_mask:0xf
    v_add_f32_dpp v66, v67, v66 wave_shr:1 row_mask:0xf bank_mask:0xf bound_ctrl:0
    v_add_f32_dpp v78, v61, v77 wave_ror:1 row_mask:0xf bank_mask:0xf
    v_add_f32_dpp v74, v62, v73 wave_ror:1 row_mask:0xf bank_mask:0xf
    v_add_f32_dpp v70, v66, v69 wave_ror:1 row_mask:0xf bank_mask:0xf
    v_add_f32_dpp v78, v60, v77 wave_shr:1 row_mask:0xf bank_mask:0xf
    v_add_f32_dpp v74, v61, v73 wave_shr:1 row_mask:0xf bank_mask:0xf
    v_add_f32_dpp v70, v62, v69 wave_shr:1 row_mask:0xf bank_mask:0xf
    v_add_f32_dpp v65, v66, v65 wave_shr:1 row_mask:0xf bank_mask:0xf bound_ctrl:0
    v_add_f32_dpp v77, v74, v76 wave_ror:1 row_mask:0xf bank_mask:0xf
    v_add_f32_dpp v73, v70, v72 wave_ror:1 row_mask:0xf bank_mask:0xf
    v_add_f32_dpp v69, v65, v68 wave_ror:1 row_mask:0xf bank_mask:0xf
    v_add_f32_dpp v77, v78, v76 wave_shr:1 row_mask:0xf bank_mask:0xf
    v_add_f32_dpp v73, v74, v72 wave_shr:1 row_mask:0xf bank_mask:0xf
    v_add_f32_dpp v69, v70, v68 wave_shr:1 row_mask:0xf bank_mask:0xf
    s_mov_b32 m0, s29
    v_add_f32_dpp v64, v65, v64 wave_shr:1 row_mask:0xf bank_mask:0xf bound_ctrl:0
    ds_write_addtid_b32 v79 offset:26076
    ds_write_addtid_b32 v60 offset:26072
    ds_write_addtid_b32 v78 offset:26068
    ds_write_addtid_b32 v77 offset:18368
    ds_write_addtid_b32 v73 offset:18112
    ds_write_addtid_b32 v69 offset:17856
    ds_write_addtid_b32 v64 offset:17600
    v_add_f32_dpp v60, v91, v94 wave_ror:1 row_mask:0xf bank_mask:0xf
    v_add_f32_dpp v61, v87, v90 wave_ror:1 row_mask:0xf bank_mask:0xf
    v_add_f32_dpp v62, v83, v86 wave_ror:1 row_mask:0xf bank_mask:0xf
    v_add_f32_dpp v60, v95, v94 wave_shr:1 row_mask:0xf bank_mask:0xf
    v_add_f32_dpp v61, v91, v90 wave_shr:1 row_mask:0xf bank_mask:0xf
    v_add_f32_dpp v62, v87, v86 wave_shr:1 row_mask:0xf bank_mask:0xf
    v_add_f32_dpp v82, v83, v82 wave_shr:1 row_mask:0xf bank_mask:0xf bound_ctrl:0
    v_add_f32_dpp v94, v61, v93 wave_ror:1 row_mask:0xf bank_mask:0xf
    v_add_f32_dpp v90, v62, v89 wave_ror:1 row_mask:0xf bank_mask:0xf
    v_add_f32_dpp v86, v82, v85 wave_ror:1 row_mask:0xf bank_mask:0xf
    v_add_f32_dpp v94, v60, v93 wave_shr:1 row_mask:0xf bank_mask:0xf
    v_add_f32_dpp v90, v61, v89 wave_shr:1 row_mask:0xf bank_mask:0xf
    v_add_f32_dpp v86, v62, v85 wave_shr:1 row_mask:0xf bank_mask:0xf
    v_add_f32_dpp v81, v82, v81 wave_shr:1 row_mask:0xf bank_mask:0xf bound_ctrl:0
    v_add_f32_dpp v93, v90, v92 wave_ror:1 row_mask:0xf bank_mask:0xf
    v_add_f32_dpp v89, v86, v88 wave_ror:1 row_mask:0xf bank_mask:0xf
    v_add_f32_dpp v85, v81, v84 wave_ror:1 row_mask:0xf bank_mask:0xf
    v_add_f32_dpp v93, v94, v92 wave_shr:1 row_mask:0xf bank_mask:0xf
    v_add_f32_dpp v89, v90, v88 wave_shr:1 row_mask:0xf bank_mask:0xf
    v_add_f32_dpp v85, v86, v84 wave_shr:1 row_mask:0xf bank_mask:0xf
    v_add_f32_dpp v80, v81, v80 wave_shr:1 row_mask:0xf bank_mask:0xf bound_ctrl:0
    ds_write_addtid_b32 v95 offset:26620
    ds_write_addtid_b32 v60 offset:26616
    ds_write_addtid_b32 v94 offset:26612
    ds_write_addtid_b32 v93 offset:20416
    ds_write_addtid_b32 v89 offset:20160
    ds_write_addtid_b32 v85 offset:19904
    ds_write_addtid_b32 v80 offset:19648
    v_add_f32_dpp v60, v107, v110 wave_ror:1 row_mask:0xf bank_mask:0xf
    v_add_f32_dpp v61, v103, v106 wave_ror:1 row_mask:0xf bank_mask:0xf
    v_add_f32_dpp v62, v99, v102 wave_ror:1 row_mask:0xf bank_mask:0xf
    v_add_f32_dpp v60, v111, v110 wave_shr:1 row_mask:0xf bank_mask:0xf
    v_add_f32_dpp v61, v107, v106 wave_shr:1 row_mask:0xf bank_mask:0xf
    v_add_f32_dpp v62, v103, v102 wave_shr:1 row_mask:0xf bank_mask:0xf
    v_add_f32_dpp v98, v99, v98 wave_shr:1 row_mask:0xf bank_mask:0xf bound_ctrl:0
    v_add_f32_dpp v110, v61, v109 wave_ror:1 row_mask:0xf bank_mask:0xf
    v_add_f32_dpp v106, v62, v105 wave_ror:1 row_mask:0xf bank_mask:0xf
    v_add_f32_dpp v102, v98, v101 wave_ror:1 row_mask:0xf bank_mask:0xf
    v_add_f32_dpp v110, v60, v109 wave_shr:1 row_mask:0xf bank_mask:0xf
    v_add_f32_dpp v106, v61, v105 wave_shr:1 row_mask:0xf bank_mask:0xf
    v_add_f32_dpp v102, v62, v101 wave_shr:1 row_mask:0xf bank_mask:0xf
    v_add_f32_dpp v97, v98, v97 wave_shr:1 row_mask:0xf bank_mask:0xf bound_ctrl:0
    v_add_f32_dpp v109, v106, v108 wave_ror:1 row_mask:0xf bank_mask:0xf
    v_add_f32_dpp v105, v102, v104 wave_ror:1 row_mask:0xf bank_mask:0xf
    v_add_f32_dpp v101, v97, v100 wave_ror:1 row_mask:0xf bank_mask:0xf
    v_add_f32_dpp v109, v110, v108 wave_shr:1 row_mask:0xf bank_mask:0xf
    v_add_f32_dpp v105, v106, v104 wave_shr:1 row_mask:0xf bank_mask:0xf
    v_add_f32_dpp v101, v102, v100 wave_shr:1 row_mask:0xf bank_mask:0xf
    v_add_f32_dpp v96, v97, v96 wave_shr:1 row_mask:0xf bank_mask:0xf bound_ctrl:0
    ds_write_addtid_b32 v111 offset:27436
    ds_write_addtid_b32 v60 offset:27432
    ds_write_addtid_b32 v110 offset:27428
    ds_write_addtid_b32 v109 offset:23488
    ds_write_addtid_b32 v105 offset:23232
    ds_write_addtid_b32 v101 offset:22976
    ds_write_addtid_b32 v96 offset:22720
    v_add_f32_dpp v60, v123, v126 wave_ror:1 row_mask:0xf bank_mask:0xf
    v_add_f32_dpp v61, v119, v122 wave_ror:1 row_mask:0xf bank_mask:0xf
    v_add_f32_dpp v62, v115, v118 wave_ror:1 row_mask:0xf bank_mask:0xf
    v_add_f32_dpp v60, v127, v126 wave_shr:1 row_mask:0xf bank_mask:0xf
    v_add_f32_dpp v61, v123, v122 wave_shr:1 row_mask:0xf bank_mask:0xf
    v_add_f32_dpp v62, v119, v118 wave_shr:1 row_mask:0xf bank_mask:0xf
    v_add_f32_dpp v114, v115, v114 wave_shr:1 row_mask:0xf bank_mask:0xf bound_ctrl:0
    v_add_f32_dpp v126, v61, v125 wave_ror:1 row_mask:0xf bank_mask:0xf
    v_add_f32_dpp v122, v62, v121 wave_ror:1 row_mask:0xf bank_mask:0xf
    v_add_f32_dpp v118, v114, v117 wave_ror:1 row_mask:0xf bank_mask:0xf
    v_add_f32_dpp v126, v60, v125 wave_shr:1 row_mask:0xf bank_mask:0xf
    v_add_f32_dpp v122, v61, v121 wave_shr:1 row_mask:0xf bank_mask:0xf
    v_add_f32_dpp v118, v62, v117 wave_shr:1 row_mask:0xf bank_mask:0xf
    v_add_f32_dpp v113, v114, v113 wave_shr:1 row_mask:0xf bank_mask:0xf bound_ctrl:0
    v_add_f32_dpp v125, v122, v124 wave_ror:1 row_mask:0xf bank_mask:0xf
    v_add_f32_dpp v121, v118, v120 wave_ror:1 row_mask:0xf bank_mask:0xf
    v_add_f32_dpp v117, v113, v116 wave_ror:1 row_mask:0xf bank_mask:0xf
    v_add_f32_dpp v125, v126, v124 wave_shr:1 row_mask:0xf bank_mask:0xf
    v_add_f32_dpp v121, v122, v120 wave_shr:1 row_mask:0xf bank_mask:0xf
    v_add_f32_dpp v117, v118, v116 wave_shr:1 row_mask:0xf bank_mask:0xf
    v_add_f32_dpp v112, v113, v112 wave_shr:1 row_mask:0xf bank_mask:0xf bound_ctrl:0
    ds_write_addtid_b32 v125 offset:25536
    ds_write_addtid_b32 v121 offset:25280
    ds_write_addtid_b32 v117 offset:25024
    ds_write_addtid_b32 v112 offset:24768
    s_waitcnt lgkmcnt(0)
    s_barrier
    ds_read_b128 v[24:27], v5 offset:0
    ds_read_b128 v[28:31], v5 offset:16
    ds_read_b128 v[32:35], v6 offset:0
    ds_read_b128 v[36:39], v5 offset:1024
    ds_read_b128 v[40:43], v5 offset:1040
    ds_read_b128 v[44:47], v6 offset:272
    s_waitcnt lgkmcnt(3)
    s_mov_b64 exec, 5
    v_pk_add_f32 v[24:25], v[24:25], v[32:33]
    v_add_f32 v26, v26, v34
    s_mov_b64 exec, -1
    v_cvt_pk_bf16_f32 v48, v24, v25
    v_cvt_pk_bf16_f32 v49, v26, v27
    v_cvt_pk_bf16_f32 v50, v28, v29
    v_cvt_pk_bf16_f32 v51, v30, v31
    buffer_store_dwordx4 v[48:51], v7, s[4:7], s22 offen sc1
    s_waitcnt lgkmcnt(0)
    s_mov_b64 exec, 5
    v_pk_add_f32 v[36:37], v[36:37], v[44:45]
    v_add_f32 v38, v38, v46
    s_mov_b64 exec, -1
    v_cvt_pk_bf16_f32 v52, v36, v37
    v_cvt_pk_bf16_f32 v53, v38, v39
    v_cvt_pk_bf16_f32 v54, v40, v41
    v_cvt_pk_bf16_f32 v55, v42, v43
    buffer_store_dwordx4 v[52:55], v7, s[4:7], s23 offen sc1
    v_mbcnt_lo_u32_b32 v24, -1, 0
    v_mbcnt_hi_u32_b32 v24, -1, v24
    v_lshlrev_b32 v24, 10, v24
    v_mov_b32 v25, s47
    s_waitcnt vmcnt(24)
    ds_read_b64_tr_b16 v[144:145], v254 offset:0
    ds_read_b64_tr_b16 v[146:147], v254 offset:512
    ds_read_b64_tr_b16 v[148:149], v255 offset:0
    ds_read_b64_tr_b16 v[150:151], v255 offset:512
    s_waitcnt vmcnt(22)
    ds_read_b64_tr_b16 v[152:153], v254 offset:2048
    ds_read_b64_tr_b16 v[154:155], v254 offset:2560
    ds_read_b64_tr_b16 v[156:157], v255 offset:2048
    ds_read_b64_tr_b16 v[158:159], v255 offset:2560
    s_waitcnt vmcnt(20)
    ds_read_b64_tr_b16 a[80:81], v254 offset:4096
    ds_read_b64_tr_b16 a[82:83], v254 offset:4608
    ds_read_b64_tr_b16 a[84:85], v255 offset:4096
    ds_read_b64_tr_b16 a[86:87], v255 offset:4608
    s_waitcnt vmcnt(18)
    ds_read_b64_tr_b16 a[88:89], v254 offset:6144
    ds_read_b64_tr_b16 a[90:91], v254 offset:6656
    ds_read_b64_tr_b16 a[92:93], v255 offset:6144
    ds_read_b64_tr_b16 a[94:95], v255 offset:6656
    s_waitcnt vmcnt(16)
    ds_read_b64_tr_b16 a[96:97], v254 offset:8192
    ds_read_b64_tr_b16 a[98:99], v254 offset:8704
    ds_read_b64_tr_b16 a[100:101], v255 offset:8192
    ds_read_b64_tr_b16 a[102:103], v255 offset:8704
    s_waitcnt vmcnt(14)
    ds_read_b64_tr_b16 a[104:105], v254 offset:10240
    ds_read_b64_tr_b16 a[106:107], v254 offset:10752
    ds_read_b64_tr_b16 a[108:109], v255 offset:10240
    ds_read_b64_tr_b16 a[110:111], v255 offset:10752
    s_waitcnt vmcnt(12)
    ds_read_b64_tr_b16 a[112:113], v254 offset:12288
    ds_read_b64_tr_b16 a[114:115], v254 offset:12800
    ds_read_b64_tr_b16 a[116:117], v255 offset:12288
    ds_read_b64_tr_b16 a[118:119], v255 offset:12800
    s_waitcnt vmcnt(10)
    ds_read_b64_tr_b16 a[120:121], v254 offset:14336
    ds_read_b64_tr_b16 a[122:123], v254 offset:14848
    ds_read_b64_tr_b16 a[124:125], v255 offset:14336
    ds_read_b64_tr_b16 a[126:127], v255 offset:14848
    s_waitcnt vmcnt(8)
    ds_read_b64_tr_b16 a[128:129], v254 offset:16384
    ds_read_b64_tr_b16 a[130:131], v254 offset:16896
    ds_read_b64_tr_b16 a[132:133], v255 offset:16384
    ds_read_b64_tr_b16 a[134:135], v255 offset:16896
    s_waitcnt vmcnt(6)
    ds_read_b64_tr_b16 a[136:137], v254 offset:18432
    ds_read_b64_tr_b16 a[138:139], v254 offset:18944
    ds_read_b64_tr_b16 a[140:141], v255 offset:18432
    ds_read_b64_tr_b16 a[142:143], v255 offset:18944
    s_waitcnt vmcnt(4)
    ds_read_b64_tr_b16 a[144:145], v254 offset:20480
    ds_read_b64_tr_b16 a[146:147], v254 offset:20992
    ds_read_b64_tr_b16 a[148:149], v255 offset:20480
    ds_read_b64_tr_b16 a[150:151], v255 offset:20992
    s_waitcnt vmcnt(2)
    ds_read_b64_tr_b16 a[152:153], v254 offset:22528
    ds_read_b64_tr_b16 a[154:155], v254 offset:23040
    ds_read_b64_tr_b16 a[156:157], v255 offset:22528
    ds_read_b64_tr_b16 a[158:159], v255 offset:23040
    s_waitcnt lgkmcnt(15)
    s_add_u32 m0, s55, 0
    s_add_u32 s43, s50, 57344
    buffer_load_dwordx4 v250, s[8:11], s50 offen lds
    buffer_load_dwordx4 v251, s[8:11], s50 offen offset:1024 lds
    s_cmp_eq_u32 s43, s52
    s_cselect_b32 s50, s51, s43
    s_add_u32 s43, s53, 262144
    s_sub_u32 s41, s43, 1835008
    s_add_u32 m0, s55, 2048
    s_cmp_ge_u32 s43, s54
    s_cselect_b32 s43, s41, s43
    buffer_load_dwordx4 v252, s[12:15], s43 offen lds
    buffer_load_dwordx4 v253, s[12:15], s43 offen offset:1024 lds
    s_waitcnt vmcnt(4)
    s_mov_b64 exec, 0xff
    buffer_store_dword v25, v24, s[4:7], s56 offen sc1
    s_mov_b64 exec, -1
    s_add_u32 s56, s56, 16
    s_waitcnt lgkmcnt(0)
    s_branch .Lcv0_join
.p2alignl 12, 0xbf810000
.Lpage6:
.Lcv0_odd:
    s_waitcnt vmcnt(5)
    ds_write2_b32 v2, v24, v25 offset0:0 offset1:4
    ds_write2_b32 v2, v26, v27 offset0:8 offset1:12
    s_waitcnt vmcnt(4)
    ds_write2_b32 v2, v28, v29 offset0:128 offset1:132
    ds_write2_b32 v2, v30, v31 offset0:136 offset1:140
    s_waitcnt lgkmcnt(0)
    s_barrier
    ds_read_b64_tr_b16 v[24:25], v4 offset:32
    ds_read_b64_tr_b16 v[26:27], v4 offset:0
    ds_read_b128 v[28:31], v3 offset:896
    ds_read_b128 v[32:35], v3 offset:1920
    ds_read_b128 v[36:39], v3 offset:2432
    ds_read_b128 v[40:43], v3 offset:3456
    ds_read_b64_tr_b16 v[44:45], v4 offset:544
    ds_read_b64_tr_b16 v[46:47], v4 offset:512
    ds_read_b128 v[48:51], v3 offset:384
    ds_read_b128 v[52:55], v3 offset:1408
    s_waitcnt lgkmcnt(7)
    v_mfma_f32_32x32x16_bf16 v[64:79], v[28:31], v[24:27], 0
    s_add_u32 m0, s55, 4096
    s_add_u32 s43, s50, 57344
    ds_read_b128 v[56:59], v3 offset:2944
    s_waitcnt lgkmcnt(7)
    v_mfma_f32_32x32x16_bf16 v[80:95], v[32:35], v[24:27], 0
    buffer_load_dwordx4 v250, s[8:11], s50 offen lds
    ds_read_b64_tr_b16 v[208:209], v4 offset:1056
    ds_read_b64_tr_b16 v[210:211], v4 offset:1024
    s_waitcnt lgkmcnt(8)
    v_mfma_f32_32x32x16_bf16 v[96:111], v[36:39], v[24:27], 0
    buffer_load_dwordx4 v251, s[8:11], s50 offen offset:1024 lds
    s_waitcnt lgkmcnt(7)
    v_mfma_f32_32x32x16_bf16 v[112:127], v[40:43], v[24:27], 0
    s_cmp_eq_u32 s43, s52
    s_cselect_b32 s50, s51, s43
    s_waitcnt lgkmcnt(4)
    v_mfma_f32_32x32x16_bf16 v[64:79], v[48:51], v[44:47], v[64:79]
    ds_read_b64_tr_b16 v[212:213], v4 offset:1568
    ds_read_b64_tr_b16 v[214:215], v4 offset:1536
    s_waitcnt lgkmcnt(5)
    v_mfma_f32_32x32x16_bf16 v[80:95], v[52:55], v[44:47], v[80:95]
    v_mfma_f32_32x32x16_bf16 v[96:111], v[32:35], v[44:47], v[96:111]
    s_waitcnt lgkmcnt(4)
    v_mfma_f32_32x32x16_bf16 v[112:127], v[56:59], v[44:47], v[112:127]
    s_add_u32 m0, s55, 6144
    s_add_u32 s43, s50, 57344
    ds_read_b64_tr_b16 v[216:217], v4 offset:2080
    ds_read_b64_tr_b16 v[218:219], v4 offset:2048
    s_waitcnt lgkmcnt(4)
    v_mfma_f32_32x32x16_bf16 v[80:95], v[28:31], v[208:211], v[80:95]
    buffer_load_dwordx4 v250, s[8:11], s50 offen lds
    v_mfma_f32_32x32x16_bf16 v[96:111], v[52:55], v[208:211], v[96:111]
    buffer_load_dwordx4 v251, s[8:11], s50 offen offset:1024 lds
    ds_read_b64_tr_b16 v[220:221], v4 offset:2592
    ds_read_b64_tr_b16 v[222:223], v4 offset:2560
    v_mfma_f32_32x32x16_bf16 v[112:127], v[36:39], v[208:211], v[112:127]
    s_cmp_eq_u32 s43, s52
    s_cselect_b32 s50, s51, s43
    ds_read_b64_tr_b16 v[224:225], v4 offset:3104
    ds_read_b64_tr_b16 v[226:227], v4 offset:3072
    s_waitcnt lgkmcnt(6)
    v_mfma_f32_32x32x16_bf16 v[80:95], v[48:51], v[212:215], v[80:95]
    ds_read_b64_tr_b16 v[228:229], v4 offset:160
    ds_read_b64_tr_b16 v[230:231], v4 offset:128
    ds_read_b128 v[232:235], v3 offset:768
    v_mfma_f32_32x32x16_bf16 v[96:111], v[28:31], v[212:215], v[96:111]
    ds_read_b128 v[236:239], v3 offset:1792
    v_mfma_f32_32x32x16_bf16 v[112:127], v[32:35], v[212:215], v[112:127]
    ds_read_b128 v[240:243], v3 offset:2304
    s_waitcnt lgkmcnt(9)
    v_mfma_f32_32x32x16_bf16 v[96:111], v[48:51], v[216:219], v[96:111]
    s_add_u32 m0, s55, 8192
    s_add_u32 s43, s50, 57344
    ds_read_b128 v[244:247], v3 offset:3328
    v_mfma_f32_32x32x16_bf16 v[112:127], v[52:55], v[216:219], v[112:127]
    buffer_load_dwordx4 v250, s[8:11], s50 offen lds
    ds_read_b64_tr_b16 v[24:25], v4 offset:672
    ds_read_b64_tr_b16 v[26:27], v4 offset:640
    ds_read_b128 v[32:35], v3 offset:256
    s_waitcnt lgkmcnt(11)
    v_mfma_f32_32x32x16_bf16 v[112:127], v[28:31], v[220:223], v[112:127]
    buffer_load_dwordx4 v251, s[8:11], s50 offen offset:1024 lds
    ds_read_b128 v[28:31], v3 offset:1280
    s_waitcnt lgkmcnt(10)
    v_mfma_f32_32x32x16_bf16 v[112:127], v[48:51], v[224:227], v[112:127]
    s_cmp_eq_u32 s43, s52
    s_cselect_b32 s50, s51, s43
    s_waitcnt lgkmcnt(7)
    v_mfma_f32_32x32x16_bf16 v[64:79], v[232:235], v[228:231], v[64:79]
    ds_read_b128 v[36:39], v3 offset:2816
    s_waitcnt lgkmcnt(7)
    v_mfma_f32_32x32x16_bf16 v[80:95], v[236:239], v[228:231], v[80:95]
    ds_read_b64_tr_b16 v[40:41], v4 offset:1184
    ds_read_b64_tr_b16 v[42:43], v4 offset:1152
    s_waitcnt lgkmcnt(8)
    v_mfma_f32_32x32x16_bf16 v[96:111], v[240:243], v[228:231], v[96:111]
    s_waitcnt lgkmcnt(7)
    v_mfma_f32_32x32x16_bf16 v[112:127], v[244:247], v[228:231], v[112:127]
    s_add_u32 m0, s55, 10240
    s_add_u32 s43, s50, 57344
    s_waitcnt lgkmcnt(4)
    v_mfma_f32_32x32x16_bf16 v[64:79], v[32:35], v[24:27], v[64:79]
    buffer_load_dwordx4 v250, s[8:11], s50 offen lds
    ds_read_b64_tr_b16 v[44:45], v4 offset:1696
    ds_read_b64_tr_b16 v[46:47], v4 offset:1664
    s_waitcnt lgkmcnt(5)
    v_mfma_f32_32x32x16_bf16 v[80:95], v[28:31], v[24:27], v[80:95]
    buffer_load_dwordx4 v251, s[8:11], s50 offen offset:1024 lds
    v_mfma_f32_32x32x16_bf16 v[96:111], v[236:239], v[24:27], v[96:111]
    s_cmp_eq_u32 s43, s52
    s_cselect_b32 s50, s51, s43
    s_waitcnt lgkmcnt(4)
    v_mfma_f32_32x32x16_bf16 v[112:127], v[36:39], v[24:27], v[112:127]
    ds_read_b64_tr_b16 v[48:49], v4 offset:2208
    ds_read_b64_tr_b16 v[50:51], v4 offset:2176
    s_waitcnt lgkmcnt(4)
    v_mfma_f32_32x32x16_bf16 v[80:95], v[232:235], v[40:43], v[80:95]
    v_mfma_f32_32x32x16_bf16 v[96:111], v[28:31], v[40:43], v[96:111]
    ds_read_b64_tr_b16 v[52:53], v4 offset:2720
    ds_read_b64_tr_b16 v[54:55], v4 offset:2688
    v_mfma_f32_32x32x16_bf16 v[112:127], v[240:243], v[40:43], v[112:127]
    s_add_u32 m0, s55, 12288
    s_add_u32 s43, s50, 57344
    ds_read_b64_tr_b16 v[56:57], v4 offset:3232
    ds_read_b64_tr_b16 v[58:59], v4 offset:3200
    s_waitcnt lgkmcnt(6)
    v_mfma_f32_32x32x16_bf16 v[80:95], v[32:35], v[44:47], v[80:95]
    buffer_load_dwordx4 v250, s[8:11], s50 offen lds
    ds_read_b64_tr_b16 v[208:209], v4 offset:288
    ds_read_b64_tr_b16 v[210:211], v4 offset:256
    ds_read_b128 v[212:215], v3 offset:640
    v_mfma_f32_32x32x16_bf16 v[96:111], v[232:235], v[44:47], v[96:111]
    buffer_load_dwordx4 v251, s[8:11], s50 offen offset:1024 lds
    ds_read_b128 v[216:219], v3 offset:1664
    v_mfma_f32_32x32x16_bf16 v[112:127], v[236:239], v[44:47], v[112:127]
    s_cmp_eq_u32 s43, s52
    s_cselect_b32 s50, s51, s43
    ds_read_b128 v[220:223], v3 offset:2176
    s_waitcnt lgkmcnt(9)
    v_mfma_f32_32x32x16_bf16 v[96:111], v[32:35], v[48:51], v[96:111]
    ds_read_b128 v[224:227], v3 offset:3200
    v_mfma_f32_32x32x16_bf16 v[112:127], v[28:31], v[48:51], v[112:127]
    ds_read_b64_tr_b16 v[228:229], v4 offset:800
    ds_read_b64_tr_b16 v[230:231], v4 offset:768
    ds_read_b128 v[236:239], v3 offset:128
    s_waitcnt lgkmcnt(11)
    v_mfma_f32_32x32x16_bf16 v[112:127], v[232:235], v[52:55], v[112:127]
    ds_read_b128 v[232:235], v3 offset:1152
    s_waitcnt lgkmcnt(10)
    v_mfma_f32_32x32x16_bf16 v[112:127], v[32:35], v[56:59], v[112:127]
    s_waitcnt lgkmcnt(7)
    v_mfma_f32_32x32x16_bf16 v[64:79], v[212:215], v[208:211], v[64:79]
    s_add_u32 m0, s55, 14336
    s_add_u32 s43, s50, 57344
    ds_read_b128 v[240:243], v3 offset:2688
    s_waitcnt lgkmcnt(7)
    v_mfma_f32_32x32x16_bf16 v[80:95], v[216:219], v[208:211], v[80:95]
    buffer_load_dwordx4 v250, s[8:11], s50 offen lds
    ds_read_b64_tr_b16 v[244:245], v4 offset:1312
    ds_read_b64_tr_b16 v[246:247], v4 offset:1280
    s_waitcnt lgkmcnt(8)
    v_mfma_f32_32x32x16_bf16 v[96:111], v[220:223], v[208:211], v[96:111]
    buffer_load_dwordx4 v251, s[8:11], s50 offen offset:1024 lds
    s_waitcnt lgkmcnt(7)
    v_mfma_f32_32x32x16_bf16 v[112:127], v[224:227], v[208:211], v[112:127]
    s_cmp_eq_u32 s43, s52
    s_cselect_b32 s50, s51, s43
    s_waitcnt lgkmcnt(4)
    v_mfma_f32_32x32x16_bf16 v[64:79], v[236:239], v[228:231], v[64:79]
    ds_read_b64_tr_b16 v[24:25], v4 offset:1824
    ds_read_b64_tr_b16 v[26:27], v4 offset:1792
    s_waitcnt lgkmcnt(5)
    v_mfma_f32_32x32x16_bf16 v[80:95], v[232:235], v[228:231], v[80:95]
    v_mfma_f32_32x32x16_bf16 v[96:111], v[216:219], v[228:231], v[96:111]
    s_waitcnt lgkmcnt(4)
    v_mfma_f32_32x32x16_bf16 v[112:127], v[240:243], v[228:231], v[112:127]
    s_add_u32 m0, s55, 16384
    s_add_u32 s43, s50, 57344
    ds_read_b64_tr_b16 v[32:33], v4 offset:2336
    ds_read_b64_tr_b16 v[34:35], v4 offset:2304
    s_waitcnt lgkmcnt(4)
    v_mfma_f32_32x32x16_bf16 v[80:95], v[212:215], v[244:247], v[80:95]
    buffer_load_dwordx4 v250, s[8:11], s50 offen lds
    v_mfma_f32_32x32x16_bf16 v[96:111], v[232:235], v[244:247], v[96:111]
    buffer_load_dwordx4 v251, s[8:11], s50 offen offset:1024 lds
    ds_read_b64_tr_b16 v[28:29], v4 offset:2848
    ds_read_b64_tr_b16 v[30:31], v4 offset:2816
    v_mfma_f32_32x32x16_bf16 v[112:127], v[220:223], v[244:247], v[112:127]
    s_cmp_eq_u32 s43, s52
    s_cselect_b32 s50, s51, s43
    ds_read_b64_tr_b16 v[36:37], v4 offset:3360
    ds_read_b64_tr_b16 v[38:39], v4 offset:3328
    s_waitcnt lgkmcnt(6)
    v_mfma_f32_32x32x16_bf16 v[80:95], v[236:239], v[24:27], v[80:95]
    ds_read_b64_tr_b16 v[40:41], v4 offset:416
    ds_read_b64_tr_b16 v[42:43], v4 offset:384
    ds_read_b128 v[44:47], v3 offset:512
    v_mfma_f32_32x32x16_bf16 v[96:111], v[212:215], v[24:27], v[96:111]
    ds_read_b128 v[48:51], v3 offset:1536
    v_mfma_f32_32x32x16_bf16 v[112:127], v[216:219], v[24:27], v[112:127]
    ds_read_b128 v[52:55], v3 offset:2048
    s_waitcnt lgkmcnt(9)
    v_mfma_f32_32x32x16_bf16 v[96:111], v[236:239], v[32:35], v[96:111]
    s_add_u32 m0, s55, 18432
    s_add_u32 s43, s50, 57344
    ds_read_b128 v[56:59], v3 offset:3072
    v_mfma_f32_32x32x16_bf16 v[112:127], v[232:235], v[32:35], v[112:127]
    buffer_load_dwordx4 v250, s[8:11], s50 offen lds
    ds_read_b64_tr_b16 v[208:209], v4 offset:928
    ds_read_b64_tr_b16 v[210:211], v4 offset:896
    ds_read_b128 v[216:219], v3 offset:0
    s_waitcnt lgkmcnt(11)
    v_mfma_f32_32x32x16_bf16 v[112:127], v[212:215], v[28:31], v[112:127]
    buffer_load_dwordx4 v251, s[8:11], s50 offen offset:1024 lds
    ds_read_b128 v[212:215], v3 offset:1024
    s_waitcnt lgkmcnt(10)
    v_mfma_f32_32x32x16_bf16 v[112:127], v[236:239], v[36:39], v[112:127]
    s_cmp_eq_u32 s43, s52
    s_cselect_b32 s50, s51, s43
    s_waitcnt lgkmcnt(7)
    v_mfma_f32_32x32x16_bf16 v[64:79], v[44:47], v[40:43], v[64:79]
    ds_read_b128 v[220:223], v3 offset:2560
    s_waitcnt lgkmcnt(7)
    v_mfma_f32_32x32x16_bf16 v[80:95], v[48:51], v[40:43], v[80:95]
    ds_read_b64_tr_b16 v[224:225], v4 offset:1440
    ds_read_b64_tr_b16 v[226:227], v4 offset:1408
    s_waitcnt lgkmcnt(8)
    v_mfma_f32_32x32x16_bf16 v[96:111], v[52:55], v[40:43], v[96:111]
    s_waitcnt lgkmcnt(7)
    v_mfma_f32_32x32x16_bf16 v[112:127], v[56:59], v[40:43], v[112:127]
    s_add_u32 m0, s55, 20480
    s_add_u32 s43, s50, 57344
    s_waitcnt lgkmcnt(4)
    v_mfma_f32_32x32x16_bf16 v[64:79], v[216:219], v[208:211], v[64:79]
    buffer_load_dwordx4 v250, s[8:11], s50 offen lds
    ds_read_b64_tr_b16 v[228:229], v4 offset:1952
    ds_read_b64_tr_b16 v[230:231], v4 offset:1920
    s_waitcnt lgkmcnt(5)
    v_mfma_f32_32x32x16_bf16 v[80:95], v[212:215], v[208:211], v[80:95]
    buffer_load_dwordx4 v251, s[8:11], s50 offen offset:1024 lds
    v_mfma_f32_32x32x16_bf16 v[96:111], v[48:51], v[208:211], v[96:111]
    s_cmp_eq_u32 s43, s52
    s_cselect_b32 s50, s51, s43
    s_waitcnt lgkmcnt(4)
    v_mfma_f32_32x32x16_bf16 v[112:127], v[220:223], v[208:211], v[112:127]
    ds_read_b64_tr_b16 v[236:237], v4 offset:2464
    ds_read_b64_tr_b16 v[238:239], v4 offset:2432
    s_waitcnt lgkmcnt(4)
    v_mfma_f32_32x32x16_bf16 v[80:95], v[44:47], v[224:227], v[80:95]
    v_mfma_f32_32x32x16_bf16 v[96:111], v[212:215], v[224:227], v[96:111]
    ds_read_b64_tr_b16 v[232:233], v4 offset:2976
    ds_read_b64_tr_b16 v[234:235], v4 offset:2944
    v_mfma_f32_32x32x16_bf16 v[112:127], v[52:55], v[224:227], v[112:127]
    s_add_u32 m0, s55, 22528
    s_add_u32 s43, s50, 57344
    ds_read_b64_tr_b16 v[240:241], v4 offset:3488
    ds_read_b64_tr_b16 v[242:243], v4 offset:3456
    s_waitcnt lgkmcnt(6)
    v_mfma_f32_32x32x16_bf16 v[80:95], v[216:219], v[228:231], v[80:95]
    buffer_load_dwordx4 v250, s[8:11], s50 offen lds
    v_mfma_f32_32x32x16_bf16 v[96:111], v[44:47], v[228:231], v[96:111]
    buffer_load_dwordx4 v251, s[8:11], s50 offen offset:1024 lds
    v_mfma_f32_32x32x16_bf16 v[112:127], v[48:51], v[228:231], v[112:127]
    s_cmp_eq_u32 s43, s52
    s_cselect_b32 s50, s51, s43
    s_waitcnt lgkmcnt(4)
    v_mfma_f32_32x32x16_bf16 v[96:111], v[216:219], v[236:239], v[96:111]
    v_mfma_f32_32x32x16_bf16 v[112:127], v[212:215], v[236:239], v[112:127]
    s_waitcnt lgkmcnt(2)
    v_mfma_f32_32x32x16_bf16 v[112:127], v[44:47], v[232:235], v[112:127]
    s_waitcnt lgkmcnt(0)
    v_mfma_f32_32x32x16_bf16 v[112:127], v[216:219], v[240:243], v[112:127]
    v_add_f32_dpp v60, v75, v78 wave_ror:1 row_mask:0xf bank_mask:0xf
    v_add_f32_dpp v61, v71, v74 wave_ror:1 row_mask:0xf bank_mask:0xf
    v_add_f32_dpp v62, v67, v70 wave_ror:1 row_mask:0xf bank_mask:0xf
    v_add_f32_dpp v60, v79, v78 wave_shr:1 row_mask:0xf bank_mask:0xf
    v_add_f32_dpp v61, v75, v74 wave_shr:1 row_mask:0xf bank_mask:0xf
    v_add_f32_dpp v62, v71, v70 wave_shr:1 row_mask:0xf bank_mask:0xf
    v_add_f32_dpp v66, v67, v66 wave_shr:1 row_mask:0xf bank_mask:0xf bound_ctrl:0
    v_add_f32_dpp v78, v61, v77 wave_ror:1 row_mask:0xf bank_mask:0xf
    v_add_f32_dpp v74, v62, v73 wave_ror:1 row_mask:0xf bank_mask:0xf
    v_add_f32_dpp v70, v66, v69 wave_ror:1 row_mask:0xf bank_mask:0xf
    v_add_f32_dpp v78, v60, v77 wave_shr:1 row_mask:0xf bank_mask:0xf
    v_add_f32_dpp v74, v61, v73 wave_shr:1 row_mask:0xf bank_mask:0xf
    v_add_f32_dpp v70, v62, v69 wave_shr:1 row_mask:0xf bank_mask:0xf
    v_add_f32_dpp v65, v66, v65 wave_shr:1 row_mask:0xf bank_mask:0xf bound_ctrl:0
    v_add_f32_dpp v77, v74, v76 wave_ror:1 row_mask:0xf bank_mask:0xf
    v_add_f32_dpp v73, v70, v72 wave_ror:1 row_mask:0xf bank_mask:0xf
    v_add_f32_dpp v69, v65, v68 wave_ror:1 row_mask:0xf bank_mask:0xf
    v_add_f32_dpp v77, v78, v76 wave_shr:1 row_mask:0xf bank_mask:0xf
    v_add_f32_dpp v73, v74, v72 wave_shr:1 row_mask:0xf bank_mask:0xf
    v_add_f32_dpp v69, v70, v68 wave_shr:1 row_mask:0xf bank_mask:0xf
    s_mov_b32 m0, s29
    v_add_f32_dpp v64, v65, v64 wave_shr:1 row_mask:0xf bank_mask:0xf bound_ctrl:0
    ds_write_addtid_b32 v79 offset:26348
    ds_write_addtid_b32 v60 offset:26344
    ds_write_addtid_b32 v78 offset:26340
    ds_write_addtid_b32 v77 offset:19392
    ds_write_addtid_b32 v73 offset:19136
    ds_write_addtid_b32 v69 offset:18880
    ds_write_addtid_b32 v64 offset:18624
    v_add_f32_dpp v60, v91, v94 wave_ror:1 row_mask:0xf bank_mask:0xf
    v_add_f32_dpp v61, v87, v90 wave_ror:1 row_mask:0xf bank_mask:0xf
    v_add_f32_dpp v62, v83, v86 wave_ror:1 row_mask:0xf bank_mask:0xf
    v_add_f32_dpp v60, v95, v94 wave_shr:1 row_mask:0xf bank_mask:0xf
    v_add_f32_dpp v61, v91, v90 wave_shr:1 row_mask:0xf bank_mask:0xf
    v_add_f32_dpp v62, v87, v86 wave_shr:1 row_mask:0xf bank_mask:0xf
    v_add_f32_dpp v82, v83, v82 wave_shr:1 row_mask:0xf bank_mask:0xf bound_ctrl:0
    v_add_f32_dpp v94, v61, v93 wave_ror:1 row_mask:0xf bank_mask:0xf
    v_add_f32_dpp v90, v62, v89 wave_ror:1 row_mask:0xf bank_mask:0xf
    v_add_f32_dpp v86, v82, v85 wave_ror:1 row_mask:0xf bank_mask:0xf
    v_add_f32_dpp v94, v60, v93 wave_shr:1 row_mask:0xf bank_mask:0xf
    v_add_f32_dpp v90, v61, v89 wave_shr:1 row_mask:0xf bank_mask:0xf
    v_add_f32_dpp v86, v62, v85 wave_shr:1 row_mask:0xf bank_mask:0xf
    v_add_f32_dpp v81, v82, v81 wave_shr:1 row_mask:0xf bank_mask:0xf bound_ctrl:0
    v_add_f32_dpp v93, v90, v92 wave_ror:1 row_mask:0xf bank_mask:0xf
    v_add_f32_dpp v89, v86, v88 wave_ror:1 row_mask:0xf bank_mask:0xf
    v_add_f32_dpp v85, v81, v84 wave_ror:1 row_mask:0xf bank_mask:0xf
    v_add_f32_dpp v93, v94, v92 wave_shr:1 row_mask:0xf bank_mask:0xf
    v_add_f32_dpp v89, v90, v88 wave_shr:1 row_mask:0xf bank_mask:0xf
    v_add_f32_dpp v85, v86, v84 wave_shr:1 row_mask:0xf bank_mask:0xf
    v_add_f32_dpp v80, v81, v80 wave_shr:1 row_mask:0xf bank_mask:0xf bound_ctrl:0
    ds_write_addtid_b32 v95 offset:26892
    ds_write_addtid_b32 v60 offset:26888
    ds_write_addtid_b32 v94 offset:26884
    ds_write_addtid_b32 v93 offset:21440
    ds_write_addtid_b32 v89 offset:21184
    ds_write_addtid_b32 v85 offset:20928
    ds_write_addtid_b32 v80 offset:20672
    v_add_f32_dpp v60, v107, v110 wave_ror:1 row_mask:0xf bank_mask:0xf
    v_add_f32_dpp v61, v103, v106 wave_ror:1 row_mask:0xf bank_mask:0xf
    v_add_f32_dpp v62, v99, v102 wave_ror:1 row_mask:0xf bank_mask:0xf
    v_add_f32_dpp v60, v111, v110 wave_shr:1 row_mask:0xf bank_mask:0xf
    v_add_f32_dpp v61, v107, v106 wave_shr:1 row_mask:0xf bank_mask:0xf
    v_add_f32_dpp v62, v103, v102 wave_shr:1 row_mask:0xf bank_mask:0xf
    v_add_f32_dpp v98, v99, v98 wave_shr:1 row_mask:0xf bank_mask:0xf bound_ctrl:0
    v_add_f32_dpp v110, v61, v109 wave_ror:1 row_mask:0xf bank_mask:0xf
    v_add_f32_dpp v106, v62, v105 wave_ror:1 row_mask:0xf bank_mask:0xf
    v_add_f32_dpp v102, v98, v101 wave_ror:1 row_mask:0xf bank_mask:0xf
    v_add_f32_dpp v110, v60, v109 wave_shr:1 row_mask:0xf bank_mask:0xf
    v_add_f32_dpp v106, v61, v105 wave_shr:1 row_mask:0xf bank_mask:0xf
    v_add_f32_dpp v102, v62, v101 wave_shr:1 row_mask:0xf bank_mask:0xf
    v_add_f32_dpp v97, v98, v97 wave_shr:1 row_mask:0xf bank_mask:0xf bound_ctrl:0
    v_add_f32_dpp v109, v106, v108 wave_ror:1 row_mask:0xf bank_mask:0xf
    v_add_f32_dpp v105, v102, v104 wave_ror:1 row_mask:0xf bank_mask:0xf
    v_add_f32_dpp v101, v97, v100 wave_ror:1 row_mask:0xf bank_mask:0xf
    v_add_f32_dpp v109, v110, v108 wave_shr:1 row_mask:0xf bank_mask:0xf
    v_add_f32_dpp v105, v106, v104 wave_shr:1 row_mask:0xf bank_mask:0xf
    v_add_f32_dpp v101, v102, v100 wave_shr:1 row_mask:0xf bank_mask:0xf
    v_add_f32_dpp v96, v97, v96 wave_shr:1 row_mask:0xf bank_mask:0xf bound_ctrl:0
    ds_write_addtid_b32 v111 offset:27164
    ds_write_addtid_b32 v60 offset:27160
    ds_write_addtid_b32 v110 offset:27156
    ds_write_addtid_b32 v109 offset:22464
    ds_write_addtid_b32 v105 offset:22208
    ds_write_addtid_b32 v101 offset:21952
    ds_write_addtid_b32 v96 offset:21696
    v_add_f32_dpp v60, v123, v126 wave_ror:1 row_mask:0xf bank_mask:0xf
    v_add_f32_dpp v61, v119, v122 wave_ror:1 row_mask:0xf bank_mask:0xf
    v_add_f32_dpp v62, v115, v118 wave_ror:1 row_mask:0xf bank_mask:0xf
    v_add_f32_dpp v60, v127, v126 wave_shr:1 row_mask:0xf bank_mask:0xf
    v_add_f32_dpp v61, v123, v122 wave_shr:1 row_mask:0xf bank_mask:0xf
    v_add_f32_dpp v62, v119, v118 wave_shr:1 row_mask:0xf bank_mask:0xf
    v_add_f32_dpp v114, v115, v114 wave_shr:1 row_mask:0xf bank_mask:0xf bound_ctrl:0
    v_add_f32_dpp v126, v61, v125 wave_ror:1 row_mask:0xf bank_mask:0xf
    v_add_f32_dpp v122, v62, v121 wave_ror:1 row_mask:0xf bank_mask:0xf
    v_add_f32_dpp v118, v114, v117 wave_ror:1 row_mask:0xf bank_mask:0xf
    v_add_f32_dpp v126, v60, v125 wave_shr:1 row_mask:0xf bank_mask:0xf
    v_add_f32_dpp v122, v61, v121 wave_shr:1 row_mask:0xf bank_mask:0xf
    v_add_f32_dpp v118, v62, v117 wave_shr:1 row_mask:0xf bank_mask:0xf
    v_add_f32_dpp v113, v114, v113 wave_shr:1 row_mask:0xf bank_mask:0xf bound_ctrl:0
    v_add_f32_dpp v125, v122, v124 wave_ror:1 row_mask:0xf bank_mask:0xf
    v_add_f32_dpp v121, v118, v120 wave_ror:1 row_mask:0xf bank_mask:0xf
    v_add_f32_dpp v117, v113, v116 wave_ror:1 row_mask:0xf bank_mask:0xf
    v_add_f32_dpp v125, v126, v124 wave_shr:1 row_mask:0xf bank_mask:0xf
    v_add_f32_dpp v121, v122, v120 wave_shr:1 row_mask:0xf bank_mask:0xf
    v_add_f32_dpp v117, v118, v116 wave_shr:1 row_mask:0xf bank_mask:0xf
    v_add_f32_dpp v112, v113, v112 wave_shr:1 row_mask:0xf bank_mask:0xf bound_ctrl:0
    ds_write_addtid_b32 v127 offset:27708
    ds_write_addtid_b32 v60 offset:27704
    ds_write_addtid_b32 v126 offset:27700
    ds_write_addtid_b32 v125 offset:24512
    ds_write_addtid_b32 v121 offset:24256
    ds_write_addtid_b32 v117 offset:24000
    ds_write_addtid_b32 v112 offset:23744
    s_waitcnt lgkmcnt(0)
    s_barrier
    ds_read_b128 v[24:27], v5 offset:0
    ds_read_b128 v[28:31], v5 offset:16
    ds_read_b128 v[32:35], v6 offset:0
    ds_read_b128 v[36:39], v5 offset:1024
    ds_read_b128 v[40:43], v5 offset:1040
    ds_read_b128 v[44:47], v6 offset:272
    s_waitcnt lgkmcnt(3)
    s_mov_b64 exec, 5
    v_pk_add_f32 v[24:25], v[24:25], v[32:33]
    v_add_f32 v26, v26, v34
    s_mov_b64 exec, -1
    v_cvt_pk_bf16_f32 v48, v24, v25
    v_cvt_pk_bf16_f32 v49, v26, v27
    v_cvt_pk_bf16_f32 v50, v28, v29
    v_cvt_pk_bf16_f32 v51, v30, v31
    buffer_store_dwordx4 v[48:51], v7, s[4:7], s22 offen sc1
    s_waitcnt lgkmcnt(0)
    s_mov_b64 exec, 5
    v_pk_add_f32 v[36:37], v[36:37], v[44:45]
    v_add_f32 v38, v38, v46
    s_mov_b64 exec, -1
    v_cvt_pk_bf16_f32 v52, v36, v37
    v_cvt_pk_bf16_f32 v53, v38, v39
    v_cvt_pk_bf16_f32 v54, v40, v41
    v_cvt_pk_bf16_f32 v55, v42, v43
    buffer_store_dwordx4 v[52:55], v7, s[4:7], s23 offen sc1
    v_mbcnt_lo_u32_b32 v24, -1, 0
    v_mbcnt_hi_u32_b32 v24, -1, v24
    v_lshlrev_b32 v24, 10, v24
    v_mov_b32 v25, s47
    s_waitcnt vmcnt(24)
    ds_read_b64_tr_b16 v[144:145], v254 offset:0
    ds_read_b64_tr_b16 v[146:147], v254 offset:512
    ds_read_b64_tr_b16 v[148:149], v255 offset:0
    ds_read_b64_tr_b16 v[150:151], v255 offset:512
    s_waitcnt vmcnt(22)
    ds_read_b64_tr_b16 v[152:153], v254 offset:2048
    ds_read_b64_tr_b16 v[154:155], v254 offset:2560
    ds_read_b64_tr_b16 v[156:157], v255 offset:2048
    ds_read_b64_tr_b16 v[158:159], v255 offset:2560
    s_waitcnt vmcnt(20)
    ds_read_b64_tr_b16 a[80:81], v254 offset:4096
    ds_read_b64_tr_b16 a[82:83], v254 offset:4608
    ds_read_b64_tr_b16 a[84:85], v255 offset:4096
    ds_read_b64_tr_b16 a[86:87], v255 offset:4608
    s_waitcnt vmcnt(18)
    ds_read_b64_tr_b16 a[88:89], v254 offset:6144
    ds_read_b64_tr_b16 a[90:91], v254 offset:6656
    ds_read_b64_tr_b16 a[92:93], v255 offset:6144
    ds_read_b64_tr_b16 a[94:95], v255 offset:6656
    s_waitcnt vmcnt(16)
    ds_read_b64_tr_b16 a[96:97], v254 offset:8192
    ds_read_b64_tr_b16 a[98:99], v254 offset:8704
    ds_read_b64_tr_b16 a[100:101], v255 offset:8192
    ds_read_b64_tr_b16 a[102:103], v255 offset:8704
    s_waitcnt vmcnt(14)
    ds_read_b64_tr_b16 a[104:105], v254 offset:10240
    ds_read_b64_tr_b16 a[106:107], v254 offset:10752
    ds_read_b64_tr_b16 a[108:109], v255 offset:10240
    ds_read_b64_tr_b16 a[110:111], v255 offset:10752
    s_waitcnt vmcnt(12)
    ds_read_b64_tr_b16 a[112:113], v254 offset:12288
    ds_read_b64_tr_b16 a[114:115], v254 offset:12800
    ds_read_b64_tr_b16 a[116:117], v255 offset:12288
    ds_read_b64_tr_b16 a[118:119], v255 offset:12800
    s_waitcnt vmcnt(10)
    ds_read_b64_tr_b16 a[120:121], v254 offset:14336
    ds_read_b64_tr_b16 a[122:123], v254 offset:14848
    ds_read_b64_tr_b16 a[124:125], v255 offset:14336
    ds_read_b64_tr_b16 a[126:127], v255 offset:14848
    s_waitcnt vmcnt(8)
    ds_read_b64_tr_b16 a[128:129], v254 offset:16384
    ds_read_b64_tr_b16 a[130:131], v254 offset:16896
    ds_read_b64_tr_b16 a[132:133], v255 offset:16384
    ds_read_b64_tr_b16 a[134:135], v255 offset:16896
    s_waitcnt vmcnt(6)
    ds_read_b64_tr_b16 a[136:137], v254 offset:18432
    ds_read_b64_tr_b16 a[138:139], v254 offset:18944
    ds_read_b64_tr_b16 a[140:141], v255 offset:18432
    ds_read_b64_tr_b16 a[142:143], v255 offset:18944
    s_waitcnt vmcnt(4)
    ds_read_b64_tr_b16 a[144:145], v254 offset:20480
    ds_read_b64_tr_b16 a[146:147], v254 offset:20992
    ds_read_b64_tr_b16 a[148:149], v255 offset:20480
    ds_read_b64_tr_b16 a[150:151], v255 offset:20992
    s_waitcnt vmcnt(2)
    ds_read_b64_tr_b16 a[152:153], v254 offset:22528
    ds_read_b64_tr_b16 a[154:155], v254 offset:23040
    ds_read_b64_tr_b16 a[156:157], v255 offset:22528
    ds_read_b64_tr_b16 a[158:159], v255 offset:23040
    s_waitcnt lgkmcnt(15)
    s_add_u32 m0, s55, 0
    s_add_u32 s43, s50, 57344
    buffer_load_dwordx4 v250, s[8:11], s50 offen lds
    buffer_load_dwordx4 v251, s[8:11], s50 offen offset:1024 lds
    s_cmp_eq_u32 s43, s52
    s_cselect_b32 s50, s51, s43
    s_add_u32 s43, s53, 262144
    s_sub_u32 s41, s43, 1835008
    s_add_u32 m0, s55, 2048
    s_cmp_ge_u32 s43, s54
    s_cselect_b32 s43, s41, s43
    buffer_load_dwordx4 v252, s[12:15], s43 offen lds
    buffer_load_dwordx4 v253, s[12:15], s43 offen offset:1024 lds
    s_waitcnt vmcnt(4)
    s_mov_b64 exec, 0xff
    buffer_store_dword v25, v24, s[4:7], s56 offen sc1
    s_mov_b64 exec, -1
    s_add_u32 s56, s56, 16
    s_waitcnt lgkmcnt(0)
    s_branch .Lpage8
.p2alignl 12, 0xbf810000
.Lpage8:
.Lcv0_join:
    s_add_u32 m0, s55, 4096
    s_add_u32 s43, s50, 57344
    buffer_load_dwordx4 v250, s[8:11], s50 offen lds
    buffer_load_dwordx4 v251, s[8:11], s50 offen offset:1024 lds
    s_cmp_eq_u32 s43, s52
    s_cselect_b32 s50, s51, s43
    s_add_u32 m0, s55, 6144
    s_add_u32 s43, s50, 57344
    buffer_load_dwordx4 v250, s[8:11], s50 offen lds
    buffer_load_dwordx4 v251, s[8:11], s50 offen offset:1024 lds
    s_cmp_eq_u32 s43, s52
    s_cselect_b32 s50, s51, s43
    s_add_u32 m0, s55, 8192
    s_add_u32 s43, s50, 57344
    buffer_load_dwordx4 v250, s[8:11], s50 offen lds
    buffer_load_dwordx4 v251, s[8:11], s50 offen offset:1024 lds
    s_cmp_eq_u32 s43, s52
    s_cselect_b32 s50, s51, s43
    s_add_u32 m0, s55, 10240
    s_add_u32 s43, s50, 57344
    buffer_load_dwordx4 v250, s[8:11], s50 offen lds
    buffer_load_dwordx4 v251, s[8:11], s50 offen offset:1024 lds
    s_cmp_eq_u32 s43, s52
    s_cselect_b32 s50, s51, s43
    s_add_u32 m0, s55, 12288
    s_add_u32 s43, s50, 57344
    buffer_load_dwordx4 v250, s[8:11], s50 offen lds
    buffer_load_dwordx4 v251, s[8:11], s50 offen offset:1024 lds
    s_cmp_eq_u32 s43, s52
    s_cselect_b32 s50, s51, s43
    s_add_u32 m0, s55, 14336
    s_add_u32 s43, s50, 57344
    buffer_load_dwordx4 v250, s[8:11], s50 offen lds
    buffer_load_dwordx4 v251, s[8:11], s50 offen offset:1024 lds
    s_cmp_eq_u32 s43, s52
    s_cselect_b32 s50, s51, s43
    s_add_u32 m0, s55, 16384
    s_add_u32 s43, s50, 57344
    buffer_load_dwordx4 v250, s[8:11], s50 offen lds
    buffer_load_dwordx4 v251, s[8:11], s50 offen offset:1024 lds
    s_cmp_eq_u32 s43, s52
    s_cselect_b32 s50, s51, s43
    s_add_u32 m0, s55, 18432
    s_add_u32 s43, s50, 57344
    buffer_load_dwordx4 v250, s[8:11], s50 offen lds
    buffer_load_dwordx4 v251, s[8:11], s50 offen offset:1024 lds
    s_cmp_eq_u32 s43, s52
    s_cselect_b32 s50, s51, s43
    s_add_u32 s43, s53, 393216
    s_sub_u32 s41, s43, 1835008
    s_add_u32 m0, s55, 20480
    s_cmp_ge_u32 s43, s54
    s_cselect_b32 s43, s41, s43
    buffer_load_dwordx4 v252, s[12:15], s43 offen lds
    buffer_load_dwordx4 v253, s[12:15], s43 offen offset:1024 lds
    v_mbcnt_lo_u32_b32 v4, -1, 0
    v_mbcnt_hi_u32_b32 v4, -1, v4
    v_lshrrev_b32 v5, 5, v4
    v_and_b32 v6, 31, v4
    v_lshlrev_b32 v1, 10, v5
    v_lshl_add_u32 v1, v6, 4, v1
    v_lshlrev_b32 v2, 2, v4
    v_and_b32 v6, 7, v4
    v_lshlrev_b32 v3, 4, v6
    v_lshl_add_u32 v3, v5, 7, v3
    v_bfe_u32 v6, v4, 3, 2
    v_lshl_add_u32 v3, v6, 8, v3
    s_lshl_b32 s22, s46, 3
    s_add_u32 s22, s22, s44
    s_lshl_b32 s22, s22, 11
    s_add_u32 s20, s22, 76021760
    s_lshl_b32 s21, s45, 8
    s_add_u32 s21, s21, s20
    s_and_b32 s42, s31, 8192
    s_add_u32 s20, s20, s42
    s_add_u32 s21, s21, s42
    s_xor_b32 s28, s21, 8192
    s_add_u32 s22, s22, s31
    s_add_u32 s23, s22, 524288
    s_add_u32 s22, s22, 1048576
    s_mov_b32 s24, 0x11111111
    s_mov_b32 s25, s24
    s_mov_b32 s26, 0xbb000000
    s_mov_b32 s27, 0x3b000000
    v_and_b32 v6, 31, v4
    v_lshlrev_b32 v6, 5, v6
    v_lshl_add_u32 v6, v5, 4, v6
    s_mov_b32 s34, 0x3f80
    s_mov_b32 s35, 0x3f800000
    s_min_u32 s42, s48, 27
    s_lshl_b32 s42, s42, 7
    s_lshl_b32 s41, s44, 5
    s_add_u32 s42, s42, s41
    v_lshl_add_u32 v64, v5, 4, s42
    global_load_dwordx4 v[120:123], v64, s[36:37]
    s_lshl_b32 s42, s46, 7
    s_add_u32 s42, s42, s41
    v_lshl_add_u32 v65, v5, 4, s42
    global_load_dwordx4 v[124:127], v65, s[38:39]
.Lpoll3:
    s_load_dwordx4 s[60:63], s[4:5], s57 glc
    s_load_dwordx4 s[64:67], s[4:5], s57 offset:128 glc
    s_addk_i32 s59, 0x2000
    s_cbranch_scc1 .Lend
.Lpoll3_chk:
    s_waitcnt lgkmcnt(0)
    s_xor_b64 s[60:61], s[60:61], s[32:33]
    s_xor_b64 s[62:63], s[62:63], s[32:33]
    s_xor_b64 s[64:65], s[64:65], s[32:33]
    s_xor_b64 s[66:67], s[66:67], s[32:33]
    s_or_b64 s[60:61], s[60:61], s[62:63]
    s_or_b64 s[64:65], s[64:65], s[66:67]
    s_or_b64 s[60:61], s[60:61], s[64:65]
    s_cbranch_scc1 .Lpoll3
    s_add_u32 s57, s57, 16
    s_barrier
    buffer_load_dwordx4 v[56:59], v6, s[4:7], s23 offen sc1
    buffer_load_dwordx4 v[60:63], v6, s[4:7], s23 offen offset:1024 sc1
    s_add_u32 m0, s55, 22528
    s_add_u32 s43, s50, 57344
    buffer_load_dwordx4 v250, s[8:11], s50 offen lds
    buffer_load_dwordx4 v251, s[8:11], s50 offen offset:1024 lds
    s_cmp_eq_u32 s43, s52
    s_cselect_b32 s50, s51, s43
    s_waitcnt vmcnt(27)
    ds_read_b64_tr_b16 a[160:161], v254 offset:0
    ds_read_b64_tr_b16 a[162:163], v254 offset:512
    ds_read_b64_tr_b16 a[164:165], v255 offset:0
    ds_read_b64_tr_b16 a[166:167], v255 offset:512
    s_waitcnt lgkmcnt(0)
    s_add_u32 m0, s55, 0
    s_add_u32 s43, s50, 57344
    buffer_load_dwordx4 v250, s[8:11], s50 offen lds
    buffer_load_dwordx4 v251, s[8:11], s50 offen offset:1024 lds
    s_cmp_eq_u32 s43, s52
    s_cselect_b32 s50, s51, s43
    s_waitcnt vmcnt(27)
    ds_read_b64_tr_b16 v[160:161], v254 offset:2048
    ds_read_b64_tr_b16 v[162:163], v254 offset:2560
    ds_read_b64_tr_b16 v[164:165], v255 offset:2048
    ds_read_b64_tr_b16 v[166:167], v255 offset:2560
    s_waitcnt lgkmcnt(0)
    s_add_u32 s43, s53, 524288
    s_sub_u32 s41, s43, 1835008
    s_add_u32 m0, s55, 2048
    s_cmp_ge_u32 s43, s54
    s_cselect_b32 s43, s41, s43
    buffer_load_dwordx4 v252, s[12:15], s43 offen lds
    buffer_load_dwordx4 v253, s[12:15], s43 offen offset:1024 lds
    s_waitcnt vmcnt(26)
    ds_read_b64_tr_b16 a[168:169], v254 offset:4096
    ds_read_b64_tr_b16 a[170:171], v254 offset:4608
    ds_read_b64_tr_b16 a[172:173], v255 offset:4096
    ds_read_b64_tr_b16 a[174:175], v255 offset:4608
    s_waitcnt lgkmcnt(0)
    s_add_u32 s43, s53, 655360
    s_sub_u32 s41, s43, 1835008
    s_add_u32 m0, s55, 4096
    s_cmp_ge_u32 s43, s54
    s_cselect_b32 s43, s41, s43
    buffer_load_dwordx4 v252, s[12:15], s43 offen lds
    buffer_load_dwordx4 v253, s[12:15], s43 offen offset:1024 lds
    s_waitcnt vmcnt(9)
    v_dot2c_f32_bf16 v8, s34, v56
    v_dot2c_f32_bf16 v9, s35, v56
    v_dot2c_f32_bf16 v10, s34, v57
    v_dot2c_f32_bf16 v11, s35, v57
    v_dot2c_f32_bf16 v12, s34, v58
    v_dot2c_f32_bf16 v13, s35, v58
    v_dot2c_f32_bf16 v14, s34, v59
    v_dot2c_f32_bf16 v15, s35, v59
    s_waitcnt vmcnt(8)
    v_dot2c_f32_bf16 v16, s34, v60
    v_dot2c_f32_bf16 v17, s35, v60
    v_dot2c_f32_bf16 v18, s34, v61
    v_dot2c_f32_bf16 v19, s35, v61
    v_dot2c_f32_bf16 v20, s34, v62
    v_dot2c_f32_bf16 v21, s35, v62
    v_dot2c_f32_bf16 v22, s34, v63
    v_dot2c_f32_bf16 v23, s35, v63
    v_pk_mul_f32 v[32:33], v[8:9], v[8:9]
    v_pk_mul_f32 v[34:35], v[10:11], v[10:11]
    v_pk_mul_f32 v[36:37], v[12:13], v[12:13]
    v_pk_mul_f32 v[38:39], v[14:15], v[14:15]
    v_pk_add_f32 v[24:25], v[8:9], v[16:17]
    v_pk_add_f32 v[26:27], v[10:11], v[18:19]
    v_pk_add_f32 v[28:29], v[12:13], v[20:21]
    v_pk_add_f32 v[30:31], v[14:15], v[22:23]
    v_pk_fma_f32 v[32:33], v[16:17], v[16:17], v[32:33]
    v_pk_fma_f32 v[34:35], v[18:19], v[18:19], v[34:35]
    v_pk_fma_f32 v[36:37], v[20:21], v[20:21], v[36:37]
    v_pk_fma_f32 v[38:39], v[22:23], v[22:23], v[38:39]
    v_permlane16_swap_b32 v24, v28
    v_permlane16_swap_b32 v25, v29
    v_permlane16_swap_b32 v26, v30
    v_permlane16_swap_b32 v27, v31
    v_permlane16_swap_b32 v32, v36
    v_permlane16_swap_b32 v33, v37
    v_permlane16_swap_b32 v34, v38
    v_permlane16_swap_b32 v35, v39
    v_pk_add_f32 v[24:25], v[24:25], v[28:29]
    v_pk_add_f32 v[26:27], v[26:27], v[30:31]
    v_pk_add_f32 v[32:33], v[32:33], v[36:37]
    v_pk_add_f32 v[34:35], v[34:35], v[38:39]
    v_add_f32_dpp v24, v24, v24 row_mirror row_mask:0xf bank_mask:0x3
    v_add_f32_dpp v25, v25, v25 row_mirror row_mask:0xf bank_mask:0x3
    v_add_f32_dpp v32, v32, v32 row_mirror row_mask:0xf bank_mask:0x3
    v_add_f32_dpp v33, v33, v33 row_mirror row_mask:0xf bank_mask:0x3
    v_add_f32_dpp v24, v26, v26 row_mirror row_mask:0xf bank_mask:0xc
    v_add_f32_dpp v25, v27, v27 row_mirror row_mask:0xf bank_mask:0xc
    v_add_f32_dpp v32, v34, v34 row_mirror row_mask:0xf bank_mask:0xc
    v_add_f32_dpp v33, v35, v35 row_mirror row_mask:0xf bank_mask:0xc
    v_add_f32_dpp v24, v24, v24 row_half_mirror row_mask:0xf bank_mask:0x5
    v_add_f32_dpp v32, v32, v32 row_half_mirror row_mask:0xf bank_mask:0x5
    v_add_f32_dpp v24, v25, v25 row_half_mirror row_mask:0xf bank_mask:0xa
    v_add_f32_dpp v32, v33, v33 row_half_mirror row_mask:0xf bank_mask:0xa
    v_mov_b32 v25, s47
    v_add_f32_dpp v24, v24, v24 quad_perm:[2,3,0,1] row_mask:0xf bank_mask:0xf
    v_add_f32_dpp v32, v32, v32 quad_perm:[2,3,0,1] row_mask:0xf bank_mask:0xf
    v_mov_b32 v27, s47
    v_add_f32_dpp v24, v24, v24 quad_perm:[1,0,3,2] row_mask:0xf bank_mask:0xf
    v_add_f32_dpp v26, v32, v32 quad_perm:[1,0,3,2] row_mask:0xf bank_mask:0xf
    s_mov_b64 exec, s[24:25]
    buffer_store_dwordx4 v[24:27], v2, s[4:7], s21 offen sc1
    buffer_store_dwordx4 v[24:27], v2, s[4:7], s28 offen sc1
    s_mov_b64 exec, -1
    ds_read_b64_tr_b16 a[176:177], v254 offset:6144
    ds_read_b64_tr_b16 a[178:179], v254 offset:6656
    ds_read_b64_tr_b16 a[180:181], v255 offset:6144
    ds_read_b64_tr_b16 a[182:183], v255 offset:6656
    s_waitcnt lgkmcnt(0)
    s_add_u32 m0, s55, 6144
    s_add_u32 s43, s50, 57344
    buffer_load_dwordx4 v250, s[8:11], s50 offen lds
    buffer_load_dwordx4 v251, s[8:11], s50 offen offset:1024 lds
    s_cmp_eq_u32 s43, s52
    s_cselect_b32 s50, s51, s43
    ds_read_b64_tr_b16 a[184:185], v254 offset:8192
    ds_read_b64_tr_b16 a[186:187], v254 offset:8704
    ds_read_b64_tr_b16 a[188:189], v255 offset:8192
    ds_read_b64_tr_b16 a[190:191], v255 offset:8704
    s_waitcnt lgkmcnt(0)
    s_add_u32 s43, s53, 786432
    s_sub_u32 s41, s43, 1835008
    s_add_u32 m0, s55, 8192
    s_cmp_ge_u32 s43, s54
    s_cselect_b32 s43, s41, s43
    buffer_load_dwordx4 v252, s[12:15], s43 offen lds
    buffer_load_dwordx4 v253, s[12:15], s43 offen offset:1024 lds
    ds_read_b64_tr_b16 a[192:193], v254 offset:10240
    ds_read_b64_tr_b16 a[194:195], v254 offset:10752
    ds_read_b64_tr_b16 a[196:197], v255 offset:10240
    ds_read_b64_tr_b16 a[198:199], v255 offset:10752
    s_waitcnt lgkmcnt(0)
    s_add_u32 s43, s53, 917504
    s_sub_u32 s41, s43, 1835008
    s_add_u32 m0, s55, 10240
    s_cmp_ge_u32 s43, s54
    s_cselect_b32 s43, s41, s43
    buffer_load_dwordx4 v252, s[12:15], s43 offen lds
    buffer_load_dwordx4 v253, s[12:15], s43 offen offset:1024 lds
    ds_read_b64_tr_b16 a[200:201], v254 offset:12288
    ds_read_b64_tr_b16 a[202:203], v254 offset:12800
    ds_read_b64_tr_b16 a[204:205], v255 offset:12288
    ds_read_b64_tr_b16 a[206:207], v255 offset:12800
    s_waitcnt lgkmcnt(0)
    s_add_u32 s43, s53, 1048576
    s_sub_u32 s41, s43, 1835008
    s_add_u32 m0, s55, 12288
    s_cmp_ge_u32 s43, s54
    s_cselect_b32 s43, s41, s43
    buffer_load_dwordx4 v252, s[12:15], s43 offen lds
    buffer_load_dwordx4 v253, s[12:15], s43 offen offset:1024 lds
    ds_read_b64_tr_b16 a[208:209], v254 offset:14336
    ds_read_b64_tr_b16 a[210:211], v254 offset:14848
    ds_read_b64_tr_b16 a[212:213], v255 offset:14336
    ds_read_b64_tr_b16 a[214:215], v255 offset:14848
    s_waitcnt lgkmcnt(0)
    s_add_u32 s43, s53, 1179648
    s_sub_u32 s41, s43, 1835008
    s_add_u32 m0, s55, 14336
    s_cmp_ge_u32 s43, s54
    s_cselect_b32 s43, s41, s43
    buffer_load_dwordx4 v252, s[12:15], s43 offen lds
    buffer_load_dwordx4 v253, s[12:15], s43 offen offset:1024 lds
    ds_read_b64_tr_b16 a[216:217], v254 offset:16384
    ds_read_b64_tr_b16 a[218:219], v254 offset:16896
    ds_read_b64_tr_b16 a[220:221], v255 offset:16384
    ds_read_b64_tr_b16 a[222:223], v255 offset:16896
    s_waitcnt lgkmcnt(0)
    s_add_u32 s43, s53, 1310720
    s_sub_u32 s41, s43, 1835008
    s_add_u32 m0, s55, 16384
    s_cmp_ge_u32 s43, s54
    s_cselect_b32 s43, s41, s43
    buffer_load_dwordx4 v252, s[12:15], s43 offen lds
    buffer_load_dwordx4 v253, s[12:15], s43 offen offset:1024 lds
    ds_read_b64_tr_b16 a[224:225], v254 offset:18432
    ds_read_b64_tr_b16 a[226:227], v254 offset:18944
    ds_read_b64_tr_b16 a[228:229], v255 offset:18432
    ds_read_b64_tr_b16 a[230:231], v255 offset:18944
    s_waitcnt lgkmcnt(0)
    s_add_u32 s43, s53, 1441792
    s_sub_u32 s41, s43, 1835008
    s_add_u32 m0, s55, 18432
    s_cmp_ge_u32 s43, s54
    s_cselect_b32 s43, s41, s43
    buffer_load_dwordx4 v252, s[12:15], s43 offen lds
    buffer_load_dwordx4 v253, s[12:15], s43 offen offset:1024 lds
    ds_read_b64_tr_b16 v[168:169], v254 offset:20480
    ds_read_b64_tr_b16 v[170:171], v254 offset:20992
    ds_read_b64_tr_b16 v[172:173], v255 offset:20480
    ds_read_b64_tr_b16 v[174:175], v255 offset:20992
    s_waitcnt lgkmcnt(0)
    s_add_u32 s43, s53, 1572864
    s_sub_u32 s41, s43, 1835008
    s_add_u32 m0, s55, 20480
    s_cmp_ge_u32 s43, s54
    s_cselect_b32 s43, s41, s43
    buffer_load_dwordx4 v252, s[12:15], s43 offen lds
    buffer_load_dwordx4 v253, s[12:15], s43 offen offset:1024 lds
    s_waitcnt vmcnt(16)
.Lgat4:
    buffer_load_dwordx4 v[40:43], v3, s[4:7], s20 offen sc1
    buffer_load_dwordx4 v[44:47], v3, s[4:7], s20 offen offset:1024 sc1
    s_addk_i32 s59, 0x2000
    s_cbranch_scc1 .Lend
.Lgat4_chk:
    s_waitcnt vmcnt(0)
    v_add_f32 v40, v40, v44
    v_add_f32 v42, v42, v46
    v_bitop3_b32 v41, v41, v43, s47 bitop3:0x7e
    v_bitop3_b32 v43, v45, v47, s47 bitop3:0x7e
    v_add_f32_dpp v44, v40, v40 row_ror:8 row_mask:0xf bank_mask:0xf
    v_add_f32_dpp v46, v40, v40 row_ror:8 row_mask:0xf bank_mask:0xf
    v_add_f32_dpp v45, v42, v42 row_ror:8 row_mask:0xf bank_mask:0xf
    v_add_f32_dpp v47, v42, v42 row_ror:8 row_mask:0xf bank_mask:0xf
    v_permlane16_swap_b32 v44, v46
    v_or_b32 v41, v41, v43
    v_permlane16_swap_b32 v45, v47
    v_cmp_ne_u32 vcc, 0, v41
    v_pk_add_f32 v[40:41], v[44:45], v[46:47]
    v_pk_mul_f32 v[40:41], v[40:41], s[26:27]
    v_fma_f32 v41, -v40, v40, v41
    v_max_f32 v41, 0, v41
    v_mul_f32 v41, 0x3f800054, v41
    v_add_f32 v42, 0x2edbe6ff, v41
    v_rsq_f32 v42, v42
    s_cbranch_vccnz .Lgat4
    v_mul_f32 v40, v40, v42
    v_mov_b32_dpp v24, v42 row_newbcast:0 row_mask:0xf bank_mask:0xf
    v_mov_b32_dpp v25, v42 row_newbcast:1 row_mask:0xf bank_mask:0xf
    v_mov_b32_dpp v26, v42 row_newbcast:2 row_mask:0xf bank_mask:0xf
    v_mov_b32_dpp v27, v42 row_newbcast:3 row_mask:0xf bank_mask:0xf
    v_mov_b32_dpp v28, v42 row_newbcast:4 row_mask:0xf bank_mask:0xf
    v_mov_b32_dpp v29, v42 row_newbcast:5 row_mask:0xf bank_mask:0xf
    v_mov_b32_dpp v30, v42 row_newbcast:6 row_mask:0xf bank_mask:0xf
    v_mov_b32_dpp v31, v42 row_newbcast:7 row_mask:0xf bank_mask:0xf
    v_mov_b32_dpp v32, v40 row_newbcast:0 row_mask:0xf bank_mask:0xf
    v_mov_b32_dpp v33, v40 row_newbcast:1 row_mask:0xf bank_mask:0xf
    v_mov_b32_dpp v34, v40 row_newbcast:2 row_mask:0xf bank_mask:0xf
    v_mov_b32_dpp v35, v40 row_newbcast:3 row_mask:0xf bank_mask:0xf
    v_mov_b32_dpp v36, v40 row_newbcast:4 row_mask:0xf bank_mask:0xf
    v_mov_b32_dpp v37, v40 row_newbcast:5 row_mask:0xf bank_mask:0xf
    v_mov_b32_dpp v38, v40 row_newbcast:6 row_mask:0xf bank_mask:0xf
    v_mov_b32_dpp v39, v40 row_newbcast:7 row_mask:0xf bank_mask:0xf
    v_pk_fma_f32 v[40:41], v[8:9], v[24:25], v[32:33]
    v_pk_fma_f32 v[42:43], v[10:11], v[26:27], v[34:35]
    v_pk_fma_f32 v[44:45], v[12:13], v[28:29], v[36:37]
    v_pk_fma_f32 v[46:47], v[14:15], v[30:31], v[38:39]
    v_cvt_pk_bf16_f32 v56, v40, v41
    v_cvt_pk_bf16_f32 v57, v42, v43
    v_cvt_pk_bf16_f32 v58, v44, v45
    v_cvt_pk_bf16_f32 v59, v46, v47
    buffer_store_dwordx4 v[56:59], v1, s[4:7], s22 offen offset:0 sc1
    v_pk_fma_f32 v[48:49], v[16:17], v[24:25], v[32:33]
    v_pk_fma_f32 v[50:51], v[18:19], v[26:27], v[34:35]
    v_pk_fma_f32 v[52:53], v[20:21], v[28:29], v[36:37]
    v_pk_fma_f32 v[54:55], v[22:23], v[30:31], v[38:39]
    v_cvt_pk_bf16_f32 v60, v48, v49
    v_cvt_pk_bf16_f32 v61, v50, v51
    v_cvt_pk_bf16_f32 v62, v52, v53
    v_cvt_pk_bf16_f32 v63, v54, v55
    buffer_store_dwordx4 v[60:63], v1, s[4:7], s22 offen offset:512 sc1
    v_cvt_pk_bf16_f32 v8, v8, v9
    v_cvt_pk_bf16_f32 v9, v10, v11
    v_cvt_pk_bf16_f32 v10, v12, v13
    v_cvt_pk_bf16_f32 v11, v14, v15
    v_cvt_pk_bf16_f32 v12, v16, v17
    v_cvt_pk_bf16_f32 v13, v18, v19
    v_cvt_pk_bf16_f32 v14, v20, v21
    v_cvt_pk_bf16_f32 v15, v22, v23
    v_mbcnt_lo_u32_b32 v24, -1, 0
    v_mbcnt_hi_u32_b32 v24, -1, v24
    v_lshlrev_b32 v24, 10, v24
    v_mov_b32 v25, s47
    ds_read_b64_tr_b16 a[232:233], v254 offset:22528
    ds_read_b64_tr_b16 a[234:235], v254 offset:23040
    ds_read_b64_tr_b16 a[236:237], v255 offset:22528
    ds_read_b64_tr_b16 a[238:239], v255 offset:23040
    ds_read_b64_tr_b16 a[240:241], v254 offset:0
    ds_read_b64_tr_b16 a[242:243], v254 offset:512
    ds_read_b64_tr_b16 a[244:245], v255 offset:0
    ds_read_b64_tr_b16 a[246:247], v255 offset:512
    ds_read_b64_tr_b16 v[176:177], v254 offset:2048
    ds_read_b64_tr_b16 v[178:179], v254 offset:2560
    ds_read_b64_tr_b16 v[180:181], v255 offset:2048
    ds_read_b64_tr_b16 v[182:183], v255 offset:2560
    ds_read_b64_tr_b16 v[184:185], v254 offset:4096
    ds_read_b64_tr_b16 v[186:187], v254 offset:4608
    ds_read_b64_tr_b16 v[188:189], v255 offset:4096
    ds_read_b64_tr_b16 v[190:191], v255 offset:4608
    ds_read_b64_tr_b16 a[248:249], v254 offset:6144
    ds_read_b64_tr_b16 a[250:251], v254 offset:6656
    ds_read_b64_tr_b16 a[252:253], v255 offset:6144
    ds_read_b64_tr_b16 a[254:255], v255 offset:6656
    ds_read_b64_tr_b16 v[192:193], v254 offset:8192
    ds_read_b64_tr_b16 v[194:195], v254 offset:8704
    ds_read_b64_tr_b16 v[196:197], v255 offset:8192
    ds_read_b64_tr_b16 v[198:199], v255 offset:8704
    ds_read_b64_tr_b16 v[200:201], v254 offset:10240
    ds_read_b64_tr_b16 v[202:203], v254 offset:10752
    ds_read_b64_tr_b16 v[204:205], v255 offset:10240
    ds_read_b64_tr_b16 v[206:207], v255 offset:10752
    ds_read_b64_tr_b16 v[208:209], v254 offset:12288
    ds_read_b64_tr_b16 v[210:211], v254 offset:12800
    ds_read_b64_tr_b16 v[212:213], v255 offset:12288
    ds_read_b64_tr_b16 v[214:215], v255 offset:12800
    ds_read_b64_tr_b16 v[216:217], v254 offset:14336
    ds_read_b64_tr_b16 v[218:219], v254 offset:14848
    ds_read_b64_tr_b16 v[220:221], v255 offset:14336
    ds_read_b64_tr_b16 v[222:223], v255 offset:14848
    ds_read_b64_tr_b16 v[224:225], v254 offset:16384
    ds_read_b64_tr_b16 v[226:227], v254 offset:16896
    ds_read_b64_tr_b16 v[228:229], v255 offset:16384
    ds_read_b64_tr_b16 v[230:231], v255 offset:16896
    ds_read_b64_tr_b16 v[232:233], v254 offset:18432
    ds_read_b64_tr_b16 v[234:235], v254 offset:18944
    ds_read_b64_tr_b16 v[236:237], v255 offset:18432
    ds_read_b64_tr_b16 v[238:239], v255 offset:18944
    ds_read_b64_tr_b16 v[240:241], v254 offset:20480
    ds_read_b64_tr_b16 v[242:243], v254 offset:20992
    ds_read_b64_tr_b16 v[244:245], v255 offset:20480
    ds_read_b64_tr_b16 v[246:247], v255 offset:20992
    s_waitcnt lgkmcnt(15)
    s_add_u32 s43, s53, 1703936
    s_sub_u32 s41, s43, 1835008
    s_add_u32 m0, s55, 22528
    s_cmp_ge_u32 s43, s54
    s_cselect_b32 s43, s41, s43
    buffer_load_dwordx4 v252, s[12:15], s43 offen lds
    buffer_load_dwordx4 v253, s[12:15], s43 offen offset:1024 lds
    s_add_u32 s43, s53, 327680
    s_sub_u32 s41, s43, 1835008
    s_add_u32 m0, s55, 0
    s_cmp_ge_u32 s43, s54
    s_cselect_b32 s43, s41, s43
    buffer_load_dwordx4 v252, s[12:15], s43 offen lds
    buffer_load_dwordx4 v253, s[12:15], s43 offen offset:1024 lds
    s_waitcnt vmcnt(4)
    s_barrier
    s_mov_b64 exec, 0xff
    buffer_store_dword v25, v24, s[4:7], s56 offen sc1
    s_mov_b64 exec, -1
    s_add_u32 s56, s56, 16
    s_getpc_b64 s[42:43]
.Lahead5:
    s_lshr_b32 s41, s2, 3
    s_lshl2_add_u32 s41, s41, s44
    s_lshl_b32 s41, s41, 7
    s_add_u32 s41, s41, 0
    s_min_u32 s41, s41, .Lcode_end-.Lahead5
    s_add_u32 s42, s42, s41
    s_addc_u32 s43, s43, 0
    v_mov_b32 v26, s42
    v_mov_b32 v27, s43
    s_mov_b64 exec, 1
    global_load_dword v24, v[26:27], off
    s_mov_b64 exec, -1
    s_add_u32 s43, s53, 458752
    s_sub_u32 s41, s43, 1835008
    s_add_u32 m0, s55, 2048
    s_cmp_ge_u32 s43, s54
    s_cselect_b32 s43, s41, s43
    buffer_load_dwordx4 v252, s[12:15], s43 offen lds
    buffer_load_dwordx4 v253, s[12:15], s43 offen offset:1024 lds
    s_add_u32 s43, s53, 589824
    s_sub_u32 s41, s43, 1835008
    s_add_u32 m0, s55, 4096
    s_cmp_ge_u32 s43, s54
    s_cselect_b32 s43, s41, s43
    buffer_load_dwordx4 v252, s[12:15], s43 offen lds
    buffer_load_dwordx4 v253, s[12:15], s43 offen offset:1024 lds
    s_add_u32 s43, s53, 720896
    s_sub_u32 s41, s43, 1835008
    s_add_u32 m0, s55, 6144
    s_cmp_ge_u32 s43, s54
    s_cselect_b32 s43, s41, s43
    buffer_load_dwordx4 v252, s[12:15], s43 offen lds
    buffer_load_dwordx4 v253, s[12:15], s43 offen offset:1024 lds
    s_add_u32 s43, s53, 851968
    s_sub_u32 s41, s43, 1835008
    s_add_u32 m0, s55, 8192
    s_cmp_ge_u32 s43, s54
    s_cselect_b32 s43, s41, s43
    buffer_load_dwordx4 v252, s[12:15], s43 offen lds
    buffer_load_dwordx4 v253, s[12:15], s43 offen offset:1024 lds
    v_mov_b32 v16, v250
    v_mov_b32 v17, v251
    v_mov_b32 v62, v252
    v_mov_b32 v63, v253
    v_mov_b32 v2, v254
    v_mov_b32 v3, v255
    v_mbcnt_lo_u32_b32 v60, -1, 0
    v_mbcnt_hi_u32_b32 v60, -1, v60
    v_lshrrev_b32 v61, 5, v60
    v_lshlrev_b32 v1, 10, v61
    v_and_b32 v61, 31, v60
    v_lshl_add_u32 v1, v61, 4, v1
    s_lshl_b32 s42, s44, 11
    v_lshl_add_u32 v60, v60, 4, s42
    s_mov_b32 s34, 0xbdd2d3e8
    s_mov_b32 s35, 0xc0135761
    s_mul_i32 s21, s44, 131072
    s_add_u32 s21, s21, s31
    s_add_u32 s21, s21, 1048576
    s_add_u32 s22, s21, 131072
    s_and_b32 s20, s45, 3
    s_lshl_b32 s20, s20, 1
    s_lshr_b32 s42, s45, 2
    s_add_u32 s20, s20, s42
    s_mul_i32 s20, s20, 16384
    s_add_u32 s20, s20, s21
    s_lshl_b32 s23, s48, 3
    s_add_u32 s23, s23, s44
    s_lshl_b32 s23, s23, 11
    s_add_u32 s23, s23, s31
    s_add_u32 s23, s23, 1572864
    v_mov_b64 v[4:5], v[124:125]
    v_mov_b64 v[6:7], v[126:127]
    v_lshlrev_b32 v64, 16, v120
    v_and_b32 v65, 0xffff0000, v120
    v_lshlrev_b32 v66, 16, v121
    v_and_b32 v67, 0xffff0000, v121
    v_lshlrev_b32 v68, 16, v122
    v_and_b32 v69, 0xffff0000, v122
    v_lshlrev_b32 v70, 16, v123
    v_and_b32 v71, 0xffff0000, v123
    v_mov_b64 v[72:73], 0
    v_mov_b64 v[74:75], 0
    v_mov_b64 v[76:77], 0
    v_mov_b64 v[78:79], 0
    v_lshlrev_b32 v96, 16, v120
    v_and_b32 v97, 0xffff0000, v120
    v_lshlrev_b32 v98, 16, v121
    v_and_b32 v99, 0xffff0000, v121
    v_lshlrev_b32 v100, 16, v122
    v_and_b32 v101, 0xffff0000, v122
    v_lshlrev_b32 v102, 16, v123
    v_and_b32 v103, 0xffff0000, v123
    v_mov_b64 v[104:105], 0
    v_mov_b64 v[106:107], 0
    v_mov_b64 v[108:109], 0
    v_mov_b64 v[110:111], 0
    s_waitcnt vmcnt(12)
    ds_read_b64_tr_b16 v[248:249], v2 offset:22528
    ds_read_b64_tr_b16 v[250:251], v2 offset:23040
    ds_read_b64_tr_b16 v[252:253], v3 offset:22528
    ds_read_b64_tr_b16 v[254:255], v3 offset:23040
    s_cmp_eq_u32 s49, 7
    s_cbranch_scc1 .Lidle0
.Lpoll6:
    s_load_dwordx4 s[60:63], s[4:5], s57 glc
    s_load_dwordx4 s[64:67], s[4:5], s57 offset:128 glc
    s_addk_i32 s59, 0x2000
    s_cbranch_scc1 .Lend
.Lpoll6_chk:
    s_waitcnt lgkmcnt(0)
    s_xor_b64 s[60:61], s[60:61], s[32:33]
    s_xor_b64 s[62:63], s[62:63], s[32:33]
    s_xor_b64 s[64:65], s[64:65], s[32:33]
    s_xor_b64 s[66:67], s[66:67], s[32:33]
    s_or_b64 s[60:61], s[60:61], s[62:63]
    s_or_b64 s[64:65], s[64:65], s[66:67]
    s_or_b64 s[60:61], s[60:61], s[64:65]
    s_cbranch_scc1 .Lpoll6
    s_add_u32 s57, s57, 16
    buffer_load_dwordx4 v[24:27], v1, s[4:7], s20 offen offset:0 sc1
    buffer_load_dwordx4 v[28:31], v1, s[4:7], s20 offen offset:2048 sc1
    s_addk_i32 s20, 4096
    buffer_load_dwordx4 v[32:35], v1, s[4:7], s20 offen offset:0 sc1
    buffer_load_dwordx4 v[36:39], v1, s[4:7], s20 offen offset:2048 sc1
    s_addk_i32 s20, 12288
    s_cmp_eq_u32 s20, s22
    s_cselect_b32 s20, s21, s20
    buffer_load_dwordx4 v[40:43], v1, s[4:7], s20 offen offset:0 sc1
    buffer_load_dwordx4 v[44:47], v1, s[4:7], s20 offen offset:2048 sc1
    s_addk_i32 s20, 4096
    buffer_load_dwordx4 v[48:51], v1, s[4:7], s20 offen offset:0 sc1
    buffer_load_dwordx4 v[52:55], v1, s[4:7], s20 offen offset:2048 sc1
    s_addk_i32 s20, 12288
    s_cmp_eq_u32 s20, s22
    s_cselect_b32 s20, s21, s20
    buffer_load_dwordx4 v[56:59], v1, s[4:7], s20 offen offset:0 sc1
    s_branch .Lpage15
.p2alignl 12, 0xbf810000
.Lpage15:
    s_waitcnt vmcnt(8)
    v_mfma_f32_32x32x16_bf16 v[80:95], a[4:7], v[24:27], 0
    v_mfma_f32_32x32x16_bf16 v[64:79], a[0:3], v[24:27], v[64:79]
    buffer_load_dwordx4 v[24:27], v1, s[4:7], s20 offen offset:2048 sc1
    s_waitcnt vmcnt(8)
    v_mfma_f32_32x32x16_bf16 v[80:95], a[12:15], v[28:31], v[80:95]
    s_addk_i32 s20, 4096
    v_mfma_f32_32x32x16_bf16 v[64:79], a[8:11], v[28:31], v[64:79]
    buffer_load_dwordx4 v[28:31], v1, s[4:7], s20 offen offset:0 sc1
    s_waitcnt vmcnt(8)
    v_mfma_f32_32x32x16_bf16 v[80:95], a[20:23], v[32:35], v[80:95]
    v_mfma_f32_32x32x16_bf16 v[64:79], a[16:19], v[32:35], v[64:79]
    buffer_load_dwordx4 v[32:35], v1, s[4:7], s20 offen offset:2048 sc1
    s_waitcnt vmcnt(8)
    v_mfma_f32_32x32x16_bf16 v[80:95], a[28:31], v[36:39], v[80:95]
    s_addk_i32 s20, 12288
    s_cmp_eq_u32 s20, s22
    s_cselect_b32 s20, s21, s20
    v_mfma_f32_32x32x16_bf16 v[64:79], a[24:27], v[36:39], v[64:79]
    buffer_load_dwordx4 v[36:39], v1, s[4:7], s20 offen offset:0 sc1
    s_waitcnt vmcnt(8)
    v_mfma_f32_32x32x16_bf16 v[80:95], a[36:39], v[40:43], v[80:95]
    v_mfma_f32_32x32x16_bf16 v[64:79], a[32:35], v[40:43], v[64:79]
    buffer_load_dwordx4 v[40:43], v1, s[4:7], s20 offen offset:2048 sc1
    s_waitcnt vmcnt(8)
    v_mfma_f32_32x32x16_bf16 v[80:95], a[44:47], v[44:47], v[80:95]
    s_addk_i32 s20, 4096
    v_mfma_f32_32x32x16_bf16 v[64:79], a[40:43], v[44:47], v[64:79]
    buffer_load_dwordx4 v[44:47], v1, s[4:7], s20 offen offset:0 sc1
    s_waitcnt vmcnt(8)
    v_mfma_f32_32x32x16_bf16 v[80:95], a[52:55], v[48:51], v[80:95]
    v_mfma_f32_32x32x16_bf16 v[64:79], a[48:51], v[48:51], v[64:79]
    buffer_load_dwordx4 v[48:51], v1, s[4:7], s20 offen offset:2048 sc1
    s_waitcnt vmcnt(8)
    v_mfma_f32_32x32x16_bf16 v[80:95], a[60:63], v[52:55], v[80:95]
    s_addk_i32 s20, 12288
    s_cmp_eq_u32 s20, s22
    s_cselect_b32 s20, s21, s20
    v_mfma_f32_32x32x16_bf16 v[64:79], a[56:59], v[52:55], v[64:79]
    buffer_load_dwordx4 v[52:55], v1, s[4:7], s20 offen offset:0 sc1
    s_waitcnt vmcnt(8)
    v_mfma_f32_32x32x16_bf16 v[80:95], a[68:71], v[56:59], v[80:95]
    v_mfma_f32_32x32x16_bf16 v[64:79], a[64:67], v[56:59], v[64:79]
    buffer_load_dwordx4 v[56:59], v1, s[4:7], s20 offen offset:2048 sc1
    s_waitcnt vmcnt(8)
    v_mfma_f32_32x32x16_bf16 v[80:95], a[76:79], v[24:27], v[80:95]
    s_addk_i32 s20, 4096
    v_mfma_f32_32x32x16_bf16 v[64:79], a[72:75], v[24:27], v[64:79]
    buffer_load_dwordx4 v[24:27], v1, s[4:7], s20 offen offset:0 sc1
    s_waitcnt vmcnt(8)
    v_mfma_f32_32x32x16_bf16 v[80:95], a[84:87], v[28:31], v[80:95]
    v_mfma_f32_32x32x16_bf16 v[64:79], a[80:83], v[28:31], v[64:79]
    buffer_load_dwordx4 v[28:31], v1, s[4:7], s20 offen offset:2048 sc1
    s_waitcnt vmcnt(8)
    v_mfma_f32_32x32x16_bf16 v[80:95], a[92:95], v[32:35], v[80:95]
    s_addk_i32 s20, 12288
    s_cmp_eq_u32 s20, s22
    s_cselect_b32 s20, s21, s20
    v_mfma_f32_32x32x16_bf16 v[64:79], a[88:91], v[32:35], v[64:79]
    buffer_load_dwordx4 v[32:35], v1, s[4:7], s20 offen offset:0 sc1
    s_waitcnt vmcnt(8)
    v_mfma_f32_32x32x16_bf16 v[80:95], a[100:103], v[36:39], v[80:95]
    v_mfma_f32_32x32x16_bf16 v[64:79], a[96:99], v[36:39], v[64:79]
    buffer_load_dwordx4 v[36:39], v1, s[4:7], s20 offen offset:2048 sc1
    s_waitcnt vmcnt(8)
    v_mfma_f32_32x32x16_bf16 v[80:95], a[108:111], v[40:43], v[80:95]
    s_addk_i32 s20, 4096
    v_mfma_f32_32x32x16_bf16 v[64:79], a[104:107], v[40:43], v[64:79]
    buffer_load_dwordx4 v[40:43], v1, s[4:7], s20 offen offset:0 sc1
    s_waitcnt vmcnt(8)
    v_mfma_f32_32x32x16_bf16 v[80:95], a[116:119], v[44:47], v[80:95]
    v_mfma_f32_32x32x16_bf16 v[64:79], a[112:115], v[44:47], v[64:79]
    buffer_load_dwordx4 v[44:47], v1, s[4:7], s20 offen offset:2048 sc1
    s_waitcnt vmcnt(8)
    v_mfma_f32_32x32x16_bf16 v[80:95], a[124:127], v[48:51], v[80:95]
    s_addk_i32 s20, 12288
    s_cmp_eq_u32 s20, s22
    s_cselect_b32 s20, s21, s20
    v_mfma_f32_32x32x16_bf16 v[64:79], a[120:123], v[48:51], v[64:79]
    buffer_load_dwordx4 v[48:51], v1, s[4:7], s20 offen offset:0 sc1
    s_waitcnt vmcnt(8)
    v_mfma_f32_32x32x16_bf16 v[80:95], a[132:135], v[52:55], v[80:95]
    v_mfma_f32_32x32x16_bf16 v[64:79], a[128:131], v[52:55], v[64:79]
    buffer_load_dwordx4 v[52:55], v1, s[4:7], s20 offen offset:2048 sc1
    s_waitcnt vmcnt(8)
    v_mfma_f32_32x32x16_bf16 v[80:95], a[140:143], v[56:59], v[80:95]
    s_addk_i32 s20, 4096
    v_mfma_f32_32x32x16_bf16 v[64:79], a[136:139], v[56:59], v[64:79]
    buffer_load_dwordx4 v[56:59], v1, s[4:7], s20 offen offset:0 sc1
    s_waitcnt vmcnt(8)
    v_mfma_f32_32x32x16_bf16 v[80:95], a[148:151], v[24:27], v[80:95]
    v_mfma_f32_32x32x16_bf16 v[64:79], a[144:147], v[24:27], v[64:79]
    buffer_load_dwordx4 v[24:27], v1, s[4:7], s20 offen offset:2048 sc1
    s_waitcnt vmcnt(8)
    v_mfma_f32_32x32x16_bf16 v[80:95], a[156:159], v[28:31], v[80:95]
    s_addk_i32 s20, 12288
    s_cmp_eq_u32 s20, s22
    s_cselect_b32 s20, s21, s20
    v_mfma_f32_32x32x16_bf16 v[64:79], a[152:155], v[28:31], v[64:79]
    buffer_load_dwordx4 v[28:31], v1, s[4:7], s20 offen offset:0 sc1
    s_waitcnt vmcnt(8)
    v_mfma_f32_32x32x16_bf16 v[80:95], a[164:167], v[32:35], v[80:95]
    v_mfma_f32_32x32x16_bf16 v[64:79], a[160:163], v[32:35], v[64:79]
    buffer_load_dwordx4 v[32:35], v1, s[4:7], s20 offen offset:2048 sc1
    s_waitcnt vmcnt(8)
    v_mfma_f32_32x32x16_bf16 v[80:95], a[172:175], v[36:39], v[80:95]
    s_addk_i32 s20, 4096
    v_mfma_f32_32x32x16_bf16 v[64:79], a[168:171], v[36:39], v[64:79]
    buffer_load_dwordx4 v[36:39], v1, s[4:7], s20 offen offset:0 sc1
    s_waitcnt vmcnt(8)
    v_mfma_f32_32x32x16_bf16 v[80:95], a[180:183], v[40:43], v[80:95]
    v_mfma_f32_32x32x16_bf16 v[64:79], a[176:179], v[40:43], v[64:79]
    buffer_load_dwordx4 v[40:43], v1, s[4:7], s20 offen offset:2048 sc1
    s_waitcnt vmcnt(8)
    v_mfma_f32_32x32x16_bf16 v[80:95], a[188:191], v[44:47], v[80:95]
    s_addk_i32 s20, 12288
    s_cmp_eq_u32 s20, s22
    s_cselect_b32 s20, s21, s20
    v_mfma_f32_32x32x16_bf16 v[64:79], a[184:187], v[44:47], v[64:79]
    buffer_load_dwordx4 v[44:47], v1, s[4:7], s20 offen offset:512 sc1
    s_waitcnt vmcnt(8)
    v_mfma_f32_32x32x16_bf16 v[80:95], a[196:199], v[48:51], v[80:95]
    v_mfma_f32_32x32x16_bf16 v[64:79], a[192:195], v[48:51], v[64:79]
    buffer_load_dwordx4 v[48:51], v1, s[4:7], s20 offen offset:2560 sc1
    s_waitcnt vmcnt(8)
    v_mfma_f32_32x32x16_bf16 v[80:95], a[204:207], v[52:55], v[80:95]
    s_addk_i32 s20, 4096
    v_mfma_f32_32x32x16_bf16 v[64:79], a[200:203], v[52:55], v[64:79]
    buffer_load_dwordx4 v[52:55], v1, s[4:7], s20 offen offset:512 sc1
    s_waitcnt vmcnt(8)
    v_mfma_f32_32x32x16_bf16 v[80:95], a[212:215], v[56:59], v[80:95]
    v_mfma_f32_32x32x16_bf16 v[64:79], a[208:211], v[56:59], v[64:79]
    buffer_load_dwordx4 v[56:59], v1, s[4:7], s20 offen offset:2560 sc1
    s_waitcnt vmcnt(8)
    v_mfma_f32_32x32x16_bf16 v[80:95], a[220:223], v[24:27], v[80:95]
    s_addk_i32 s20, 12288
    s_cmp_eq_u32 s20, s22
    s_cselect_b32 s20, s21, s20
    v_mfma_f32_32x32x16_bf16 v[64:79], a[216:219], v[24:27], v[64:79]
    buffer_load_dwordx4 v[24:27], v1, s[4:7], s20 offen offset:512 sc1
    s_waitcnt vmcnt(8)
    v_mfma_f32_32x32x16_bf16 v[80:95], a[228:231], v[28:31], v[80:95]
    v_mfma_f32_32x32x16_bf16 v[64:79], a[224:227], v[28:31], v[64:79]
    buffer_load_dwordx4 v[28:31], v1, s[4:7], s20 offen offset:2560 sc1
    s_waitcnt vmcnt(8)
    v_mfma_f32_32x32x16_bf16 v[80:95], a[236:239], v[32:35], v[80:95]
    s_addk_i32 s20, 4096
    v_mfma_f32_32x32x16_bf16 v[64:79], a[232:235], v[32:35], v[64:79]
    buffer_load_dwordx4 v[32:35], v1, s[4:7], s20 offen offset:512 sc1
    s_waitcnt vmcnt(8)
    v_mfma_f32_32x32x16_bf16 v[80:95], a[244:247], v[36:39], v[80:95]
    v_mfma_f32_32x32x16_bf16 v[64:79], a[240:243], v[36:39], v[64:79]
    buffer_load_dwordx4 v[36:39], v1, s[4:7], s20 offen offset:2560 sc1
    s_waitcnt vmcnt(8)
    v_mfma_f32_32x32x16_bf16 v[80:95], a[252:255], v[40:43], v[80:95]
    s_addk_i32 s20, 12288
    s_cmp_eq_u32 s20, s22
    s_cselect_b32 s20, s21, s20
    v_mfma_f32_32x32x16_bf16 v[64:79], a[248:251], v[40:43], v[64:79]
    buffer_load_dwordx4 v[40:43], v1, s[4:7], s20 offen offset:512 sc1
    s_waitcnt vmcnt(8)
    v_mfma_f32_32x32x16_bf16 v[112:127], a[4:7], v[44:47], 0
    v_mfma_f32_32x32x16_bf16 v[96:111], a[0:3], v[44:47], v[96:111]
    buffer_load_dwordx4 v[44:47], v1, s[4:7], s20 offen offset:2560 sc1
    s_waitcnt vmcnt(8)
    v_mfma_f32_32x32x16_bf16 v[112:127], a[12:15], v[48:51], v[112:127]
    s_addk_i32 s20, 4096
    v_mfma_f32_32x32x16_bf16 v[96:111], a[8:11], v[48:51], v[96:111]
    buffer_load_dwordx4 v[48:51], v1, s[4:7], s20 offen offset:512 sc1
    v_xor_b32 v61, 6144, v60
    s_waitcnt vmcnt(8)
    v_mfma_f32_32x32x16_bf16 v[112:127], a[20:23], v[52:55], v[112:127]
    ds_write_b128 v61, v[88:91] offset:24704
    v_mfma_f32_32x32x16_bf16 v[96:111], a[16:19], v[52:55], v[96:111]
    buffer_load_dwordx4 v[52:55], v1, s[4:7], s20 offen offset:2560 sc1
    ds_write_b128 v61, v[92:95] offset:25728
    s_waitcnt vmcnt(8)
    v_mfma_f32_32x32x16_bf16 v[112:127], a[28:31], v[56:59], v[112:127]
    s_addk_i32 s20, 12288
    s_cmp_eq_u32 s20, s22
    s_cselect_b32 s20, s21, s20
    v_xor_b32 v61, 4096, v60
    v_mfma_f32_32x32x16_bf16 v[96:111], a[24:27], v[56:59], v[96:111]
    buffer_load_dwordx4 v[56:59], v1, s[4:7], s20 offen offset:512 sc1
    ds_write_b128 v61, v[80:83] offset:16512
    s_waitcnt vmcnt(8)
    v_mfma_f32_32x32x16_bf16 v[112:127], a[36:39], v[24:27], v[112:127]
    ds_write_b128 v61, v[84:87] offset:17536
    v_mfma_f32_32x32x16_bf16 v[96:111], a[32:35], v[24:27], v[96:111]
    buffer_load_dwordx4 v[24:27], v1, s[4:7], s20 offen offset:2560 sc1
    v_xor_b32 v61, 2048, v60
    ds_write_b128 v61, v[72:75] offset:8320
    s_waitcnt vmcnt(8)
    v_mfma_f32_32x32x16_bf16 v[112:127], a[44:47], v[28:31], v[112:127]
    s_addk_i32 s20, 4096
    v_mfma_f32_32x32x16_bf16 v[96:111], a[40:43], v[28:31], v[96:111]
    buffer_load_dwordx4 v[28:31], v1, s[4:7], s20 offen offset:512 sc1
    ds_write_b128 v61, v[76:79] offset:9344
    s_waitcnt vmcnt(8)
    v_mfma_f32_32x32x16_bf16 v[112:127], a[52:55], v[32:35], v[112:127]
    v_mfma_f32_32x32x16_bf16 v[96:111], a[48:51], v[32:35], v[96:111]
    buffer_load_dwordx4 v[32:35], v1, s[4:7], s20 offen offset:2560 sc1
    s_waitcnt lgkmcnt(0)
    s_barrier
    ds_read_b128 v[72:75], v60 offset:8320
    ds_read_b128 v[76:79], v60 offset:9344
    s_waitcnt vmcnt(8)
    v_mfma_f32_32x32x16_bf16 v[112:127], a[60:63], v[36:39], v[112:127]
    s_addk_i32 s20, 12288
    s_cmp_eq_u32 s20, s22
    s_cselect_b32 s20, s21, s20
    ds_read_b128 v[80:83], v60 offset:16512
    ds_read_b128 v[84:87], v60 offset:17536
    ds_read_b128 v[88:91], v60 offset:24704
    v_mfma_f32_32x32x16_bf16 v[96:111], a[56:59], v[36:39], v[96:111]
    buffer_load_dwordx4 v[36:39], v1, s[4:7], s20 offen offset:512 sc1
    ds_read_b128 v[92:95], v60 offset:25728
    s_waitcnt vmcnt(8)
    v_mfma_f32_32x32x16_bf16 v[112:127], a[68:71], v[40:43], v[112:127]
    s_waitcnt lgkmcnt(4)
    v_add_f32 v64, v64, v72
    v_add_f32 v65, v65, v73
    v_add_f32 v66, v66, v74
    v_add_f32 v67, v67, v75
    v_add_f32 v68, v68, v76
    v_add_f32 v69, v69, v77
    v_mfma_f32_32x32x16_bf16 v[96:111], a[64:67], v[40:43], v[96:111]
    buffer_load_dwordx4 v[40:43], v1, s[4:7], s20 offen offset:2560 sc1
    v_add_f32 v70, v70, v78
    v_add_f32 v71, v71, v79
    s_waitcnt lgkmcnt(2)
    v_add_f32 v64, v64, v80
    v_add_f32 v65, v65, v81
    s_waitcnt vmcnt(8)
    v_mfma_f32_32x32x16_bf16 v[112:127], a[76:79], v[44:47], v[112:127]
    s_addk_i32 s20, 4096
    v_add_f32 v66, v66, v82
    v_add_f32 v67, v67, v83
    v_add_f32 v68, v68, v84
    v_add_f32 v69, v69, v85
    v_add_f32 v70, v70, v86
    v_add_f32 v71, v71, v87
    v_mfma_f32_32x32x16_bf16 v[96:111], a[72:75], v[44:47], v[96:111]
    buffer_load_dwordx4 v[44:47], v1, s[4:7], s20 offen offset:512 sc1
    s_waitcnt lgkmcnt(0)
    v_add_f32 v64, v64, v88
    v_add_f32 v65, v65, v89
    v_add_f32 v66, v66, v90
    v_add_f32 v67, v67, v91
    s_waitcnt vmcnt(8)
    v_mfma_f32_32x32x16_bf16 v[112:127], a[84:87], v[48:51], v[112:127]
    v_add_f32 v68, v68, v92
    v_add_f32 v69, v69, v93
    v_add_f32 v70, v70, v94
    v_add_f32 v71, v71, v95
    v_mov_b32 v80, s35
    v_mfma_f32_32x32x16_bf16 v[96:111], a[80:83], v[48:51], v[96:111]
    buffer_load_dwordx4 v[48:51], v1, s[4:7], s20 offen offset:2560 sc1
    v_mul_f32 v72, v64, v64
    v_mul_f32 v73, v65, v65
    v_mul_f32 v74, v66, v66
    v_mul_f32 v75, v67, v67
    s_waitcnt vmcnt(8)
    v_mfma_f32_32x32x16_bf16 v[112:127], a[92:95], v[52:55], v[112:127]
    s_addk_i32 s20, 12288
    s_cmp_eq_u32 s20, s22
    s_cselect_b32 s20, s21, s20
    v_mul_f32 v76, v68, v68
    v_mul_f32 v77, v69, v69
    v_mul_f32 v78, v70, v70
    v_mfma_f32_32x32x16_bf16 v[96:111], a[88:91], v[52:55], v[96:111]
    buffer_load_dwordx4 v[52:55], v1, s[4:7], s20 offen offset:512 sc1
    v_mul_f32 v79, v71, v71
    v_fma_f32 v72, v72, s34, v80
    v_fma_f32 v73, v73, s34, v80
    v_fma_f32 v74, v74, s34, v80
    s_waitcnt vmcnt(8)
    v_mfma_f32_32x32x16_bf16 v[112:127], a[100:103], v[56:59], v[112:127]
    v_fma_f32 v75, v75, s34, v80
    v_fma_f32 v76, v76, s34, v80
    v_fma_f32 v77, v77, s34, v80
    v_fma_f32 v78, v78, s34, v80
    v_fma_f32 v79, v79, s34, v80
    v_mul_f32 v72, v72, v64
    v_mul_f32 v73, v73, v65
    v_mfma_f32_32x32x16_bf16 v[96:111], a[96:99], v[56:59], v[96:111]
    buffer_load_dwordx4 v[56:59], v1, s[4:7], s20 offen offset:2560 sc1
    v_mul_f32 v74, v74, v66
    v_mul_f32 v75, v75, v67
    v_mul_f32 v76, v76, v68
    v_mul_f32 v77, v77, v69
    s_waitcnt vmcnt(8)
    v_mfma_f32_32x32x16_bf16 v[112:127], a[108:111], v[24:27], v[112:127]
    s_addk_i32 s20, 4096
    v_mul_f32 v78, v78, v70
    v_mul_f32 v79, v79, v71
    v_exp_f32 v72, v72
    v_mfma_f32_32x32x16_bf16 v[96:111], a[104:107], v[24:27], v[96:111]
    buffer_load_dwordx4 v[24:27], v1, s[4:7], s20 offen offset:512 sc1
    v_exp_f32 v73, v73
    v_exp_f32 v74, v74
    s_waitcnt vmcnt(8)
    v_mfma_f32_32x32x16_bf16 v[112:127], a[116:119], v[28:31], v[112:127]
    v_exp_f32 v75, v75
    v_exp_f32 v76, v76
    v_exp_f32 v77, v77
    v_mfma_f32_32x32x16_bf16 v[96:111], a[112:115], v[28:31], v[96:111]
    buffer_load_dwordx4 v[28:31], v1, s[4:7], s20 offen offset:2560 sc1
    v_exp_f32 v78, v78
    v_exp_f32 v79, v79
    s_waitcnt vmcnt(8)
    v_mfma_f32_32x32x16_bf16 v[112:127], a[124:127], v[32:35], v[112:127]
    s_addk_i32 s20, 12288
    s_cmp_eq_u32 s20, s22
    s_cselect_b32 s20, s21, s20
    v_add_f32 v72, 1.0, v72
    v_add_f32 v73, 1.0, v73
    v_add_f32 v74, 1.0, v74
    v_mfma_f32_32x32x16_bf16 v[96:111], a[120:123], v[32:35], v[96:111]
    buffer_load_dwordx4 v[32:35], v1, s[4:7], s20 offen offset:512 sc1
    v_add_f32 v75, 1.0, v75
    v_add_f32 v76, 1.0, v76
    v_add_f32 v77, 1.0, v77
    v_add_f32 v78, 1.0, v78
    s_waitcnt vmcnt(8)
    v_mfma_f32_32x32x16_bf16 v[112:127], a[132:135], v[36:39], v[112:127]
    v_add_f32 v79, 1.0, v79
    v_rcp_f32 v72, v72
    v_rcp_f32 v73, v73
    v_rcp_f32 v74, v74
    v_mfma_f32_32x32x16_bf16 v[96:111], a[128:131], v[36:39], v[96:111]
    buffer_load_dwordx4 v[36:39], v1, s[4:7], s20 offen offset:2560 sc1
    v_rcp_f32 v75, v75
    v_rcp_f32 v76, v76
    s_waitcnt vmcnt(8)
    v_mfma_f32_32x32x16_bf16 v[112:127], a[140:143], v[40:43], v[112:127]
    s_addk_i32 s20, 4096
    v_rcp_f32 v77, v77
    v_rcp_f32 v78, v78
    v_mfma_f32_32x32x16_bf16 v[96:111], a[136:139], v[40:43], v[96:111]
    buffer_load_dwordx4 v[40:43], v1, s[4:7], s20 offen offset:512 sc1
    v_rcp_f32 v79, v79
    v_mul_f32 v72, v72, v64
    v_mul_f32 v73, v73, v65
    s_waitcnt vmcnt(8)
    v_mfma_f32_32x32x16_bf16 v[112:127], a[148:151], v[44:47], v[112:127]
    v_mul_f32 v74, v74, v66
    v_mul_f32 v75, v75, v67
    v_mul_f32 v76, v76, v68
    v_mul_f32 v77, v77, v69
    v_mul_f32 v78, v78, v70
    v_mul_f32 v79, v79, v71
    v_mfma_f32_32x32x16_bf16 v[96:111], a[144:147], v[44:47], v[96:111]
    buffer_load_dwordx4 v[44:47], v1, s[4:7], s20 offen offset:2560 sc1
    v_cvt_pk_bf16_f32 v80, v72, v73
    v_cvt_pk_bf16_f32 v81, v74, v75
    v_cvt_pk_bf16_f32 v82, v76, v77
    v_cvt_pk_bf16_f32 v83, v78, v79
    s_waitcnt vmcnt(8)
    v_mfma_f32_32x32x16_bf16 v[112:127], a[156:159], v[48:51], v[112:127]
    s_addk_i32 s20, 12288
    s_cmp_eq_u32 s20, s22
    s_cselect_b32 s20, s21, s20
    s_add_u32 s43, s53, 983040
    s_sub_u32 s41, s43, 1835008
    buffer_store_dwordx4 v[80:83], v1, s[4:7], s23 offen offset:0 sc1
    v_mfma_f32_32x32x16_bf16 v[96:111], a[152:155], v[48:51], v[96:111]
    buffer_load_dwordx4 v[48:51], v1, s[4:7], s20 offen offset:512 sc1
    s_add_u32 m0, s55, 10240
    s_cmp_ge_u32 s43, s54
    s_cselect_b32 s43, s41, s43
    v_lshlrev_b32 v64, 16, v4
    s_waitcnt vmcnt(9)
    v_mfma_f32_32x32x16_bf16 v[112:127], a[164:167], v[52:55], v[112:127]
    buffer_load_dwordx4 v62, s[12:15], s43 offen lds
    v_and_b32 v65, 0xffff0000, v4
    v_lshlrev_b32 v66, 16, v5
    v_and_b32 v67, 0xffff0000, v5
    v_lshlrev_b32 v68, 16, v6
    v_and_b32 v69, 0xffff0000, v6
    v_mfma_f32_32x32x16_bf16 v[96:111], a[160:163], v[52:55], v[96:111]
    buffer_load_dwordx4 v[52:55], v1, s[4:7], s20 offen offset:2560 sc1
    buffer_load_dwordx4 v63, s[12:15], s43 offen offset:1024 lds
    v_lshlrev_b32 v70, 16, v7
    v_and_b32 v71, 0xffff0000, v7
    v_lshlrev_b32 v72, 16, v8
    s_waitcnt vmcnt(11)
    v_mfma_f32_32x32x16_bf16 v[112:127], a[172:175], v[56:59], v[112:127]
    s_addk_i32 s20, 4096
    v_and_b32 v73, 0xffff0000, v8
    v_lshlrev_b32 v74, 16, v9
    v_and_b32 v75, 0xffff0000, v9
    v_lshlrev_b32 v76, 16, v10
    v_and_b32 v77, 0xffff0000, v10
    v_mfma_f32_32x32x16_bf16 v[96:111], a[168:171], v[56:59], v[96:111]
    buffer_load_dwordx4 v[56:59], v1, s[4:7], s20 offen offset:512 sc1
    v_lshlrev_b32 v78, 16, v11
    v_and_b32 v79, 0xffff0000, v11
    v_add_f32 v64, v64, v72
    v_add_f32 v65, v65, v73
    s_waitcnt vmcnt(11)
    v_mfma_f32_32x32x16_bf16 v[112:127], a[180:183], v[24:27], v[112:127]
    s_add_u32 s43, s53, 1114112
    s_sub_u32 s41, s43, 1835008
    v_add_f32 v66, v66, v74
    v_add_f32 v67, v67, v75
    v_add_f32 v68, v68, v76
    v_add_f32 v69, v69, v77
    v_mfma_f32_32x32x16_bf16 v[96:111], a[176:179], v[24:27], v[96:111]
    buffer_load_dwordx4 v[24:27], v1, s[4:7], s20 offen offset:2560 sc1
    s_add_u32 m0, s55, 12288
    s_cmp_ge_u32 s43, s54
    s_cselect_b32 s43, s41, s43
    v_add_f32 v70, v70, v78
    v_add_f32 v71, v71, v79
    s_waitcnt vmcnt(11)
    v_mfma_f32_32x32x16_bf16 v[112:127], a[188:191], v[28:31], v[112:127]
    s_addk_i32 s20, 12288
    s_cmp_eq_u32 s20, s22
    s_cselect_b32 s20, s21, s20
    buffer_load_dwordx4 v62, s[12:15], s43 offen lds
    v_mov_b32 v72, 0
    v_mov_b32 v73, 0
    v_mfma_f32_32x32x16_bf16 v[96:111], a[184:187], v[28:31], v[96:111]
    buffer_load_dwordx4 v63, s[12:15], s43 offen offset:1024 lds
    v_mov_b32 v74, 0
    v_mov_b32 v75, 0
    v_mov_b32 v76, 0
    v_mov_b32 v77, 0
    s_waitcnt vmcnt(12)
    v_mfma_f32_32x32x16_bf16 v[112:127], a[196:199], v[32:35], v[112:127]
    v_mov_b32 v78, 0
    v_mov_b32 v79, 0
    v_mbcnt_lo_u32_b32 v88, -1, 0
    v_mbcnt_hi_u32_b32 v88, -1, v88
    v_lshlrev_b32 v88, 10, v88
    v_mov_b32 v89, s47
    v_mfma_f32_32x32x16_bf16 v[96:111], a[192:195], v[32:35], v[96:111]
    s_waitcnt vmcnt(11)
    v_mfma_f32_32x32x16_bf16 v[112:127], a[204:207], v[36:39], v[112:127]
    s_add_u32 s43, s53, 1245184
    s_sub_u32 s41, s43, 1835008
    v_mfma_f32_32x32x16_bf16 v[96:111], a[200:203], v[36:39], v[96:111]
    s_add_u32 m0, s55, 14336
    s_cmp_ge_u32 s43, s54
    s_cselect_b32 s43, s41, s43
    s_waitcnt vmcnt(10)
    v_mfma_f32_32x32x16_bf16 v[112:127], a[212:215], v[40:43], v[112:127]
    buffer_load_dwordx4 v62, s[12:15], s43 offen lds
    v_mfma_f32_32x32x16_bf16 v[96:111], a[208:211], v[40:43], v[96:111]
    buffer_load_dwordx4 v63, s[12:15], s43 offen offset:1024 lds
    s_waitcnt vmcnt(11)
    v_mfma_f32_32x32x16_bf16 v[112:127], a[220:223], v[44:47], v[112:127]
    v_mfma_f32_32x32x16_bf16 v[96:111], a[216:219], v[44:47], v[96:111]
    s_waitcnt vmcnt(9)
    v_mfma_f32_32x32x16_bf16 v[112:127], a[228:231], v[48:51], v[112:127]
    s_add_u32 s43, s53, 1376256
    s_sub_u32 s41, s43, 1835008
    s_barrier
    s_mov_b64 exec, 0xff
    buffer_store_dword v89, v88, s[4:7], s56 offen sc1
    s_mov_b64 exec, -1
    s_add_u32 s56, s56, 16
    s_waitcnt vmcnt(8)
    v_mfma_f32_32x32x16_bf16 v[112:127], a[236:239], v[52:55], v[112:127]
    s_add_u32 m0, s55, 16384
    s_cmp_ge_u32 s43, s54
    s_cselect_b32 s43, s41, s43
    s_waitcnt vmcnt(6)
    v_mfma_f32_32x32x16_bf16 v[112:127], a[244:247], v[56:59], v[112:127]
    buffer_load_dwordx4 v62, s[12:15], s43 offen lds
    s_mul_i32 s21, s44, 114688
    s_add_u32 s21, s21, s31
    s_add_u32 s21, s21, 1572864
    s_add_u32 s22, s21, 114688
    s_load_dwordx4 s[60:63], s[4:5], s57 glc
    s_load_dwordx4 s[64:67], s[4:5], s57 offset:128 glc
    s_waitcnt vmcnt(6)
    v_mfma_f32_32x32x16_bf16 v[112:127], a[252:255], v[24:27], v[112:127]
    buffer_load_dwordx4 v63, s[12:15], s43 offen offset:1024 lds
    s_lshl_b32 s20, s58, 12
    s_add_u32 s20, s20, s21
    s_add_u32 s20, s20, 16384
    s_cmp_eq_u32 s20, s22
    s_cselect_b32 s20, s21, s20
    v_mfma_f32_32x32x16_bf16 v[96:111], a[224:227], v[48:51], v[96:111]
    v_xor_b32 v61, 6144, v60
    v_mfma_f32_32x32x16_bf16 v[96:111], a[232:235], v[52:55], v[96:111]
    s_nop 2
    ds_write_b128 v61, v[120:123] offset:49280
    v_mfma_f32_32x32x16_bf16 v[96:111], a[240:243], v[56:59], v[96:111]
    ds_write_b128 v61, v[124:127] offset:50304
    v_mfma_f32_32x32x16_bf16 v[96:111], a[248:251], v[24:27], v[96:111]
    v_xor_b32 v61, 4096, v60
    ds_write_b128 v61, v[112:115] offset:41088
    ds_write_b128 v61, v[116:119] offset:42112
    s_nop 7
    v_xor_b32 v61, 2048, v60
    ds_write_b128 v61, v[104:107] offset:32896
    ds_write_b128 v61, v[108:111] offset:33920
    s_add_u32 s43, s53, 1507328
    s_sub_u32 s41, s43, 1835008
    s_add_u32 m0, s55, 18432
    s_cmp_ge_u32 s43, s54
    s_cselect_b32 s43, s41, s43
    buffer_load_dwordx4 v62, s[12:15], s43 offen lds
    buffer_load_dwordx4 v63, s[12:15], s43 offen offset:1024 lds
    s_add_u32 s43, s53, 1638400
    s_sub_u32 s41, s43, 1835008
    s_add_u32 m0, s55, 20480
    s_cmp_ge_u32 s43, s54
    s_cselect_b32 s43, s41, s43
    buffer_load_dwordx4 v62, s[12:15], s43 offen lds
    buffer_load_dwordx4 v63, s[12:15], s43 offen offset:1024 lds
    s_waitcnt lgkmcnt(0)
    s_barrier
    ds_read_b128 v[104:107], v60 offset:32896
    ds_read_b128 v[108:111], v60 offset:33920
    ds_read_b128 v[112:115], v60 offset:41088
    ds_read_b128 v[116:119], v60 offset:42112
    ds_read_b128 v[120:123], v60 offset:49280
    ds_read_b128 v[124:127], v60 offset:50304
    s_waitcnt lgkmcnt(4)
    v_pk_add_f32 v[96:97], v[96:97], v[104:105]
    v_pk_add_f32 v[98:99], v[98:99], v[106:107]
    v_pk_add_f32 v[100:101], v[100:101], v[108:109]
    v_pk_add_f32 v[102:103], v[102:103], v[110:111]
    s_waitcnt lgkmcnt(2)
    v_pk_add_f32 v[96:97], v[96:97], v[112:113]
    v_pk_add_f32 v[98:99], v[98:99], v[114:115]
    v_pk_add_f32 v[100:101], v[100:101], v[116:117]
    v_pk_add_f32 v[102:103], v[102:103], v[118:119]
    s_waitcnt lgkmcnt(0)
    v_pk_add_f32 v[96:97], v[96:97], v[120:121]
    v_pk_add_f32 v[98:99], v[98:99], v[122:123]
    v_pk_add_f32 v[100:101], v[100:101], v[124:125]
    v_pk_add_f32 v[102:103], v[102:103], v[126:127]
    v_mbcnt_lo_u32_b32 v22, -1, 0
    v_mbcnt_hi_u32_b32 v22, -1, v22
    v_lshlrev_b32 v22, 4, v22
    v_mov_b32 v18, -1
    v_mov_b32 v19, -1
    v_mov_b32 v20, -1
    v_mov_b32 v21, -1
    s_lshl3_add_u32 s40, s46, s44
    s_lshl_b32 s40, s40, 11
    s_add_u32 s40, s40, s31
    s_add_u32 s40, s40, 4194304
    buffer_store_dwordx4 v[18:21], v22, s[4:7], s40 offen offset:0 sc1
    buffer_store_dwordx4 v[18:21], v22, s[4:7], s40 offen offset:1024 sc1
    s_add_u32 s43, s53, 1769472
    s_sub_u32 s41, s43, 1835008
    s_add_u32 m0, s55, 22528
    s_cmp_ge_u32 s43, s54
    s_cselect_b32 s43, s41, s43
    buffer_load_dwordx4 v62, s[12:15], s43 offen lds
    buffer_load_dwordx4 v63, s[12:15], s43 offen offset:1024 lds
    s_branch .Lpoll7_chk
.Lpoll7:
    s_load_dwordx4 s[60:63], s[4:5], s57 glc
    s_load_dwordx4 s[64:67], s[4:5], s57 offset:128 glc
    s_addk_i32 s59, 0x2000
    s_cbranch_scc1 .Lend
.Lpoll7_chk:
    s_waitcnt lgkmcnt(0)
    s_mov_b32 s67, s47
    s_xor_b64 s[60:61], s[60:61], s[32:33]
    s_xor_b64 s[62:63], s[62:63], s[32:33]
    s_xor_b64 s[64:65], s[64:65], s[32:33]
    s_xor_b64 s[66:67], s[66:67], s[32:33]
    s_or_b64 s[60:61], s[60:61], s[62:63]
    s_or_b64 s[64:65], s[64:65], s[66:67]
    s_or_b64 s[60:61], s[60:61], s[64:65]
    s_cbranch_scc1 .Lpoll7
    s_add_u32 s57, s57, 16
    buffer_load_dwordx4 v[28:31], v1, s[4:7], s20 offen offset:0 sc1
    buffer_load_dwordx4 v[32:35], v1, s[4:7], s20 offen offset:2048 sc1
    s_addk_i32 s20, 4096
    buffer_load_dwordx4 v[36:39], v1, s[4:7], s20 offen offset:0 sc1
    buffer_load_dwordx4 v[40:43], v1, s[4:7], s20 offen offset:2048 sc1
    s_addk_i32 s20, 12288
    s_cmp_eq_u32 s20, s22
    s_cselect_b32 s20, s21, s20
    buffer_load_dwordx4 v[44:47], v1, s[4:7], s20 offen offset:0 sc1
    buffer_load_dwordx4 v[48:51], v1, s[4:7], s20 offen offset:2048 sc1
    s_addk_i32 s20, 4096
    buffer_load_dwordx4 v[52:55], v1, s[4:7], s20 offen offset:0 sc1
    buffer_load_dwordx4 v[56:59], v1, s[4:7], s20 offen offset:2048 sc1
    s_addk_i32 s20, 12288
    s_cmp_eq_u32 s20, s22
    s_cselect_b32 s20, s21, s20
    v_pk_mul_f32 v[104:105], v[96:97], v[96:97]
    v_pk_mul_f32 v[106:107], v[98:99], v[98:99]
    v_pk_mul_f32 v[108:109], v[100:101], v[100:101]
    v_pk_mul_f32 v[110:111], v[102:103], v[102:103]
    v_pk_fma_f32 v[104:105], v[104:105], s[34:35], s[34:35] op_sel:[0,0,1] op_sel_hi:[1,0,1]
    v_pk_fma_f32 v[106:107], v[106:107], s[34:35], s[34:35] op_sel:[0,0,1] op_sel_hi:[1,0,1]
    v_pk_fma_f32 v[108:109], v[108:109], s[34:35], s[34:35] op_sel:[0,0,1] op_sel_hi:[1,0,1]
    v_pk_fma_f32 v[110:111], v[110:111], s[34:35], s[34:35] op_sel:[0,0,1] op_sel_hi:[1,0,1]
    v_pk_mul_f32 v[104:105], v[104:105], v[96:97]
    v_pk_mul_f32 v[106:107], v[106:107], v[98:99]
    v_pk_mul_f32 v[108:109], v[108:109], v[100:101]
    v_pk_mul_f32 v[110:111], v[110:111], v[102:103]
    v_exp_f32 v104, v104
    v_exp_f32 v105, v105
    v_exp_f32 v106, v106
    v_exp_f32 v107, v107
    v_exp_f32 v108, v108
    v_exp_f32 v109, v109
    v_exp_f32 v110, v110
    v_exp_f32 v111, v111
    v_pk_add_f32 v[104:105], v[104:105], 1.0 op_sel_hi:[1,0]
    v_pk_add_f32 v[106:107], v[106:107], 1.0 op_sel_hi:[1,0]
    v_pk_add_f32 v[108:109], v[108:109], 1.0 op_sel_hi:[1,0]
    v_pk_add_f32 v[110:111], v[110:111], 1.0 op_sel_hi:[1,0]
    v_rcp_f32 v104, v104
    v_rcp_f32 v105, v105
    v_rcp_f32 v106, v106
    v_rcp_f32 v107, v107
    v_rcp_f32 v108, v108
    v_rcp_f32 v109, v109
    v_rcp_f32 v110, v110
    v_rcp_f32 v111, v111
    v_pk_mul_f32 v[104:105], v[104:105], v[96:97]
    v_pk_mul_f32 v[106:107], v[106:107], v[98:99]
    v_pk_mul_f32 v[108:109], v[108:109], v[100:101]
    v_pk_mul_f32 v[110:111], v[110:111], v[102:103]
    v_cvt_pk_bf16_f32 v112, v104, v105
    v_cvt_pk_bf16_f32 v113, v106, v107
    v_cvt_pk_bf16_f32 v114, v108, v109
    v_cvt_pk_bf16_f32 v115, v110, v111
    buffer_store_dwordx4 v[112:115], v1, s[4:7], s23 offen offset:512 sc1
    s_branch .Lpage13
.p2alignl 12, 0xbf810000
.Lpage13:
.Lg2_0:
    buffer_load_dwordx4 v[24:27], v1, s[4:7], s20 offen offset:0 sc1
    ds_read_b64_tr_b16 v[20:21], v3 offset:0
    ds_read_b64_tr_b16 v[22:23], v3 offset:512
    ds_read_b64_tr_b16 v[16:17], v2 offset:0
    ds_read_b64_tr_b16 v[18:19], v2 offset:512
    s_waitcnt vmcnt(9)
    v_mfma_f32_32x32x16_bf16 v[80:95], v[164:167], v[28:31], 0
    v_mbcnt_lo_u32_b32 v120, -1, 0
    v_mbcnt_hi_u32_b32 v120, -1, v120
    v_lshlrev_b32 v120, 10, v120
    v_mov_b32 v121, s47
    v_mfma_f32_32x32x16_bf16 v[64:79], v[160:163], v[28:31], v[64:79]
    buffer_load_dwordx4 v[28:31], v1, s[4:7], s20 offen offset:2048 sc1
    s_waitcnt vmcnt(9) lgkmcnt(2)
    v_mfma_f32_32x32x16_bf16 v[80:95], v[20:23], v[32:35], v[80:95]
    s_addk_i32 s20, 4096
    ds_read_b64_tr_b16 v[20:21], v3 offset:2048
    ds_read_b64_tr_b16 v[22:23], v3 offset:2560
    s_waitcnt lgkmcnt(2)
    v_mfma_f32_32x32x16_bf16 v[64:79], v[16:19], v[32:35], v[64:79]
    ds_read_b64_tr_b16 v[16:17], v2 offset:2048
    ds_read_b64_tr_b16 v[18:19], v2 offset:2560
    buffer_load_dwordx4 v[32:35], v1, s[4:7], s20 offen offset:0 sc1
    s_waitcnt vmcnt(9)
    v_mfma_f32_32x32x16_bf16 v[80:95], v[172:175], v[36:39], v[80:95]
    v_mfma_f32_32x32x16_bf16 v[64:79], v[168:171], v[36:39], v[64:79]
    buffer_load_dwordx4 v[36:39], v1, s[4:7], s20 offen offset:2048 sc1
    s_waitcnt vmcnt(9) lgkmcnt(2)
    v_mfma_f32_32x32x16_bf16 v[80:95], v[20:23], v[40:43], v[80:95]
    s_addk_i32 s20, 12288
    s_cmp_eq_u32 s20, s22
    s_cselect_b32 s20, s21, s20
    ds_read_b64_tr_b16 v[20:21], v3 offset:4096
    ds_read_b64_tr_b16 v[22:23], v3 offset:4608
    s_waitcnt lgkmcnt(2)
    v_mfma_f32_32x32x16_bf16 v[64:79], v[16:19], v[40:43], v[64:79]
    ds_read_b64_tr_b16 v[16:17], v2 offset:4096
    ds_read_b64_tr_b16 v[18:19], v2 offset:4608
    buffer_load_dwordx4 v[40:43], v1, s[4:7], s20 offen offset:0 sc1
    s_waitcnt vmcnt(9)
    v_mfma_f32_32x32x16_bf16 v[80:95], v[180:183], v[44:47], v[80:95]
    v_mfma_f32_32x32x16_bf16 v[64:79], v[176:179], v[44:47], v[64:79]
    buffer_load_dwordx4 v[44:47], v1, s[4:7], s20 offen offset:2048 sc1
    s_waitcnt vmcnt(9) lgkmcnt(2)
    v_mfma_f32_32x32x16_bf16 v[80:95], v[20:23], v[48:51], v[80:95]
    s_addk_i32 s20, 4096
    ds_read_b64_tr_b16 v[20:21], v3 offset:6144
    ds_read_b64_tr_b16 v[22:23], v3 offset:6656
    s_waitcnt lgkmcnt(2)
    v_mfma_f32_32x32x16_bf16 v[64:79], v[16:19], v[48:51], v[64:79]
    ds_read_b64_tr_b16 v[16:17], v2 offset:6144
    ds_read_b64_tr_b16 v[18:19], v2 offset:6656
    buffer_load_dwordx4 v[48:51], v1, s[4:7], s20 offen offset:0 sc1
    s_waitcnt vmcnt(9)
    v_mfma_f32_32x32x16_bf16 v[80:95], v[188:191], v[52:55], v[80:95]
    v_mfma_f32_32x32x16_bf16 v[64:79], v[184:187], v[52:55], v[64:79]
    buffer_load_dwordx4 v[52:55], v1, s[4:7], s20 offen offset:2048 sc1
    s_waitcnt vmcnt(9) lgkmcnt(2)
    v_mfma_f32_32x32x16_bf16 v[80:95], v[20:23], v[56:59], v[80:95]
    s_addk_i32 s20, 12288
    s_cmp_eq_u32 s20, s22
    s_cselect_b32 s20, s21, s20
    ds_read_b64_tr_b16 v[20:21], v3 offset:8192
    ds_read_b64_tr_b16 v[22:23], v3 offset:8704
    s_waitcnt lgkmcnt(2)
    v_mfma_f32_32x32x16_bf16 v[64:79], v[16:19], v[56:59], v[64:79]
    ds_read_b64_tr_b16 v[16:17], v2 offset:8192
    ds_read_b64_tr_b16 v[18:19], v2 offset:8704
    buffer_load_dwordx4 v[56:59], v1, s[4:7], s20 offen offset:0 sc1
    s_waitcnt vmcnt(8)
    v_mfma_f32_32x32x16_bf16 v[80:95], v[196:199], v[24:27], v[80:95]
    s_barrier
    s_mov_b64 exec, 0xff
    buffer_store_dword v121, v120, s[4:7], s56 offen sc1
    s_mov_b64 exec, -1
    s_add_u32 s56, s56, 16
    v_lshlrev_b32 v96, 16, v4
    v_mfma_f32_32x32x16_bf16 v[64:79], v[192:195], v[24:27], v[64:79]
    buffer_load_dwordx4 v[24:27], v1, s[4:7], s20 offen offset:2048 sc1
    v_and_b32 v97, 0xffff0000, v4
    v_lshlrev_b32 v98, 16, v5
    v_and_b32 v99, 0xffff0000, v5
    v_lshlrev_b32 v100, 16, v6
    s_waitcnt vmcnt(9) lgkmcnt(2)
    v_mfma_f32_32x32x16_bf16 v[80:95], v[20:23], v[28:31], v[80:95]
    s_addk_i32 s20, 4096
    ds_read_b64_tr_b16 v[20:21], v3 offset:10240
    ds_read_b64_tr_b16 v[22:23], v3 offset:10752
    v_and_b32 v101, 0xffff0000, v6
    v_lshlrev_b32 v102, 16, v7
    s_waitcnt lgkmcnt(2)
    v_mfma_f32_32x32x16_bf16 v[64:79], v[16:19], v[28:31], v[64:79]
    ds_read_b64_tr_b16 v[16:17], v2 offset:10240
    ds_read_b64_tr_b16 v[18:19], v2 offset:10752
    buffer_load_dwordx4 v[28:31], v1, s[4:7], s20 offen offset:0 sc1
    v_and_b32 v103, 0xffff0000, v7
    v_lshlrev_b32 v104, 16, v12
    s_waitcnt vmcnt(9)
    v_mfma_f32_32x32x16_bf16 v[80:95], v[204:207], v[32:35], v[80:95]
    v_and_b32 v105, 0xffff0000, v12
    v_lshlrev_b32 v106, 16, v13
    v_and_b32 v107, 0xffff0000, v13
    v_lshlrev_b32 v108, 16, v14
    v_and_b32 v109, 0xffff0000, v14
    v_lshlrev_b32 v110, 16, v15
    v_mfma_f32_32x32x16_bf16 v[64:79], v[200:203], v[32:35], v[64:79]
    buffer_load_dwordx4 v[32:35], v1, s[4:7], s20 offen offset:2048 sc1
    v_and_b32 v111, 0xffff0000, v15
    v_add_f32 v96, v96, v104
    v_add_f32 v97, v97, v105
    v_add_f32 v98, v98, v106
    v_add_f32 v99, v99, v107
    s_waitcnt vmcnt(9) lgkmcnt(2)
    v_mfma_f32_32x32x16_bf16 v[80:95], v[20:23], v[36:39], v[80:95]
    s_addk_i32 s20, 12288
    s_cmp_eq_u32 s20, s22
    s_cselect_b32 s20, s21, s20
    ds_read_b64_tr_b16 v[20:21], v3 offset:12288
    ds_read_b64_tr_b16 v[22:23], v3 offset:12800
    s_waitcnt lgkmcnt(2)
    v_mfma_f32_32x32x16_bf16 v[64:79], v[16:19], v[36:39], v[64:79]
    ds_read_b64_tr_b16 v[16:17], v2 offset:12288
    ds_read_b64_tr_b16 v[18:19], v2 offset:12800
    buffer_load_dwordx4 v[36:39], v1, s[4:7], s20 offen offset:0 sc1
    v_add_f32 v100, v100, v108
    v_add_f32 v101, v101, v109
    s_waitcnt vmcnt(9)
    v_mfma_f32_32x32x16_bf16 v[80:95], v[212:215], v[40:43], v[80:95]
    v_add_f32 v102, v102, v110
    v_add_f32 v103, v103, v111
    v_mov_b32 v104, 0
    v_mov_b32 v105, 0
    v_mov_b32 v106, 0
    v_mov_b32 v107, 0
    v_mfma_f32_32x32x16_bf16 v[64:79], v[208:211], v[40:43], v[64:79]
    buffer_load_dwordx4 v[40:43], v1, s[4:7], s20 offen offset:2048 sc1
    v_mov_b32 v108, 0
    v_mov_b32 v109, 0
    v_mov_b32 v110, 0
    v_mov_b32 v111, 0
    s_waitcnt vmcnt(9) lgkmcnt(2)
    v_mfma_f32_32x32x16_bf16 v[80:95], v[20:23], v[44:47], v[80:95]
    s_addk_i32 s20, 4096
    ds_read_b64_tr_b16 v[20:21], v3 offset:14336
    ds_read_b64_tr_b16 v[22:23], v3 offset:14848
    s_waitcnt lgkmcnt(2)
    v_mfma_f32_32x32x16_bf16 v[64:79], v[16:19], v[44:47], v[64:79]
    ds_read_b64_tr_b16 v[16:17], v2 offset:14336
    ds_read_b64_tr_b16 v[18:19], v2 offset:14848
    buffer_load_dwordx4 v[44:47], v1, s[4:7], s20 offen offset:0 sc1
    s_waitcnt vmcnt(9)
    v_mfma_f32_32x32x16_bf16 v[80:95], v[220:223], v[48:51], v[80:95]
    ds_read_b64_tr_b16 v[116:117], v3 offset:20480
    ds_read_b64_tr_b16 v[118:119], v3 offset:20992
    v_mfma_f32_32x32x16_bf16 v[64:79], v[216:219], v[48:51], v[64:79]
    ds_read_b64_tr_b16 v[112:113], v2 offset:20480
    ds_read_b64_tr_b16 v[114:115], v2 offset:20992
    buffer_load_dwordx4 v[48:51], v1, s[4:7], s20 offen offset:2048 sc1
    s_waitcnt vmcnt(9) lgkmcnt(6)
    v_mfma_f32_32x32x16_bf16 v[80:95], v[20:23], v[52:55], v[80:95]
    s_addk_i32 s20, 12288
    s_cmp_eq_u32 s20, s22
    s_cselect_b32 s20, s21, s20
    ds_read_b64_tr_b16 v[20:21], v3 offset:16384
    ds_read_b64_tr_b16 v[22:23], v3 offset:16896
    s_waitcnt lgkmcnt(6)
    v_mfma_f32_32x32x16_bf16 v[64:79], v[16:19], v[52:55], v[64:79]
    ds_read_b64_tr_b16 v[16:17], v2 offset:16384
    ds_read_b64_tr_b16 v[18:19], v2 offset:16896
    buffer_load_dwordx4 v[52:55], v1, s[4:7], s20 offen offset:0 sc1
    s_waitcnt vmcnt(9)
    v_mfma_f32_32x32x16_bf16 v[80:95], v[228:231], v[56:59], v[80:95]
    ds_read_b64_tr_b16 v[124:125], v3 offset:22528
    ds_read_b64_tr_b16 v[126:127], v3 offset:23040
    v_mfma_f32_32x32x16_bf16 v[64:79], v[224:227], v[56:59], v[64:79]
    ds_read_b64_tr_b16 v[120:121], v2 offset:22528
    ds_read_b64_tr_b16 v[122:123], v2 offset:23040
    buffer_load_dwordx4 v[56:59], v1, s[4:7], s20 offen offset:2048 sc1
    s_waitcnt vmcnt(8) lgkmcnt(6)
    v_mfma_f32_32x32x16_bf16 v[80:95], v[20:23], v[24:27], v[80:95]
    s_addk_i32 s20, 4096
    ds_read_b64_tr_b16 v[20:21], v3 offset:18432
    ds_read_b64_tr_b16 v[22:23], v3 offset:18944
    s_waitcnt lgkmcnt(6)
    v_mfma_f32_32x32x16_bf16 v[64:79], v[16:19], v[24:27], v[64:79]
    ds_read_b64_tr_b16 v[16:17], v2 offset:18432
    ds_read_b64_tr_b16 v[18:19], v2 offset:18944
    buffer_load_dwordx4 v[24:27], v1, s[4:7], s20 offen offset:0 sc1
    s_waitcnt vmcnt(8)
    v_mfma_f32_32x32x16_bf16 v[80:95], v[236:239], v[28:31], v[80:95]
    v_mfma_f32_32x32x16_bf16 v[64:79], v[232:235], v[28:31], v[64:79]
    buffer_load_dwordx4 v[28:31], v1, s[4:7], s20 offen offset:2048 sc1
    s_waitcnt vmcnt(8) lgkmcnt(2)
    v_mfma_f32_32x32x16_bf16 v[80:95], v[20:23], v[32:35], v[80:95]
    s_addk_i32 s20, 12288
    s_cmp_eq_u32 s20, s22
    s_cselect_b32 s20, s21, s20
    s_waitcnt lgkmcnt(0)
    v_mfma_f32_32x32x16_bf16 v[64:79], v[16:19], v[32:35], v[64:79]
    s_load_dwordx4 s[60:63], s[4:5], s57 glc
    s_load_dwordx4 s[64:67], s[4:5], s57 offset:128 glc
    s_waitcnt vmcnt(7)
    v_mfma_f32_32x32x16_bf16 v[80:95], v[244:247], v[36:39], v[80:95]
    v_mfma_f32_32x32x16_bf16 v[64:79], v[240:243], v[36:39], v[64:79]
    s_waitcnt vmcnt(6)
    v_mfma_f32_32x32x16_bf16 v[80:95], v[116:119], v[40:43], v[80:95]
    v_mfma_f32_32x32x16_bf16 v[64:79], v[112:115], v[40:43], v[64:79]
    s_waitcnt vmcnt(5)
    v_mfma_f32_32x32x16_bf16 v[80:95], v[252:255], v[44:47], v[80:95]
    v_mfma_f32_32x32x16_bf16 v[64:79], v[248:251], v[44:47], v[64:79]
    s_waitcnt vmcnt(4)
    v_mfma_f32_32x32x16_bf16 v[80:95], v[124:127], v[48:51], v[80:95]
    s_waitcnt lgkmcnt(0)
    s_xor_b64 s[60:61], s[60:61], s[32:33]
    s_xor_b64 s[62:63], s[62:63], s[32:33]
    s_xor_b64 s[64:65], s[64:65], s[32:33]
    s_xor_b64 s[66:67], s[66:67], s[32:33]
    v_mfma_f32_32x32x16_bf16 v[64:79], v[120:123], v[48:51], v[64:79]
    s_or_b64 s[60:61], s[60:61], s[62:63]
    s_or_b64 s[64:65], s[64:65], s[66:67]
    s_or_b64 s[60:61], s[60:61], s[64:65]
    s_cbranch_scc0 .Lgate9
.Lpoll10:
    s_load_dwordx4 s[60:63], s[4:5], s57 glc
    s_load_dwordx4 s[64:67], s[4:5], s57 offset:128 glc
    s_addk_i32 s59, 0x2000
    s_cbranch_scc1 .Lend
.Lpoll10_chk:
    s_waitcnt lgkmcnt(0)
    s_xor_b64 s[60:61], s[60:61], s[32:33]
    s_xor_b64 s[62:63], s[62:63], s[32:33]
    s_xor_b64 s[64:65], s[64:65], s[32:33]
    s_xor_b64 s[66:67], s[66:67], s[32:33]
    s_or_b64 s[60:61], s[60:61], s[62:63]
    s_or_b64 s[64:65], s[64:65], s[66:67]
    s_or_b64 s[60:61], s[60:61], s[64:65]
    s_cbranch_scc1 .Lpoll10
.Lgate9:
    s_waitcnt vmcnt(3)
    v_mfma_f32_32x32x16_bf16 v[80:95], v[132:135], v[52:55], v[80:95]
    s_add_u32 s57, s57, 16
    buffer_load_dwordx4 v[32:35], v1, s[4:7], s20 offen offset:512 sc1
    buffer_load_dwordx4 v[36:39], v1, s[4:7], s20 offen offset:2560 sc1
    v_mfma_f32_32x32x16_bf16 v[64:79], v[128:131], v[52:55], v[64:79]
    s_addk_i32 s20, 4096
    buffer_load_dwordx4 v[40:43], v1, s[4:7], s20 offen offset:512 sc1
    buffer_load_dwordx4 v[44:47], v1, s[4:7], s20 offen offset:2560 sc1
    s_waitcnt vmcnt(6)
    v_mfma_f32_32x32x16_bf16 v[80:95], v[140:143], v[56:59], v[80:95]
    s_addk_i32 s20, 12288
    s_cmp_eq_u32 s20, s22
    s_cselect_b32 s20, s21, s20
    buffer_load_dwordx4 v[48:51], v1, s[4:7], s20 offen offset:512 sc1
    buffer_load_dwordx4 v[52:55], v1, s[4:7], s20 offen offset:2560 sc1
    v_mfma_f32_32x32x16_bf16 v[64:79], v[136:139], v[56:59], v[64:79]
    s_addk_i32 s20, 4096
    buffer_load_dwordx4 v[56:59], v1, s[4:7], s20 offen offset:512 sc1
    s_waitcnt vmcnt(8)
    v_mfma_f32_32x32x16_bf16 v[80:95], v[148:151], v[24:27], v[80:95]
    v_mfma_f32_32x32x16_bf16 v[64:79], v[144:147], v[24:27], v[64:79]
    buffer_load_dwordx4 v[24:27], v1, s[4:7], s20 offen offset:2560 sc1
    s_waitcnt vmcnt(8)
    v_mfma_f32_32x32x16_bf16 v[80:95], v[156:159], v[28:31], v[80:95]
    s_addk_i32 s20, 12288
    s_cmp_eq_u32 s20, s22
    s_cselect_b32 s20, s21, s20
    v_mfma_f32_32x32x16_bf16 v[64:79], v[152:155], v[28:31], v[64:79]
    buffer_load_dwordx4 v[28:31], v1, s[4:7], s20 offen offset:512 sc1
    ds_read_b64_tr_b16 v[20:21], v3 offset:0
    ds_read_b64_tr_b16 v[22:23], v3 offset:512
    ds_read_b64_tr_b16 v[16:17], v2 offset:0
    ds_read_b64_tr_b16 v[18:19], v2 offset:512
    s_waitcnt vmcnt(8)
    v_mfma_f32_32x32x16_bf16 v[112:127], v[164:167], v[32:35], 0
    v_mfma_f32_32x32x16_bf16 v[96:111], v[160:163], v[32:35], v[96:111]
    buffer_load_dwordx4 v[32:35], v1, s[4:7], s20 offen offset:2560 sc1
    s_waitcnt vmcnt(8) lgkmcnt(2)
    v_mfma_f32_32x32x16_bf16 v[112:127], v[20:23], v[36:39], v[112:127]
    s_addk_i32 s20, 4096
    ds_read_b64_tr_b16 v[20:21], v3 offset:2048
    ds_read_b64_tr_b16 v[22:23], v3 offset:2560
    s_waitcnt lgkmcnt(2)
    v_mfma_f32_32x32x16_bf16 v[96:111], v[16:19], v[36:39], v[96:111]
    ds_read_b64_tr_b16 v[16:17], v2 offset:2048
    ds_read_b64_tr_b16 v[18:19], v2 offset:2560
    buffer_load_dwordx4 v[36:39], v1, s[4:7], s20 offen offset:512 sc1
    s_waitcnt vmcnt(8)
    v_mfma_f32_32x32x16_bf16 v[112:127], v[172:175], v[40:43], v[112:127]
    v_xor_b32 v61, 6144, v60
    ds_write_b128 v61, v[88:91] offset:24704
    v_mfma_f32_32x32x16_bf16 v[96:111], v[168:171], v[40:43], v[96:111]
    buffer_load_dwordx4 v[40:43], v1, s[4:7], s20 offen offset:2560 sc1
    s_waitcnt vmcnt(8) lgkmcnt(3)
    v_mfma_f32_32x32x16_bf16 v[112:127], v[20:23], v[44:47], v[112:127]
    s_addk_i32 s20, 12288
    s_cmp_eq_u32 s20, s22
    s_cselect_b32 s20, s21, s20
    ds_read_b64_tr_b16 v[20:21], v3 offset:4096
    ds_read_b64_tr_b16 v[22:23], v3 offset:4608
    s_waitcnt lgkmcnt(3)
    v_mfma_f32_32x32x16_bf16 v[96:111], v[16:19], v[44:47], v[96:111]
    ds_read_b64_tr_b16 v[16:17], v2 offset:4096
    ds_read_b64_tr_b16 v[18:19], v2 offset:4608
    buffer_load_dwordx4 v[44:47], v1, s[4:7], s20 offen offset:512 sc1
    ds_write_b128 v61, v[92:95] offset:25728
    s_waitcnt vmcnt(8)
    v_mfma_f32_32x32x16_bf16 v[112:127], v[180:183], v[48:51], v[112:127]
    v_xor_b32 v61, 4096, v60
    ds_write_b128 v61, v[80:83] offset:16512
    v_mfma_f32_32x32x16_bf16 v[96:111], v[176:179], v[48:51], v[96:111]
    buffer_load_dwordx4 v[48:51], v1, s[4:7], s20 offen offset:2560 sc1
    ds_write_b128 v61, v[84:87] offset:17536
    s_waitcnt vmcnt(8) lgkmcnt(5)
    v_mfma_f32_32x32x16_bf16 v[112:127], v[20:23], v[52:55], v[112:127]
    s_addk_i32 s20, 4096
    ds_read_b64_tr_b16 v[20:21], v3 offset:6144
    ds_read_b64_tr_b16 v[22:23], v3 offset:6656
    s_waitcnt lgkmcnt(5)
    v_mfma_f32_32x32x16_bf16 v[96:111], v[16:19], v[52:55], v[96:111]
    ds_read_b64_tr_b16 v[16:17], v2 offset:6144
    ds_read_b64_tr_b16 v[18:19], v2 offset:6656
    buffer_load_dwordx4 v[52:55], v1, s[4:7], s20 offen offset:512 sc1
    s_waitcnt vmcnt(8)
    v_mfma_f32_32x32x16_bf16 v[112:127], v[188:191], v[56:59], v[112:127]
    v_xor_b32 v61, 2048, v60
    ds_write_b128 v61, v[72:75] offset:8320
    v_mfma_f32_32x32x16_bf16 v[96:111], v[184:187], v[56:59], v[96:111]
    buffer_load_dwordx4 v[56:59], v1, s[4:7], s20 offen offset:2560 sc1
    ds_write_b128 v61, v[76:79] offset:9344
    s_waitcnt vmcnt(8) lgkmcnt(4)
    v_mfma_f32_32x32x16_bf16 v[112:127], v[20:23], v[24:27], v[112:127]
    s_addk_i32 s20, 12288
    s_cmp_eq_u32 s20, s22
    s_cselect_b32 s20, s21, s20
    ds_read_b64_tr_b16 v[20:21], v3 offset:8192
    ds_read_b64_tr_b16 v[22:23], v3 offset:8704
    s_waitcnt lgkmcnt(4)
    v_mfma_f32_32x32x16_bf16 v[96:111], v[16:19], v[24:27], v[96:111]
    ds_read_b64_tr_b16 v[16:17], v2 offset:8192
    ds_read_b64_tr_b16 v[18:19], v2 offset:8704
    buffer_load_dwordx4 v[24:27], v1, s[4:7], s20 offen offset:512 sc1
    s_waitcnt vmcnt(8)
    v_mfma_f32_32x32x16_bf16 v[112:127], v[196:199], v[28:31], v[112:127]
    s_waitcnt lgkmcnt(0)
    s_barrier
    ds_read_b128 v[72:75], v60 offset:8320
    v_mfma_f32_32x32x16_bf16 v[96:111], v[192:195], v[28:31], v[96:111]
    buffer_load_dwordx4 v[28:31], v1, s[4:7], s20 offen offset:2560 sc1
    ds_read_b128 v[76:79], v60 offset:9344
    ds_read_b128 v[80:83], v60 offset:16512
    ds_read_b128 v[84:87], v60 offset:17536
    ds_read_b128 v[88:91], v60 offset:24704
    s_waitcnt vmcnt(8)
    v_mfma_f32_32x32x16_bf16 v[112:127], v[20:23], v[32:35], v[112:127]
    s_addk_i32 s20, 4096
    ds_read_b64_tr_b16 v[20:21], v3 offset:10240
    ds_read_b64_tr_b16 v[22:23], v3 offset:10752
    ds_read_b128 v[92:95], v60 offset:25728
    v_mfma_f32_32x32x16_bf16 v[96:111], v[16:19], v[32:35], v[96:111]
    ds_read_b64_tr_b16 v[16:17], v2 offset:10240
    ds_read_b64_tr_b16 v[18:19], v2 offset:10752
    buffer_load_dwordx4 v[32:35], v1, s[4:7], s20 offen offset:512 sc1
    s_waitcnt vmcnt(8)
    v_mfma_f32_32x32x16_bf16 v[112:127], v[204:207], v[36:39], v[112:127]
    s_waitcnt lgkmcnt(8)
    v_add_f32 v64, v64, v72
    v_add_f32 v65, v65, v73
    v_add_f32 v66, v66, v74
    v_add_f32 v67, v67, v75
    v_add_f32 v68, v68, v76
    v_add_f32 v69, v69, v77
    v_mfma_f32_32x32x16_bf16 v[96:111], v[200:203], v[36:39], v[96:111]
    buffer_load_dwordx4 v[36:39], v1, s[4:7], s20 offen offset:2560 sc1
    v_add_f32 v70, v70, v78
    v_add_f32 v71, v71, v79
    s_waitcnt lgkmcnt(6)
    v_add_f32 v64, v64, v80
    v_add_f32 v65, v65, v81
    s_waitcnt vmcnt(8) lgkmcnt(3)
    v_mfma_f32_32x32x16_bf16 v[112:127], v[20:23], v[40:43], v[112:127]
    s_addk_i32 s20, 12288
    s_cmp_eq_u32 s20, s22
    s_cselect_b32 s20, s21, s20
    ds_read_b64_tr_b16 v[20:21], v3 offset:12288
    ds_read_b64_tr_b16 v[22:23], v3 offset:12800
    s_waitcnt lgkmcnt(2)
    v_mfma_f32_32x32x16_bf16 v[96:111], v[16:19], v[40:43], v[96:111]
    ds_read_b64_tr_b16 v[16:17], v2 offset:12288
    ds_read_b64_tr_b16 v[18:19], v2 offset:12800
    buffer_load_dwordx4 v[40:43], v1, s[4:7], s20 offen offset:512 sc1
    v_add_f32 v66, v66, v82
    v_add_f32 v67, v67, v83
    s_waitcnt vmcnt(8)
    v_mfma_f32_32x32x16_bf16 v[112:127], v[212:215], v[44:47], v[112:127]
    v_add_f32 v68, v68, v84
    v_add_f32 v69, v69, v85
    v_add_f32 v70, v70, v86
    v_add_f32 v71, v71, v87
    v_add_f32 v64, v64, v88
    v_add_f32 v65, v65, v89
    v_mfma_f32_32x32x16_bf16 v[96:111], v[208:211], v[44:47], v[96:111]
    buffer_load_dwordx4 v[44:47], v1, s[4:7], s20 offen offset:2560 sc1
    v_add_f32 v66, v66, v90
    v_add_f32 v67, v67, v91
    v_add_f32 v68, v68, v92
    v_add_f32 v69, v69, v93
    s_waitcnt vmcnt(8) lgkmcnt(2)
    v_mfma_f32_32x32x16_bf16 v[112:127], v[20:23], v[48:51], v[112:127]
    s_addk_i32 s20, 4096
    ds_read_b64_tr_b16 v[20:21], v3 offset:14336
    ds_read_b64_tr_b16 v[22:23], v3 offset:14848
    v_add_f32 v70, v70, v94
    v_add_f32 v71, v71, v95
    s_waitcnt lgkmcnt(2)
    v_mfma_f32_32x32x16_bf16 v[96:111], v[16:19], v[48:51], v[96:111]
    ds_read_b64_tr_b16 v[16:17], v2 offset:14336
    ds_read_b64_tr_b16 v[18:19], v2 offset:14848
    buffer_load_dwordx4 v[48:51], v1, s[4:7], s20 offen offset:512 sc1
    s_waitcnt vmcnt(8)
    v_mfma_f32_32x32x16_bf16 v[112:127], v[220:223], v[52:55], v[112:127]
    v_mfma_f32_32x32x16_bf16 v[96:111], v[216:219], v[52:55], v[96:111]
    buffer_load_dwordx4 v[52:55], v1, s[4:7], s20 offen offset:2560 sc1
    s_waitcnt vmcnt(8) lgkmcnt(2)
    v_mfma_f32_32x32x16_bf16 v[112:127], v[20:23], v[56:59], v[112:127]
    s_addk_i32 s20, 12288
    s_cmp_eq_u32 s20, s22
    s_cselect_b32 s20, s21, s20
    ds_read_b64_tr_b16 v[20:21], v3 offset:16384
    ds_read_b64_tr_b16 v[22:23], v3 offset:16896
    s_waitcnt lgkmcnt(2)
    v_mfma_f32_32x32x16_bf16 v[96:111], v[16:19], v[56:59], v[96:111]
    ds_read_b64_tr_b16 v[16:17], v2 offset:16384
    ds_read_b64_tr_b16 v[18:19], v2 offset:16896
    buffer_load_dwordx4 v[56:59], v1, s[4:7], s20 offen offset:512 sc1
    s_waitcnt vmcnt(8)
    v_mfma_f32_32x32x16_bf16 v[112:127], v[228:231], v[24:27], v[112:127]
    v_mfma_f32_32x32x16_bf16 v[96:111], v[224:227], v[24:27], v[96:111]
    buffer_load_dwordx4 v[24:27], v1, s[4:7], s20 offen offset:2560 sc1
    s_waitcnt vmcnt(8) lgkmcnt(2)
    v_mfma_f32_32x32x16_bf16 v[112:127], v[20:23], v[28:31], v[112:127]
    s_addk_i32 s20, 4096
    ds_read_b64_tr_b16 v[20:21], v3 offset:18432
    ds_read_b64_tr_b16 v[22:23], v3 offset:18944
    s_waitcnt lgkmcnt(2)
    v_mfma_f32_32x32x16_bf16 v[96:111], v[16:19], v[28:31], v[96:111]
    ds_read_b64_tr_b16 v[16:17], v2 offset:18432
    ds_read_b64_tr_b16 v[18:19], v2 offset:18944
    buffer_load_dwordx4 v[28:31], v1, s[4:7], s20 offen offset:512 sc1
    s_waitcnt vmcnt(8)
    v_mfma_f32_32x32x16_bf16 v[112:127], v[236:239], v[32:35], v[112:127]
    v_mfma_f32_32x32x16_bf16 v[96:111], v[232:235], v[32:35], v[96:111]
    buffer_load_dwordx4 v[32:35], v1, s[4:7], s20 offen offset:2560 sc1
    s_waitcnt vmcnt(8) lgkmcnt(2)
    v_mfma_f32_32x32x16_bf16 v[112:127], v[20:23], v[36:39], v[112:127]
    s_addk_i32 s20, 12288
    s_cmp_eq_u32 s20, s22
    s_cselect_b32 s20, s21, s20
    ds_read_b64_tr_b16 v[20:21], v3 offset:20480
    ds_read_b64_tr_b16 v[22:23], v3 offset:20992
    s_waitcnt lgkmcnt(2)
    v_mfma_f32_32x32x16_bf16 v[96:111], v[16:19], v[36:39], v[96:111]
    ds_read_b64_tr_b16 v[16:17], v2 offset:20480
    ds_read_b64_tr_b16 v[18:19], v2 offset:20992
    v_mbcnt_lo_u32_b32 v76, -1, 0
    v_mbcnt_hi_u32_b32 v76, -1, v76
    v_lshlrev_b32 v76, 4, v76
    s_waitcnt vmcnt(7)
    v_mfma_f32_32x32x16_bf16 v[112:127], v[244:247], v[40:43], v[112:127]
    v_mov_b32 v72, -1
    v_mov_b32 v73, -1
    v_mov_b32 v74, -1
    v_mov_b32 v75, -1
    s_lshl3_add_u32 s40, s46, s44
    s_lshl_b32 s40, s40, 11
    v_mfma_f32_32x32x16_bf16 v[96:111], v[240:243], v[40:43], v[96:111]
    s_add_u32 s40, s40, s31
    s_add_u32 s40, s40, 4718592
    buffer_store_dwordx4 v[72:75], v76, s[4:7], s40 offen offset:0 sc1
    buffer_store_dwordx4 v[72:75], v76, s[4:7], s40 offen offset:1024 sc1
    s_waitcnt vmcnt(8) lgkmcnt(2)
    v_mfma_f32_32x32x16_bf16 v[112:127], v[20:23], v[44:47], v[112:127]
    ds_read_b64_tr_b16 v[20:21], v3 offset:22528
    ds_read_b64_tr_b16 v[22:23], v3 offset:23040
    s_add_u32 s40, s40, 524288
    buffer_store_dwordx4 v[72:75], v1, s[4:7], s40 offen sc1
    s_waitcnt lgkmcnt(2)
    v_mfma_f32_32x32x16_bf16 v[96:111], v[16:19], v[44:47], v[96:111]
    ds_read_b64_tr_b16 v[16:17], v2 offset:22528
    ds_read_b64_tr_b16 v[18:19], v2 offset:23040
    s_waitcnt vmcnt(8)
    v_mfma_f32_32x32x16_bf16 v[112:127], v[252:255], v[48:51], v[112:127]
    v_mfma_f32_32x32x16_bf16 v[96:111], v[248:251], v[48:51], v[96:111]
    s_waitcnt vmcnt(7) lgkmcnt(2)
    v_mfma_f32_32x32x16_bf16 v[112:127], v[20:23], v[52:55], v[112:127]
    s_waitcnt lgkmcnt(0)
    v_mfma_f32_32x32x16_bf16 v[96:111], v[16:19], v[52:55], v[96:111]
    s_waitcnt vmcnt(6)
    v_mfma_f32_32x32x16_bf16 v[112:127], v[132:135], v[56:59], v[112:127]
    v_mbcnt_lo_u32_b32 v4, -1, 0
    v_mbcnt_hi_u32_b32 v4, -1, v4
    v_lshrrev_b32 v5, 5, v4
    v_and_b32 v6, 31, v4
    v_lshlrev_b32 v1, 10, v5
    s_waitcnt vmcnt(5)
    v_mfma_f32_32x32x16_bf16 v[112:127], v[140:143], v[24:27], v[112:127]
    v_lshl_add_u32 v1, v6, 4, v1
    v_lshlrev_b32 v2, 2, v4
    v_and_b32 v6, 7, v4
    v_lshlrev_b32 v3, 4, v6
    v_lshl_add_u32 v3, v5, 7, v3
    s_waitcnt vmcnt(4)
    v_mfma_f32_32x32x16_bf16 v[112:127], v[148:151], v[28:31], v[112:127]
    v_bfe_u32 v6, v4, 3, 2
    v_lshl_add_u32 v3, v6, 8, v3
    s_lshl_b32 s22, s46, 3
    s_add_u32 s22, s22, s44
    s_lshl_b32 s22, s22, 11
    s_waitcnt vmcnt(3)
    v_mfma_f32_32x32x16_bf16 v[112:127], v[156:159], v[32:35], v[112:127]
    s_add_u32 s20, s22, 76546048
    s_lshl_b32 s21, s45, 8
    s_add_u32 s21, s21, s20
    s_and_b32 s42, s31, 8192
    s_add_u32 s20, s20, s42
    v_mfma_f32_32x32x16_bf16 v[96:111], v[128:131], v[56:59], v[96:111]
    s_add_u32 s21, s21, s42
    s_xor_b32 s28, s21, 8192
    s_add_u32 s22, s22, s31
    s_add_u32 s23, s22, 0
    v_xor_b32 v61, 6144, v60
    v_mfma_f32_32x32x16_bf16 v[96:111], v[136:139], v[24:27], v[96:111]
    s_add_u32 s22, s22, 4194304
    s_mov_b32 s24, 0x11111111
    s_mov_b32 s25, s24
    s_mov_b32 s26, 0xbb000000
    ds_write_b128 v61, v[120:123] offset:49280
    v_mfma_f32_32x32x16_bf16 v[96:111], v[144:147], v[28:31], v[96:111]
    s_mov_b32 s27, 0x3b000000
    ds_write_b128 v61, v[124:127] offset:50304
    v_mfma_f32_32x32x16_bf16 v[96:111], v[152:155], v[32:35], v[96:111]
    v_xor_b32 v61, 4096, v60
    ds_write_b128 v61, v[112:115] offset:41088
    ds_write_b128 v61, v[116:119] offset:42112
    s_nop 7
    v_xor_b32 v61, 2048, v60
    ds_write_b128 v61, v[104:107] offset:32896
    ds_write_b128 v61, v[108:111] offset:33920
    s_waitcnt lgkmcnt(0)
    s_barrier
    ds_read_b128 v[104:107], v60 offset:32896
    ds_read_b128 v[108:111], v60 offset:33920
    ds_read_b128 v[112:115], v60 offset:41088
    ds_read_b128 v[116:119], v60 offset:42112
    ds_read_b128 v[120:123], v60 offset:49280
    ds_read_b128 v[124:127], v60 offset:50304
    s_waitcnt lgkmcnt(4)
    v_pk_add_f32 v[96:97], v[96:97], v[104:105]
    v_pk_add_f32 v[98:99], v[98:99], v[106:107]
    v_pk_add_f32 v[100:101], v[100:101], v[108:109]
    v_pk_add_f32 v[102:103], v[102:103], v[110:111]
    s_waitcnt lgkmcnt(2)
    v_pk_add_f32 v[96:97], v[96:97], v[112:113]
    v_pk_add_f32 v[98:99], v[98:99], v[114:115]
    v_pk_add_f32 v[100:101], v[100:101], v[116:117]
    v_pk_add_f32 v[102:103], v[102:103], v[118:119]
    s_waitcnt lgkmcnt(0)
    v_pk_add_f32 v[16:17], v[96:97], v[120:121]
    v_pk_add_f32 v[18:19], v[98:99], v[122:123]
    v_pk_add_f32 v[20:21], v[100:101], v[124:125]
    v_pk_add_f32 v[22:23], v[102:103], v[126:127]
    v_pk_mul_f32 v[32:33], v[64:65], v[64:65]
    v_pk_mul_f32 v[34:35], v[66:67], v[66:67]
    v_pk_mul_f32 v[36:37], v[68:69], v[68:69]
    v_pk_mul_f32 v[38:39], v[70:71], v[70:71]
    v_pk_add_f32 v[24:25], v[64:65], v[16:17]
    v_pk_add_f32 v[26:27], v[66:67], v[18:19]
    v_pk_add_f32 v[28:29], v[68:69], v[20:21]
    v_pk_add_f32 v[30:31], v[70:71], v[22:23]
    v_pk_fma_f32 v[32:33], v[16:17], v[16:17], v[32:33]
    v_pk_fma_f32 v[34:35], v[18:19], v[18:19], v[34:35]
    v_pk_fma_f32 v[36:37], v[20:21], v[20:21], v[36:37]
    v_pk_fma_f32 v[38:39], v[22:23], v[22:23], v[38:39]
    v_permlane16_swap_b32 v24, v28
    v_permlane16_swap_b32 v25, v29
    v_permlane16_swap_b32 v26, v30
    v_permlane16_swap_b32 v27, v31
    v_permlane16_swap_b32 v32, v36
    v_permlane16_swap_b32 v33, v37
    v_permlane16_swap_b32 v34, v38
    v_permlane16_swap_b32 v35, v39
    v_pk_add_f32 v[24:25], v[24:25], v[28:29]
    v_pk_add_f32 v[26:27], v[26:27], v[30:31]
    v_pk_add_f32 v[32:33], v[32:33], v[36:37]
    v_pk_add_f32 v[34:35], v[34:35], v[38:39]
    v_add_f32_dpp v24, v24, v24 row_mirror row_mask:0xf bank_mask:0x3
    v_add_f32_dpp v25, v25, v25 row_mirror row_mask:0xf bank_mask:0x3
    v_add_f32_dpp v32, v32, v32 row_mirror row_mask:0xf bank_mask:0x3
    v_add_f32_dpp v33, v33, v33 row_mirror row_mask:0xf bank_mask:0x3
    v_add_f32_dpp v24, v26, v26 row_mirror row_mask:0xf bank_mask:0xc
    v_add_f32_dpp v25, v27, v27 row_mirror row_mask:0xf bank_mask:0xc
    v_add_f32_dpp v32, v34, v34 row_mirror row_mask:0xf bank_mask:0xc
    v_add_f32_dpp v33, v35, v35 row_mirror row_mask:0xf bank_mask:0xc
    v_add_f32_dpp v24, v24, v24 row_half_mirror row_mask:0xf bank_mask:0x5
    v_add_f32_dpp v32, v32, v32 row_half_mirror row_mask:0xf bank_mask:0x5
    v_add_f32_dpp v24, v25, v25 row_half_mirror row_mask:0xf bank_mask:0xa
    v_add_f32_dpp v32, v33, v33 row_half_mirror row_mask:0xf bank_mask:0xa
    v_mov_b32 v25, s47
    v_add_f32_dpp v24, v24, v24 quad_perm:[2,3,0,1] row_mask:0xf bank_mask:0xf
    v_add_f32_dpp v32, v32, v32 quad_perm:[2,3,0,1] row_mask:0xf bank_mask:0xf
    v_mov_b32 v27, s47
    v_add_f32_dpp v24, v24, v24 quad_perm:[1,0,3,2] row_mask:0xf bank_mask:0xf
    v_add_f32_dpp v26, v32, v32 quad_perm:[1,0,3,2] row_mask:0xf bank_mask:0xf
    s_mov_b64 exec, s[24:25]
    buffer_store_dwordx4 v[24:27], v2, s[4:7], s21 offen sc1
    buffer_store_dwordx4 v[24:27], v2, s[4:7], s28 offen sc1
    s_mov_b64 exec, -1
    s_branch .Lpage16
.p2alignl 12, 0xbf810000
.Lpage16:
    s_waitcnt vmcnt(0)
.Lgat11:
    buffer_load_dwordx4 v[40:43], v3, s[4:7], s20 offen sc1
    buffer_load_dwordx4 v[44:47], v3, s[4:7], s20 offen offset:1024 sc1
    s_addk_i32 s59, 0x2000
    s_cbranch_scc1 .Lend
.Lgat11_chk:
    s_waitcnt vmcnt(0)
    v_add_f32 v40, v40, v44
    v_add_f32 v42, v42, v46
    v_bitop3_b32 v41, v41, v43, s47 bitop3:0x7e
    v_bitop3_b32 v43, v45, v47, s47 bitop3:0x7e
    v_add_f32_dpp v44, v40, v40 row_ror:8 row_mask:0xf bank_mask:0xf
    v_add_f32_dpp v46, v40, v40 row_ror:8 row_mask:0xf bank_mask:0xf
    v_add_f32_dpp v45, v42, v42 row_ror:8 row_mask:0xf bank_mask:0xf
    v_add_f32_dpp v47, v42, v42 row_ror:8 row_mask:0xf bank_mask:0xf
    v_permlane16_swap_b32 v44, v46
    v_or_b32 v41, v41, v43
    v_permlane16_swap_b32 v45, v47
    v_cmp_ne_u32 vcc, 0, v41
    v_pk_add_f32 v[40:41], v[44:45], v[46:47]
    v_pk_mul_f32 v[40:41], v[40:41], s[26:27]
    v_fma_f32 v41, -v40, v40, v41
    v_max_f32 v41, 0, v41
    v_add_f32 v42, 0x3727c5ac, v41
    v_rsq_f32 v42, v42
    s_cbranch_vccnz .Lgat11
    v_mul_f32 v40, v40, v42
    v_mov_b32_dpp v24, v42 row_newbcast:0 row_mask:0xf bank_mask:0xf
    v_mov_b32_dpp v25, v42 row_newbcast:1 row_mask:0xf bank_mask:0xf
    v_mov_b32_dpp v26, v42 row_newbcast:2 row_mask:0xf bank_mask:0xf
    v_mov_b32_dpp v27, v42 row_newbcast:3 row_mask:0xf bank_mask:0xf
    v_mov_b32_dpp v28, v42 row_newbcast:4 row_mask:0xf bank_mask:0xf
    v_mov_b32_dpp v29, v42 row_newbcast:5 row_mask:0xf bank_mask:0xf
    v_mov_b32_dpp v30, v42 row_newbcast:6 row_mask:0xf bank_mask:0xf
    v_mov_b32_dpp v31, v42 row_newbcast:7 row_mask:0xf bank_mask:0xf
    v_mov_b32_dpp v32, v40 row_newbcast:0 row_mask:0xf bank_mask:0xf
    v_mov_b32_dpp v33, v40 row_newbcast:1 row_mask:0xf bank_mask:0xf
    v_mov_b32_dpp v34, v40 row_newbcast:2 row_mask:0xf bank_mask:0xf
    v_mov_b32_dpp v35, v40 row_newbcast:3 row_mask:0xf bank_mask:0xf
    v_mov_b32_dpp v36, v40 row_newbcast:4 row_mask:0xf bank_mask:0xf
    v_mov_b32_dpp v37, v40 row_newbcast:5 row_mask:0xf bank_mask:0xf
    v_mov_b32_dpp v38, v40 row_newbcast:6 row_mask:0xf bank_mask:0xf
    v_mov_b32_dpp v39, v40 row_newbcast:7 row_mask:0xf bank_mask:0xf
    v_pk_fma_f32 v[40:41], v[64:65], v[24:25], v[32:33]
    v_pk_fma_f32 v[42:43], v[66:67], v[26:27], v[34:35]
    v_pk_fma_f32 v[44:45], v[68:69], v[28:29], v[36:37]
    v_pk_fma_f32 v[46:47], v[70:71], v[30:31], v[38:39]
    v_cvt_pk_bf16_f32 v56, v40, v44
    v_cvt_pk_bf16_f32 v57, v41, v45
    v_cvt_pk_bf16_f32 v58, v42, v46
    v_cvt_pk_bf16_f32 v59, v43, v47
    buffer_store_dwordx4 v[56:59], v1, s[4:7], s22 offen offset:0 sc1
    v_pk_fma_f32 v[48:49], v[16:17], v[24:25], v[32:33]
    v_pk_fma_f32 v[50:51], v[18:19], v[26:27], v[34:35]
    v_pk_fma_f32 v[52:53], v[20:21], v[28:29], v[36:37]
    v_pk_fma_f32 v[54:55], v[22:23], v[30:31], v[38:39]
    v_cvt_pk_bf16_f32 v60, v48, v52
    v_cvt_pk_bf16_f32 v61, v49, v53
    v_cvt_pk_bf16_f32 v62, v50, v54
    v_cvt_pk_bf16_f32 v63, v51, v55
    buffer_store_dwordx4 v[60:63], v1, s[4:7], s22 offen offset:512 sc1
    v_lshlrev_b32 v24, 16, v0
    v_and_b32 v26, 0xffff0000, v0
    v_pk_fma_f32 v[8:9], v[40:41], v[24:25], v[64:65] op_sel_hi:[1,0,1]
    v_pk_fma_f32 v[10:11], v[42:43], v[24:25], v[66:67] op_sel_hi:[1,0,1]
    v_pk_fma_f32 v[12:13], v[44:45], v[24:25], v[68:69] op_sel_hi:[1,0,1]
    v_pk_fma_f32 v[14:15], v[46:47], v[24:25], v[70:71] op_sel_hi:[1,0,1]
    v_pk_fma_f32 v[16:17], v[48:49], v[26:27], v[16:17] op_sel_hi:[1,0,1]
    v_pk_fma_f32 v[18:19], v[50:51], v[26:27], v[18:19] op_sel_hi:[1,0,1]
    v_pk_fma_f32 v[20:21], v[52:53], v[26:27], v[20:21] op_sel_hi:[1,0,1]
    v_pk_fma_f32 v[22:23], v[54:55], v[26:27], v[22:23] op_sel_hi:[1,0,1]
    v_mbcnt_lo_u32_b32 v60, -1, 0
    v_mbcnt_hi_u32_b32 v60, -1, v60
    s_lshr_b32 s28, s44, 1
    v_lshrrev_b32 v61, 1, v60
    v_and_b32 v62, 1, v60
    v_lshlrev_b32 v1, 10, v61
    v_lshl_add_u32 v1, v62, 4, v1
    v_lshrrev_b32 v63, 4, v60
    v_lshl_add_u32 v1, v63, 13, v1
    s_lshl_b32 s20, s44, 17
    s_add_u32 s20, s20, s31
    s_lshl_b32 s42, s46, 5
    s_add_u32 s20, s20, s42
    s_add_u32 s20, s20, 4194304
    s_add_u32 s21, s20, 65536
    v_lshrrev_b32 v63, 3, v60
    v_lshlrev_b32 v2, 6, v63
    v_and_b32 v63, 3, v61
    v_lshl_add_u32 v2, v63, 2, v2
    v_mul_u32_u24 v63, 4640, v62
    s_lshl_b32 s42, s44, 10
    s_add_u32 s42, s42, 8832
    v_add3_u32 v2, v2, v63, s42
    v_and_b32 v63, 31, v60
    v_lshlrev_b32 v3, 4, v63
    v_lshrrev_b32 v63, 5, v60
    v_lshlrev_b32 v63, 6, v63
    v_sub_u32 v3, v3, v63
    s_mul_i32 s42, s28, 4640
    s_add_u32 s42, s42, 8448
    v_add_u32 v3, s42, v3
    v_bfe_u32 v63, v60, 2, 2
    v_and_b32 v4, 3, v60
    v_sub_u32 v4, v4, v63
    v_lshlrev_b32 v4, 3, v4
    v_lshrrev_b32 v63, 4, v60
    v_lshl_add_u32 v4, v63, 5, v4
    s_mul_i32 s42, s28, 4160
    s_add_u32 s42, s42, 32
    v_add_u32 v4, s42, v4
    v_lshrrev_b32 v63, 2, v60
    v_lshlrev_b32 v5, 6, v63
    v_lshl_add_u32 v5, v62, 5, v5
    v_lshlrev_b32 v7, 11, v63
    v_and_b32 v63, 3, v60
    v_lshl_add_u32 v7, v63, 4, v7
    v_lshrrev_b32 v63, 4, v60
    v_lshl_add_u32 v7, v63, 13, v7
    v_and_b32 v61, 1, v61
    v_mul_u32_u24 v63, 10640, v61
    s_lshl_b32 s42, s44, 11
    s_add_u32 s42, s42, 17600
    v_add3_u32 v5, v5, v63, s42
    s_mul_i32 s42, s44, 544
    s_add_u32 s42, s42, 26048
    v_add_u32 v6, s42, v63
    s_lshl_b32 s22, s44, 17
    s_add_u32 s22, s22, s31
    s_lshl_b32 s42, s46, 6
    s_add_u32 s22, s22, s42
    s_add_u32 s22, s22, 4718592
    s_add_u32 s23, s22, 65536
    s_mul_i32 s29, s28, 10640
    s_barrier
    v_mbcnt_lo_u32_b32 v60, -1, 0
    v_mbcnt_hi_u32_b32 v60, -1, v60
    v_mov_b32 v61, 0
    s_mul_i32 s42, s28, 4128
    s_lshl_b32 s41, s44, 8
    s_add_u32 s42, s42, s41
    v_lshl_add_u32 v63, v60, 2, s42
    ds_write_b32 v63, v61 offset:8320
    v_and_b32 v63, 3, v60
    v_lshl_add_u32 v63, v63, 2, s29
    ds_write_b32 v63, v61 offset:26048
    s_bitcmp1_b32 s44, 0
    s_cbranch_scc1 .Lcv1_odd
    s_waitcnt vmcnt(0)
.Lchk12:
    buffer_load_dwordx4 v[24:27], v1, s[4:7], s20 offen sc1
    buffer_load_dwordx4 v[28:31], v1, s[4:7], s21 offen sc1
    s_addk_i32 s59, 0x2000
    s_cbranch_scc1 .Lend
    s_waitcnt vmcnt(1)
    v_max3_u32 v32, v24, v25, v26
    v_max_u32 v32, v32, v27
    s_waitcnt vmcnt(0)
    v_max3_u32 v32, v32, v28, v29
    v_max3_u32 v32, v32, v30, v31
    v_cmp_eq_u32 vcc, -1, v32
    s_and_b64 exec, exec, vcc
    s_cbranch_scc1 .Lchk12
    s_mov_b64 exec, -1
    ds_write2_b32 v2, v24, v25 offset0:0 offset1:4
    ds_write2_b32 v2, v26, v27 offset0:8 offset1:12
    ds_write2_b32 v2, v28, v29 offset0:128 offset1:132
    ds_write2_b32 v2, v30, v31 offset0:136 offset1:140
    s_waitcnt lgkmcnt(0)
    s_barrier
    s_or_b32 s42, s2, s44
    s_cbranch_scc1 .Lnoep
    v_mov_b32 v60, s47
    v_mov_b32 v61, 78643200
    s_mov_b64 exec, 1
    buffer_store_dword v60, v61, s[4:7], 0 offen sc1
    s_mov_b64 exec, -1
.Lnoep:
    ds_read_b64_tr_b16 v[24:25], v4 offset:32
    ds_read_b64_tr_b16 v[26:27], v4 offset:0
    ds_read_b128 v[28:31], v3 offset:384
    ds_read_b128 v[32:35], v3 offset:1408
    ds_read_b128 v[36:39], v3 offset:2944
    ds_read_b128 v[40:43], v3 offset:3968
    s_waitcnt lgkmcnt(3)
    v_mfma_f32_32x32x16_bf16 v[64:79], v[28:31], v[24:27], 0
    ds_read_b64_tr_b16 v[44:45], v4 offset:160
    ds_read_b64_tr_b16 v[46:47], v4 offset:128
    ds_read_b128 v[48:51], v3 offset:256
    s_waitcnt lgkmcnt(5)
    v_mfma_f32_32x32x16_bf16 v[80:95], v[32:35], v[24:27], 0
    ds_read_b128 v[52:55], v3 offset:1280
    s_waitcnt lgkmcnt(5)
    v_mfma_f32_32x32x16_bf16 v[96:111], v[36:39], v[24:27], 0
    ds_read_b128 v[56:59], v3 offset:2816
    s_waitcnt lgkmcnt(5)
    v_mfma_f32_32x32x16_bf16 v[112:127], v[40:43], v[24:27], 0
    ds_read_b128 v[24:27], v3 offset:3840
    s_waitcnt lgkmcnt(3)
    v_mfma_f32_32x32x16_bf16 v[64:79], v[48:51], v[44:47], v[64:79]
    ds_read_b64_tr_b16 v[40:41], v4 offset:288
    ds_read_b64_tr_b16 v[42:43], v4 offset:256
    ds_read_b128 v[32:35], v3 offset:128
    s_waitcnt lgkmcnt(5)
    v_mfma_f32_32x32x16_bf16 v[80:95], v[52:55], v[44:47], v[80:95]
    ds_read_b128 v[52:55], v3 offset:1152
    s_waitcnt lgkmcnt(5)
    v_mfma_f32_32x32x16_bf16 v[96:111], v[56:59], v[44:47], v[96:111]
    ds_read_b128 v[56:59], v3 offset:2688
    s_waitcnt lgkmcnt(5)
    v_mfma_f32_32x32x16_bf16 v[112:127], v[24:27], v[44:47], v[112:127]
    ds_read_b128 v[44:47], v3 offset:3712
    s_waitcnt lgkmcnt(3)
    v_mfma_f32_32x32x16_bf16 v[64:79], v[32:35], v[40:43], v[64:79]
    ds_read_b64_tr_b16 v[24:25], v4 offset:416
    ds_read_b64_tr_b16 v[26:27], v4 offset:384
    ds_read_b128 v[32:35], v3 offset:0
    s_waitcnt lgkmcnt(5)
    v_mfma_f32_32x32x16_bf16 v[80:95], v[52:55], v[40:43], v[80:95]
    ds_read_b128 v[52:55], v3 offset:1024
    s_waitcnt lgkmcnt(5)
    v_mfma_f32_32x32x16_bf16 v[96:111], v[56:59], v[40:43], v[96:111]
    ds_read_b128 v[56:59], v3 offset:2560
    s_waitcnt lgkmcnt(5)
    v_mfma_f32_32x32x16_bf16 v[112:127], v[44:47], v[40:43], v[112:127]
    ds_read_b128 v[40:43], v3 offset:3584
    s_waitcnt lgkmcnt(3)
    v_mfma_f32_32x32x16_bf16 v[64:79], v[32:35], v[24:27], v[64:79]
    ds_read_b64_tr_b16 v[44:45], v4 offset:544
    ds_read_b64_tr_b16 v[46:47], v4 offset:512
    ds_read_b128 v[32:35], v3 offset:896
    s_waitcnt lgkmcnt(5)
    v_mfma_f32_32x32x16_bf16 v[80:95], v[52:55], v[24:27], v[80:95]
    ds_read_b128 v[52:55], v3 offset:2432
    s_waitcnt lgkmcnt(5)
    v_mfma_f32_32x32x16_bf16 v[96:111], v[56:59], v[24:27], v[96:111]
    ds_read_b128 v[56:59], v3 offset:3456
    s_waitcnt lgkmcnt(5)
    v_mfma_f32_32x32x16_bf16 v[112:127], v[40:43], v[24:27], v[112:127]
    ds_read_b64_tr_b16 v[24:25], v4 offset:672
    ds_read_b64_tr_b16 v[26:27], v4 offset:640
    ds_read_b128 v[40:43], v3 offset:768
    s_waitcnt lgkmcnt(5)
    v_mfma_f32_32x32x16_bf16 v[80:95], v[32:35], v[44:47], v[80:95]
    v_add_f32_dpp v60, v75, v78 wave_ror:1 row_mask:0xf bank_mask:0xf
    v_add_f32_dpp v61, v71, v74 wave_ror:1 row_mask:0xf bank_mask:0xf
    ds_read_b128 v[32:35], v3 offset:2304
    s_waitcnt lgkmcnt(5)
    v_mfma_f32_32x32x16_bf16 v[96:111], v[52:55], v[44:47], v[96:111]
    v_add_f32_dpp v62, v67, v70 wave_ror:1 row_mask:0xf bank_mask:0xf
    v_add_f32_dpp v60, v79, v78 wave_shr:1 row_mask:0xf bank_mask:0xf
    ds_read_b128 v[52:55], v3 offset:3328
    s_waitcnt lgkmcnt(5)
    v_mfma_f32_32x32x16_bf16 v[112:127], v[56:59], v[44:47], v[112:127]
    v_add_f32_dpp v61, v75, v74 wave_shr:1 row_mask:0xf bank_mask:0xf
    v_add_f32_dpp v62, v71, v70 wave_shr:1 row_mask:0xf bank_mask:0xf
    ds_read_b64_tr_b16 v[44:45], v4 offset:800
    ds_read_b64_tr_b16 v[46:47], v4 offset:768
    ds_read_b128 v[56:59], v3 offset:640
    s_waitcnt lgkmcnt(5)
    v_mfma_f32_32x32x16_bf16 v[80:95], v[40:43], v[24:27], v[80:95]
    v_add_f32_dpp v66, v67, v66 wave_shr:1 row_mask:0xf bank_mask:0xf bound_ctrl:0
    v_add_f32_dpp v78, v61, v77 wave_ror:1 row_mask:0xf bank_mask:0xf
    ds_read_b128 v[40:43], v3 offset:2176
    s_waitcnt lgkmcnt(5)
    v_mfma_f32_32x32x16_bf16 v[96:111], v[32:35], v[24:27], v[96:111]
    v_add_f32_dpp v74, v62, v73 wave_ror:1 row_mask:0xf bank_mask:0xf
    v_add_f32_dpp v70, v66, v69 wave_ror:1 row_mask:0xf bank_mask:0xf
    ds_read_b128 v[32:35], v3 offset:3200
    s_waitcnt lgkmcnt(5)
    v_mfma_f32_32x32x16_bf16 v[112:127], v[52:55], v[24:27], v[112:127]
    v_add_f32_dpp v78, v60, v77 wave_shr:1 row_mask:0xf bank_mask:0xf
    v_add_f32_dpp v74, v61, v73 wave_shr:1 row_mask:0xf bank_mask:0xf
    ds_read_b64_tr_b16 v[24:25], v4 offset:928
    ds_read_b64_tr_b16 v[26:27], v4 offset:896
    ds_read_b128 v[52:55], v3 offset:512
    s_waitcnt lgkmcnt(5)
    v_mfma_f32_32x32x16_bf16 v[80:95], v[56:59], v[44:47], v[80:95]
    v_add_f32_dpp v70, v62, v69 wave_shr:1 row_mask:0xf bank_mask:0xf
    v_add_f32_dpp v65, v66, v65 wave_shr:1 row_mask:0xf bank_mask:0xf bound_ctrl:0
    ds_read_b128 v[56:59], v3 offset:2048
    s_waitcnt lgkmcnt(5)
    v_mfma_f32_32x32x16_bf16 v[96:111], v[40:43], v[44:47], v[96:111]
    v_add_f32_dpp v77, v74, v76 wave_ror:1 row_mask:0xf bank_mask:0xf
    v_add_f32_dpp v73, v70, v72 wave_ror:1 row_mask:0xf bank_mask:0xf
    ds_read_b128 v[40:43], v3 offset:3072
    s_waitcnt lgkmcnt(5)
    v_mfma_f32_32x32x16_bf16 v[112:127], v[32:35], v[44:47], v[112:127]
    v_add_f32_dpp v69, v65, v68 wave_ror:1 row_mask:0xf bank_mask:0xf
    v_add_f32_dpp v77, v78, v76 wave_shr:1 row_mask:0xf bank_mask:0xf
    ds_read_b64_tr_b16 v[44:45], v4 offset:1056
    ds_read_b64_tr_b16 v[46:47], v4 offset:1024
    s_waitcnt lgkmcnt(4)
    v_mfma_f32_32x32x16_bf16 v[80:95], v[52:55], v[24:27], v[80:95]
    v_add_f32_dpp v73, v74, v72 wave_shr:1 row_mask:0xf bank_mask:0xf
    v_add_f32_dpp v69, v70, v68 wave_shr:1 row_mask:0xf bank_mask:0xf
    ds_read_b128 v[32:35], v3 offset:1920
    s_waitcnt lgkmcnt(4)
    v_mfma_f32_32x32x16_bf16 v[96:111], v[56:59], v[24:27], v[96:111]
    s_mov_b32 m0, s29
    v_add_f32_dpp v64, v65, v64 wave_shr:1 row_mask:0xf bank_mask:0xf bound_ctrl:0
    ds_write_addtid_b32 v79 offset:26076
    ds_write_addtid_b32 v60 offset:26072
    s_waitcnt lgkmcnt(5)
    v_mfma_f32_32x32x16_bf16 v[112:127], v[40:43], v[24:27], v[112:127]
    ds_write_addtid_b32 v78 offset:26068
    ds_write_addtid_b32 v77 offset:18368
    ds_read_b64_tr_b16 v[24:25], v4 offset:1184
    ds_read_b64_tr_b16 v[26:27], v4 offset:1152
    s_waitcnt lgkmcnt(7)
    v_mfma_f32_32x32x16_bf16 v[80:95], v[28:31], v[44:47], v[80:95]
    ds_write_addtid_b32 v73 offset:18112
    ds_write_addtid_b32 v69 offset:17856
    ds_read_b128 v[40:43], v3 offset:1792
    s_waitcnt lgkmcnt(9)
    v_mfma_f32_32x32x16_bf16 v[96:111], v[32:35], v[44:47], v[96:111]
    ds_write_addtid_b32 v64 offset:17600
    ds_read_b128 v[28:31], v3 offset:2816
    v_mfma_f32_32x32x16_bf16 v[112:127], v[36:39], v[44:47], v[112:127]
    ds_read_b64_tr_b16 v[36:37], v4 offset:1312
    ds_read_b64_tr_b16 v[38:39], v4 offset:1280
    ds_read_b128 v[44:47], v3 offset:128
    s_waitcnt lgkmcnt(8)
    v_mfma_f32_32x32x16_bf16 v[80:95], v[48:51], v[24:27], v[80:95]
    ds_read_b128 v[48:51], v3 offset:1664
    s_waitcnt lgkmcnt(6)
    v_mfma_f32_32x32x16_bf16 v[96:111], v[40:43], v[24:27], v[96:111]
    ds_read_b128 v[52:55], v3 offset:2688
    s_waitcnt lgkmcnt(5)
    v_mfma_f32_32x32x16_bf16 v[112:127], v[28:31], v[24:27], v[112:127]
    ds_read_b64_tr_b16 v[24:25], v4 offset:1440
    ds_read_b64_tr_b16 v[26:27], v4 offset:1408
    ds_read_b128 v[28:31], v3 offset:0
    s_waitcnt lgkmcnt(5)
    v_mfma_f32_32x32x16_bf16 v[80:95], v[44:47], v[36:39], v[80:95]
    ds_read_b128 v[44:47], v3 offset:1536
    s_waitcnt lgkmcnt(5)
    v_mfma_f32_32x32x16_bf16 v[96:111], v[48:51], v[36:39], v[96:111]
    ds_read_b128 v[48:51], v3 offset:2560
    s_waitcnt lgkmcnt(5)
    v_mfma_f32_32x32x16_bf16 v[112:127], v[52:55], v[36:39], v[112:127]
    ds_read_b64_tr_b16 v[36:37], v4 offset:1568
    ds_read_b64_tr_b16 v[38:39], v4 offset:1536
    ds_read_b128 v[52:55], v3 offset:1408
    s_waitcnt lgkmcnt(5)
    v_mfma_f32_32x32x16_bf16 v[80:95], v[28:31], v[24:27], v[80:95]
    ds_read_b128 v[28:31], v3 offset:2432
    s_waitcnt lgkmcnt(5)
    v_mfma_f32_32x32x16_bf16 v[96:111], v[44:47], v[24:27], v[96:111]
    ds_read_b64_tr_b16 v[44:45], v4 offset:1696
    ds_read_b64_tr_b16 v[46:47], v4 offset:1664
    ds_read_b128 v[40:43], v3 offset:1280
    s_waitcnt lgkmcnt(7)
    v_mfma_f32_32x32x16_bf16 v[112:127], v[48:51], v[24:27], v[112:127]
    ds_read_b128 v[24:27], v3 offset:2304
    s_waitcnt lgkmcnt(5)
    v_mfma_f32_32x32x16_bf16 v[96:111], v[52:55], v[36:39], v[96:111]
    ds_read_b64_tr_b16 v[48:49], v4 offset:1824
    ds_read_b64_tr_b16 v[50:51], v4 offset:1792
    ds_read_b128 v[52:55], v3 offset:1152
    s_waitcnt lgkmcnt(7)
    v_mfma_f32_32x32x16_bf16 v[112:127], v[28:31], v[36:39], v[112:127]
    v_add_f32_dpp v60, v91, v94 wave_ror:1 row_mask:0xf bank_mask:0xf
    v_add_f32_dpp v61, v87, v90 wave_ror:1 row_mask:0xf bank_mask:0xf
    ds_read_b128 v[36:39], v3 offset:2176
    s_waitcnt lgkmcnt(5)
    v_mfma_f32_32x32x16_bf16 v[96:111], v[40:43], v[44:47], v[96:111]
    v_add_f32_dpp v62, v83, v86 wave_ror:1 row_mask:0xf bank_mask:0xf
    v_add_f32_dpp v60, v95, v94 wave_shr:1 row_mask:0xf bank_mask:0xf
    ds_read_b64_tr_b16 v[28:29], v4 offset:1952
    ds_read_b64_tr_b16 v[30:31], v4 offset:1920
    ds_read_b128 v[40:43], v3 offset:1024
    s_waitcnt lgkmcnt(7)
    v_mfma_f32_32x32x16_bf16 v[112:127], v[24:27], v[44:47], v[112:127]
    v_add_f32_dpp v61, v91, v90 wave_shr:1 row_mask:0xf bank_mask:0xf
    v_add_f32_dpp v62, v87, v86 wave_shr:1 row_mask:0xf bank_mask:0xf
    s_waitcnt lgkmcnt(4)
    v_mfma_f32_32x32x16_bf16 v[96:111], v[52:55], v[48:51], v[96:111]
    v_add_f32_dpp v82, v83, v82 wave_shr:1 row_mask:0xf bank_mask:0xf bound_ctrl:0
    v_add_f32_dpp v94, v61, v93 wave_ror:1 row_mask:0xf bank_mask:0xf
    ds_read_b64_tr_b16 v[44:45], v4 offset:2080
    ds_read_b64_tr_b16 v[46:47], v4 offset:2048
    ds_read_b128 v[24:27], v3 offset:896
    s_waitcnt lgkmcnt(6)
    v_mfma_f32_32x32x16_bf16 v[112:127], v[36:39], v[48:51], v[112:127]
    v_add_f32_dpp v90, v62, v89 wave_ror:1 row_mask:0xf bank_mask:0xf
    v_add_f32_dpp v86, v82, v85 wave_ror:1 row_mask:0xf bank_mask:0xf
    s_waitcnt lgkmcnt(3)
    v_mfma_f32_32x32x16_bf16 v[96:111], v[40:43], v[28:31], v[96:111]
    v_add_f32_dpp v94, v60, v93 wave_shr:1 row_mask:0xf bank_mask:0xf
    v_add_f32_dpp v90, v61, v89 wave_shr:1 row_mask:0xf bank_mask:0xf
    ds_read_b64_tr_b16 v[48:49], v4 offset:2208
    ds_read_b64_tr_b16 v[50:51], v4 offset:2176
    ds_read_b128 v[36:39], v3 offset:768
    v_mfma_f32_32x32x16_bf16 v[112:127], v[56:59], v[28:31], v[112:127]
    v_add_f32_dpp v86, v62, v85 wave_shr:1 row_mask:0xf bank_mask:0xf
    v_add_f32_dpp v81, v82, v81 wave_shr:1 row_mask:0xf bank_mask:0xf bound_ctrl:0
    ds_read_b128 v[56:59], v3 offset:1792
    s_waitcnt lgkmcnt(4)
    v_mfma_f32_32x32x16_bf16 v[96:111], v[24:27], v[44:47], v[96:111]
    v_add_f32_dpp v93, v90, v92 wave_ror:1 row_mask:0xf bank_mask:0xf
    v_add_f32_dpp v89, v86, v88 wave_ror:1 row_mask:0xf bank_mask:0xf
    ds_read_b64_tr_b16 v[28:29], v4 offset:2336
    ds_read_b64_tr_b16 v[30:31], v4 offset:2304
    ds_read_b128 v[24:27], v3 offset:640
    v_mfma_f32_32x32x16_bf16 v[112:127], v[32:35], v[44:47], v[112:127]
    v_add_f32_dpp v85, v81, v84 wave_ror:1 row_mask:0xf bank_mask:0xf
    v_add_f32_dpp v93, v94, v92 wave_shr:1 row_mask:0xf bank_mask:0xf
    ds_read_b128 v[32:35], v3 offset:1664
    s_waitcnt lgkmcnt(5)
    v_mfma_f32_32x32x16_bf16 v[96:111], v[36:39], v[48:51], v[96:111]
    v_add_f32_dpp v89, v90, v88 wave_shr:1 row_mask:0xf bank_mask:0xf
    v_add_f32_dpp v85, v86, v84 wave_shr:1 row_mask:0xf bank_mask:0xf
    ds_read_b64_tr_b16 v[44:45], v4 offset:2464
    ds_read_b64_tr_b16 v[46:47], v4 offset:2432
    ds_read_b128 v[36:39], v3 offset:512
    s_waitcnt lgkmcnt(7)
    v_mfma_f32_32x32x16_bf16 v[112:127], v[56:59], v[48:51], v[112:127]
    v_add_f32_dpp v80, v81, v80 wave_shr:1 row_mask:0xf bank_mask:0xf bound_ctrl:0
    ds_write_addtid_b32 v95 offset:26620
    ds_write_addtid_b32 v60 offset:26616
    ds_read_b128 v[48:51], v3 offset:1536
    s_waitcnt lgkmcnt(7)
    v_mfma_f32_32x32x16_bf16 v[96:111], v[24:27], v[28:31], v[96:111]
    ds_write_addtid_b32 v94 offset:26612
    ds_write_addtid_b32 v93 offset:20416
    ds_read_b64_tr_b16 v[56:57], v4 offset:2592
    ds_read_b64_tr_b16 v[58:59], v4 offset:2560
    ds_read_b128 v[24:27], v3 offset:384
    s_waitcnt lgkmcnt(11)
    v_mfma_f32_32x32x16_bf16 v[112:127], v[32:35], v[28:31], v[112:127]
    ds_write_addtid_b32 v89 offset:20160
    ds_write_addtid_b32 v85 offset:19904
    ds_read_b128 v[28:31], v3 offset:1408
    s_waitcnt lgkmcnt(11)
    v_mfma_f32_32x32x16_bf16 v[96:111], v[36:39], v[44:47], v[96:111]
    ds_write_addtid_b32 v80 offset:19648
    ds_read_b64_tr_b16 v[32:33], v4 offset:2720
    ds_read_b64_tr_b16 v[34:35], v4 offset:2688
    ds_read_b128 v[36:39], v3 offset:256
    s_waitcnt lgkmcnt(12)
    v_mfma_f32_32x32x16_bf16 v[112:127], v[48:51], v[44:47], v[112:127]
    ds_read_b128 v[44:47], v3 offset:1280
    s_waitcnt lgkmcnt(8)
    v_mfma_f32_32x32x16_bf16 v[96:111], v[24:27], v[56:59], v[96:111]
    ds_read_b64_tr_b16 v[48:49], v4 offset:2848
    ds_read_b64_tr_b16 v[50:51], v4 offset:2816
    ds_read_b128 v[24:27], v3 offset:128
    s_waitcnt lgkmcnt(8)
    v_mfma_f32_32x32x16_bf16 v[112:127], v[28:31], v[56:59], v[112:127]
    s_waitcnt lgkmcnt(4)
    v_mfma_f32_32x32x16_bf16 v[96:111], v[36:39], v[32:35], v[96:111]
    ds_read_b64_tr_b16 v[56:57], v4 offset:2976
    ds_read_b64_tr_b16 v[58:59], v4 offset:2944
    ds_read_b128 v[28:31], v3 offset:0
    s_waitcnt lgkmcnt(6)
    v_mfma_f32_32x32x16_bf16 v[112:127], v[44:47], v[32:35], v[112:127]
    s_waitcnt lgkmcnt(3)
    v_mfma_f32_32x32x16_bf16 v[96:111], v[24:27], v[48:51], v[96:111]
    ds_read_b64_tr_b16 v[32:33], v4 offset:3104
    ds_read_b64_tr_b16 v[34:35], v4 offset:3072
    ds_read_b128 v[44:47], v3 offset:896
    v_mfma_f32_32x32x16_bf16 v[112:127], v[52:55], v[48:51], v[112:127]
    ds_read_b64_tr_b16 v[52:53], v4 offset:3232
    ds_read_b64_tr_b16 v[54:55], v4 offset:3200
    ds_read_b128 v[48:51], v3 offset:768
    s_waitcnt lgkmcnt(6)
    v_mfma_f32_32x32x16_bf16 v[96:111], v[28:31], v[56:59], v[96:111]
    ds_read_b64_tr_b16 v[28:29], v4 offset:3360
    ds_read_b64_tr_b16 v[30:31], v4 offset:3328
    ds_read_b128 v[24:27], v3 offset:640
    v_mfma_f32_32x32x16_bf16 v[112:127], v[40:43], v[56:59], v[112:127]
    ds_read_b64_tr_b16 v[40:41], v4 offset:3488
    ds_read_b64_tr_b16 v[42:43], v4 offset:3456
    ds_read_b128 v[56:59], v3 offset:512
    s_waitcnt lgkmcnt(9)
    v_mfma_f32_32x32x16_bf16 v[112:127], v[44:47], v[32:35], v[112:127]
    ds_read_b64_tr_b16 v[32:33], v4 offset:3616
    ds_read_b64_tr_b16 v[34:35], v4 offset:3584
    ds_read_b128 v[44:47], v3 offset:384
    s_waitcnt lgkmcnt(9)
    v_mfma_f32_32x32x16_bf16 v[112:127], v[48:51], v[52:55], v[112:127]
    ds_read_b64_tr_b16 v[52:53], v4 offset:3744
    ds_read_b64_tr_b16 v[54:55], v4 offset:3712
    s_waitcnt lgkmcnt(8)
    v_mfma_f32_32x32x16_bf16 v[112:127], v[24:27], v[28:31], v[112:127]
    v_add_f32_dpp v60, v107, v110 wave_ror:1 row_mask:0xf bank_mask:0xf
    v_add_f32_dpp v61, v103, v106 wave_ror:1 row_mask:0xf bank_mask:0xf
    ds_read_b64_tr_b16 v[48:49], v4 offset:3872
    ds_read_b64_tr_b16 v[50:51], v4 offset:3840
    ds_read_b128 v[28:31], v3 offset:128
    s_waitcnt lgkmcnt(8)
    v_mfma_f32_32x32x16_bf16 v[112:127], v[56:59], v[40:43], v[112:127]
    v_add_f32_dpp v62, v99, v102 wave_ror:1 row_mask:0xf bank_mask:0xf
    v_add_f32_dpp v60, v111, v110 wave_shr:1 row_mask:0xf bank_mask:0xf
    ds_read_b64_tr_b16 v[24:25], v4 offset:4000
    ds_read_b64_tr_b16 v[26:27], v4 offset:3968
    ds_read_b128 v[40:43], v3 offset:0
    s_waitcnt lgkmcnt(8)
    v_mfma_f32_32x32x16_bf16 v[112:127], v[44:47], v[32:35], v[112:127]
    v_add_f32_dpp v61, v107, v106 wave_shr:1 row_mask:0xf bank_mask:0xf
    v_add_f32_dpp v62, v103, v102 wave_shr:1 row_mask:0xf bank_mask:0xf
    s_waitcnt lgkmcnt(6)
    v_mfma_f32_32x32x16_bf16 v[112:127], v[36:39], v[52:55], v[112:127]
    v_add_f32_dpp v98, v99, v98 wave_shr:1 row_mask:0xf bank_mask:0xf bound_ctrl:0
    v_add_f32_dpp v110, v61, v109 wave_ror:1 row_mask:0xf bank_mask:0xf
    s_waitcnt lgkmcnt(3)
    v_mfma_f32_32x32x16_bf16 v[112:127], v[28:31], v[48:51], v[112:127]
    v_add_f32_dpp v106, v62, v105 wave_ror:1 row_mask:0xf bank_mask:0xf
    v_add_f32_dpp v102, v98, v101 wave_ror:1 row_mask:0xf bank_mask:0xf
    s_waitcnt lgkmcnt(0)
    v_mfma_f32_32x32x16_bf16 v[112:127], v[40:43], v[24:27], v[112:127]
    v_add_f32_dpp v110, v60, v109 wave_shr:1 row_mask:0xf bank_mask:0xf
    v_add_f32_dpp v106, v61, v105 wave_shr:1 row_mask:0xf bank_mask:0xf
    v_add_f32_dpp v102, v62, v101 wave_shr:1 row_mask:0xf bank_mask:0xf
    v_add_f32_dpp v97, v98, v97 wave_shr:1 row_mask:0xf bank_mask:0xf bound_ctrl:0
    v_add_f32_dpp v109, v106, v108 wave_ror:1 row_mask:0xf bank_mask:0xf
    v_add_f32_dpp v105, v102, v104 wave_ror:1 row_mask:0xf bank_mask:0xf
    v_add_f32_dpp v101, v97, v100 wave_ror:1 row_mask:0xf bank_mask:0xf
    v_add_f32_dpp v109, v110, v108 wave_shr:1 row_mask:0xf bank_mask:0xf
    v_add_f32_dpp v105, v106, v104 wave_shr:1 row_mask:0xf bank_mask:0xf
    v_add_f32_dpp v101, v102, v100 wave_shr:1 row_mask:0xf bank_mask:0xf
    v_add_f32_dpp v96, v97, v96 wave_shr:1 row_mask:0xf bank_mask:0xf bound_ctrl:0
    ds_write_addtid_b32 v111 offset:27436
    ds_write_addtid_b32 v60 offset:27432
    ds_write_addtid_b32 v110 offset:27428
    ds_write_addtid_b32 v109 offset:23488
    ds_write_addtid_b32 v105 offset:23232
    ds_write_addtid_b32 v101 offset:22976
    ds_write_addtid_b32 v96 offset:22720
    v_add_f32_dpp v60, v123, v126 wave_ror:1 row_mask:0xf bank_mask:0xf
    v_add_f32_dpp v61, v119, v122 wave_ror:1 row_mask:0xf bank_mask:0xf
    v_add_f32_dpp v62, v115, v118 wave_ror:1 row_mask:0xf bank_mask:0xf
    v_add_f32_dpp v60, v127, v126 wave_shr:1 row_mask:0xf bank_mask:0xf
    v_add_f32_dpp v61, v123, v122 wave_shr:1 row_mask:0xf bank_mask:0xf
    v_add_f32_dpp v62, v119, v118 wave_shr:1 row_mask:0xf bank_mask:0xf
    v_add_f32_dpp v114, v115, v114 wave_shr:1 row_mask:0xf bank_mask:0xf bound_ctrl:0
    v_add_f32_dpp v126, v61, v125 wave_ror:1 row_mask:0xf bank_mask:0xf
    v_add_f32_dpp v122, v62, v121 wave_ror:1 row_mask:0xf bank_mask:0xf
    v_add_f32_dpp v118, v114, v117 wave_ror:1 row_mask:0xf bank_mask:0xf
    v_add_f32_dpp v126, v60, v125 wave_shr:1 row_mask:0xf bank_mask:0xf
    v_add_f32_dpp v122, v61, v121 wave_shr:1 row_mask:0xf bank_mask:0xf
    v_add_f32_dpp v118, v62, v117 wave_shr:1 row_mask:0xf bank_mask:0xf
    v_add_f32_dpp v113, v114, v113 wave_shr:1 row_mask:0xf bank_mask:0xf bound_ctrl:0
    v_add_f32_dpp v125, v122, v124 wave_ror:1 row_mask:0xf bank_mask:0xf
    v_add_f32_dpp v121, v118, v120 wave_ror:1 row_mask:0xf bank_mask:0xf
    v_add_f32_dpp v117, v113, v116 wave_ror:1 row_mask:0xf bank_mask:0xf
    v_add_f32_dpp v125, v126, v124 wave_shr:1 row_mask:0xf bank_mask:0xf
    v_add_f32_dpp v121, v122, v120 wave_shr:1 row_mask:0xf bank_mask:0xf
    v_add_f32_dpp v117, v118, v116 wave_shr:1 row_mask:0xf bank_mask:0xf
    v_add_f32_dpp v112, v113, v112 wave_shr:1 row_mask:0xf bank_mask:0xf bound_ctrl:0
    ds_write_addtid_b32 v125 offset:25536
    ds_write_addtid_b32 v121 offset:25280
    ds_write_addtid_b32 v117 offset:25024
    ds_write_addtid_b32 v112 offset:24768
    s_waitcnt lgkmcnt(0)
    s_barrier
    ds_read_b128 v[24:27], v5 offset:0
    ds_read_b128 v[28:31], v5 offset:16
    ds_read_b128 v[32:35], v6 offset:0
    ds_read_b128 v[36:39], v5 offset:1024
    ds_read_b128 v[40:43], v5 offset:1040
    ds_read_b128 v[44:47], v6 offset:272
    s_waitcnt lgkmcnt(3)
    s_mov_b64 exec, 5
    v_pk_add_f32 v[24:25], v[24:25], v[32:33]
    v_add_f32 v26, v26, v34
    s_mov_b64 exec, -1
    v_cvt_pk_bf16_f32 v48, v24, v25
    v_cvt_pk_bf16_f32 v49, v26, v27
    v_cvt_pk_bf16_f32 v50, v28, v29
    v_cvt_pk_bf16_f32 v51, v30, v31
    buffer_store_dwordx4 v[48:51], v7, s[4:7], s22 offen sc1
    s_waitcnt lgkmcnt(0)
    s_mov_b64 exec, 5
    v_pk_add_f32 v[36:37], v[36:37], v[44:45]
    v_add_f32 v38, v38, v46
    s_mov_b64 exec, -1
    v_cvt_pk_bf16_f32 v52, v36, v37
    v_cvt_pk_bf16_f32 v53, v38, v39
    v_cvt_pk_bf16_f32 v54, v40, v41
    v_cvt_pk_bf16_f32 v55, v42, v43
    buffer_store_dwordx4 v[52:55], v7, s[4:7], s23 offen sc1
    s_waitcnt lgkmcnt(0)
    s_branch .Lcv1_join
.p2alignl 12, 0xbf810000
.Lpage19:
.Lcv1_odd:
    s_waitcnt vmcnt(0)
.Lchk13:
    buffer_load_dwordx4 v[24:27], v1, s[4:7], s20 offen sc1
    buffer_load_dwordx4 v[28:31], v1, s[4:7], s21 offen sc1
    s_addk_i32 s59, 0x2000
    s_cbranch_scc1 .Lend
    s_waitcnt vmcnt(1)
    v_max3_u32 v32, v24, v25, v26
    v_max_u32 v32, v32, v27
    s_waitcnt vmcnt(0)
    v_max3_u32 v32, v32, v28, v29
    v_max3_u32 v32, v32, v30, v31
    v_cmp_eq_u32 vcc, -1, v32
    s_and_b64 exec, exec, vcc
    s_cbranch_scc1 .Lchk13
    s_mov_b64 exec, -1
    ds_write2_b32 v2, v24, v25 offset0:0 offset1:4
    ds_write2_b32 v2, v26, v27 offset0:8 offset1:12
    ds_write2_b32 v2, v28, v29 offset0:128 offset1:132
    ds_write2_b32 v2, v30, v31 offset0:136 offset1:140
    s_waitcnt lgkmcnt(0)
    s_barrier
    ds_read_b64_tr_b16 v[24:25], v4 offset:32
    ds_read_b64_tr_b16 v[26:27], v4 offset:0
    ds_read_b128 v[28:31], v3 offset:896
    ds_read_b128 v[32:35], v3 offset:1920
    ds_read_b128 v[36:39], v3 offset:2432
    ds_read_b128 v[40:43], v3 offset:3456
    s_waitcnt lgkmcnt(3)
    v_mfma_f32_32x32x16_bf16 v[64:79], v[28:31], v[24:27], 0
    ds_read_b64_tr_b16 v[44:45], v4 offset:160
    ds_read_b64_tr_b16 v[46:47], v4 offset:128
    ds_read_b128 v[48:51], v3 offset:768
    s_waitcnt lgkmcnt(5)
    v_mfma_f32_32x32x16_bf16 v[80:95], v[32:35], v[24:27], 0
    ds_read_b128 v[52:55], v3 offset:1792
    s_waitcnt lgkmcnt(5)
    v_mfma_f32_32x32x16_bf16 v[96:111], v[36:39], v[24:27], 0
    ds_read_b128 v[56:59], v3 offset:2304
    s_waitcnt lgkmcnt(5)
    v_mfma_f32_32x32x16_bf16 v[112:127], v[40:43], v[24:27], 0
    ds_read_b128 v[24:27], v3 offset:3328
    s_waitcnt lgkmcnt(3)
    v_mfma_f32_32x32x16_bf16 v[64:79], v[48:51], v[44:47], v[64:79]
    ds_read_b64_tr_b16 v[40:41], v4 offset:288
    ds_read_b64_tr_b16 v[42:43], v4 offset:256
    ds_read_b128 v[48:51], v3 offset:640
    s_waitcnt lgkmcnt(5)
    v_mfma_f32_32x32x16_bf16 v[80:95], v[52:55], v[44:47], v[80:95]
    ds_read_b128 v[36:39], v3 offset:1664
    s_waitcnt lgkmcnt(5)
    v_mfma_f32_32x32x16_bf16 v[96:111], v[56:59], v[44:47], v[96:111]
    ds_read_b128 v[56:59], v3 offset:2176
    s_waitcnt lgkmcnt(5)
    v_mfma_f32_32x32x16_bf16 v[112:127], v[24:27], v[44:47], v[112:127]
    ds_read_b128 v[44:47], v3 offset:3200
    s_waitcnt lgkmcnt(3)
    v_mfma_f32_32x32x16_bf16 v[64:79], v[48:51], v[40:43], v[64:79]
    ds_read_b64_tr_b16 v[24:25], v4 offset:416
    ds_read_b64_tr_b16 v[26:27], v4 offset:384
    ds_read_b128 v[48:51], v3 offset:512
    s_waitcnt lgkmcnt(5)
    v_mfma_f32_32x32x16_bf16 v[80:95], v[36:39], v[40:43], v[80:95]
    ds_read_b128 v[28:31], v3 offset:1536
    s_waitcnt lgkmcnt(5)
    v_mfma_f32_32x32x16_bf16 v[96:111], v[56:59], v[40:43], v[96:111]
    ds_read_b128 v[56:59], v3 offset:2048
    s_waitcnt lgkmcnt(5)
    v_mfma_f32_32x32x16_bf16 v[112:127], v[44:47], v[40:43], v[112:127]
    ds_read_b128 v[40:43], v3 offset:3072
    s_waitcnt lgkmcnt(3)
    v_mfma_f32_32x32x16_bf16 v[64:79], v[48:51], v[24:27], v[64:79]
    ds_read_b64_tr_b16 v[44:45], v4 offset:544
    ds_read_b64_tr_b16 v[46:47], v4 offset:512
    ds_read_b128 v[48:51], v3 offset:384
    s_waitcnt lgkmcnt(5)
    v_mfma_f32_32x32x16_bf16 v[80:95], v[28:31], v[24:27], v[80:95]
    ds_read_b128 v[28:31], v3 offset:1408
    s_waitcnt lgkmcnt(5)
    v_mfma_f32_32x32x16_bf16 v[96:111], v[56:59], v[24:27], v[96:111]
    s_waitcnt lgkmcnt(4)
    v_mfma_f32_32x32x16_bf16 v[112:127], v[40:43], v[24:27], v[112:127]
    ds_read_b128 v[24:27], v3 offset:2944
    s_waitcnt lgkmcnt(2)
    v_mfma_f32_32x32x16_bf16 v[64:79], v[48:51], v[44:47], v[64:79]
    ds_read_b64_tr_b16 v[40:41], v4 offset:672
    ds_read_b64_tr_b16 v[42:43], v4 offset:640
    ds_read_b128 v[48:51], v3 offset:256
    s_waitcnt lgkmcnt(4)
    v_mfma_f32_32x32x16_bf16 v[80:95], v[28:31], v[44:47], v[80:95]
    ds_read_b128 v[56:59], v3 offset:1280
    v_mfma_f32_32x32x16_bf16 v[96:111], v[32:35], v[44:47], v[96:111]
    s_waitcnt lgkmcnt(4)
    v_mfma_f32_32x32x16_bf16 v[112:127], v[24:27], v[44:47], v[112:127]
    ds_read_b128 v[44:47], v3 offset:2816
    s_waitcnt lgkmcnt(2)
    v_mfma_f32_32x32x16_bf16 v[64:79], v[48:51], v[40:43], v[64:79]
    ds_read_b64_tr_b16 v[24:25], v4 offset:800
    ds_read_b64_tr_b16 v[26:27], v4 offset:768
    ds_read_b128 v[48:51], v3 offset:128
    s_waitcnt lgkmcnt(4)
    v_mfma_f32_32x32x16_bf16 v[80:95], v[56:59], v[40:43], v[80:95]
    ds_read_b128 v[32:35], v3 offset:1152
    v_mfma_f32_32x32x16_bf16 v[96:111], v[52:55], v[40:43], v[96:111]
    s_waitcnt lgkmcnt(4)
    v_mfma_f32_32x32x16_bf16 v[112:127], v[44:47], v[40:43], v[112:127]
    ds_read_b128 v[40:43], v3 offset:2688
    s_waitcnt lgkmcnt(2)
    v_mfma_f32_32x32x16_bf16 v[64:79], v[48:51], v[24:27], v[64:79]
    ds_read_b64_tr_b16 v[44:45], v4 offset:928
    ds_read_b64_tr_b16 v[46:47], v4 offset:896
    ds_read_b128 v[48:51], v3 offset:0
    s_waitcnt lgkmcnt(4)
    v_mfma_f32_32x32x16_bf16 v[80:95], v[32:35], v[24:27], v[80:95]
    ds_read_b128 v[52:55], v3 offset:1024
    v_mfma_f32_32x32x16_bf16 v[96:111], v[36:39], v[24:27], v[96:111]
    ds_read_b128 v[36:39], v3 offset:1536
    s_waitcnt lgkmcnt(5)
    v_mfma_f32_32x32x16_bf16 v[112:127], v[40:43], v[24:27], v[112:127]
    ds_read_b128 v[24:27], v3 offset:2560
    s_waitcnt lgkmcnt(3)
    v_mfma_f32_32x32x16_bf16 v[64:79], v[48:51], v[44:47], v[64:79]
    ds_read_b64_tr_b16 v[40:41], v4 offset:1056
    ds_read_b64_tr_b16 v[42:43], v4 offset:1024
    ds_read_b128 v[48:51], v3 offset:896
    s_waitcnt lgkmcnt(5)
    v_mfma_f32_32x32x16_bf16 v[80:95], v[52:55], v[44:47], v[80:95]
    s_waitcnt lgkmcnt(4)
    v_mfma_f32_32x32x16_bf16 v[96:111], v[36:39], v[44:47], v[96:111]
    ds_read_b128 v[36:39], v3 offset:2432
    s_waitcnt lgkmcnt(4)
    v_mfma_f32_32x32x16_bf16 v[112:127], v[24:27], v[44:47], v[112:127]
    ds_read_b64_tr_b16 v[44:45], v4 offset:1184
    ds_read_b64_tr_b16 v[46:47], v4 offset:1152
    ds_read_b128 v[24:27], v3 offset:768
    s_waitcnt lgkmcnt(4)
    v_mfma_f32_32x32x16_bf16 v[80:95], v[48:51], v[40:43], v[80:95]
    v_add_f32_dpp v60, v75, v78 wave_ror:1 row_mask:0xf bank_mask:0xf
    v_add_f32_dpp v61, v71, v74 wave_ror:1 row_mask:0xf bank_mask:0xf
    v_mfma_f32_32x32x16_bf16 v[96:111], v[28:31], v[40:43], v[96:111]
    v_add_f32_dpp v62, v67, v70 wave_ror:1 row_mask:0xf bank_mask:0xf
    v_add_f32_dpp v60, v79, v78 wave_shr:1 row_mask:0xf bank_mask:0xf
    ds_read_b128 v[28:31], v3 offset:2304
    s_waitcnt lgkmcnt(4)
    v_mfma_f32_32x32x16_bf16 v[112:127], v[36:39], v[40:43], v[112:127]
    v_add_f32_dpp v61, v75, v74 wave_shr:1 row_mask:0xf bank_mask:0xf
    v_add_f32_dpp v62, v71, v70 wave_shr:1 row_mask:0xf bank_mask:0xf
    ds_read_b64_tr_b16 v[40:41], v4 offset:1312
    ds_read_b64_tr_b16 v[42:43], v4 offset:1280
    ds_read_b128 v[36:39], v3 offset:640
    s_waitcnt lgkmcnt(4)
    v_mfma_f32_32x32x16_bf16 v[80:95], v[24:27], v[44:47], v[80:95]
    v_add_f32_dpp v66, v67, v66 wave_shr:1 row_mask:0xf bank_mask:0xf bound_ctrl:0
    v_add_f32_dpp v78, v61, v77 wave_ror:1 row_mask:0xf bank_mask:0xf
    v_mfma_f32_32x32x16_bf16 v[96:111], v[56:59], v[44:47], v[96:111]
    v_add_f32_dpp v74, v62, v73 wave_ror:1 row_mask:0xf bank_mask:0xf
    v_add_f32_dpp v70, v66, v69 wave_ror:1 row_mask:0xf bank_mask:0xf
    ds_read_b128 v[56:59], v3 offset:2176
    s_waitcnt lgkmcnt(4)
    v_mfma_f32_32x32x16_bf16 v[112:127], v[28:31], v[44:47], v[112:127]
    v_add_f32_dpp v78, v60, v77 wave_shr:1 row_mask:0xf bank_mask:0xf
    v_add_f32_dpp v74, v61, v73 wave_shr:1 row_mask:0xf bank_mask:0xf
    ds_read_b64_tr_b16 v[44:45], v4 offset:1440
    ds_read_b64_tr_b16 v[46:47], v4 offset:1408
    ds_read_b128 v[28:31], v3 offset:512
    s_waitcnt lgkmcnt(4)
    v_mfma_f32_32x32x16_bf16 v[80:95], v[36:39], v[40:43], v[80:95]
    v_add_f32_dpp v70, v62, v69 wave_shr:1 row_mask:0xf bank_mask:0xf
    v_add_f32_dpp v65, v66, v65 wave_shr:1 row_mask:0xf bank_mask:0xf bound_ctrl:0
    v_mfma_f32_32x32x16_bf16 v[96:111], v[32:35], v[40:43], v[96:111]
    v_add_f32_dpp v77, v74, v76 wave_ror:1 row_mask:0xf bank_mask:0xf
    v_add_f32_dpp v73, v70, v72 wave_ror:1 row_mask:0xf bank_mask:0xf
    ds_read_b128 v[32:35], v3 offset:2048
    s_waitcnt lgkmcnt(4)
    v_mfma_f32_32x32x16_bf16 v[112:127], v[56:59], v[40:43], v[112:127]
    v_add_f32_dpp v69, v65, v68 wave_ror:1 row_mask:0xf bank_mask:0xf
    v_add_f32_dpp v77, v78, v76 wave_shr:1 row_mask:0xf bank_mask:0xf
    ds_read_b64_tr_b16 v[40:41], v4 offset:1568
    ds_read_b64_tr_b16 v[42:43], v4 offset:1536
    ds_read_b128 v[56:59], v3 offset:384
    s_waitcnt lgkmcnt(4)
    v_mfma_f32_32x32x16_bf16 v[80:95], v[28:31], v[44:47], v[80:95]
    v_add_f32_dpp v73, v74, v72 wave_shr:1 row_mask:0xf bank_mask:0xf
    v_add_f32_dpp v69, v70, v68 wave_shr:1 row_mask:0xf bank_mask:0xf
    v_mfma_f32_32x32x16_bf16 v[96:111], v[52:55], v[44:47], v[96:111]
    s_mov_b32 m0, s29
    v_add_f32_dpp v64, v65, v64 wave_shr:1 row_mask:0xf bank_mask:0xf bound_ctrl:0
    ds_write_addtid_b32 v79 offset:26348
    ds_write_addtid_b32 v60 offset:26344
    ds_read_b128 v[52:55], v3 offset:1920
    s_waitcnt lgkmcnt(6)
    v_mfma_f32_32x32x16_bf16 v[112:127], v[32:35], v[44:47], v[112:127]
    ds_write_addtid_b32 v78 offset:26340
    ds_write_addtid_b32 v77 offset:19392
    ds_read_b64_tr_b16 v[44:45], v4 offset:1696
    ds_read_b64_tr_b16 v[46:47], v4 offset:1664
    ds_read_b128 v[32:35], v3 offset:256
    s_waitcnt lgkmcnt(8)
    v_mfma_f32_32x32x16_bf16 v[80:95], v[56:59], v[40:43], v[80:95]
    ds_write_addtid_b32 v73 offset:19136
    ds_write_addtid_b32 v69 offset:18880
    v_mfma_f32_32x32x16_bf16 v[96:111], v[48:51], v[40:43], v[96:111]
    ds_write_addtid_b32 v64 offset:18624
    ds_read_b128 v[48:51], v3 offset:1792
    s_waitcnt lgkmcnt(9)
    v_mfma_f32_32x32x16_bf16 v[112:127], v[52:55], v[40:43], v[112:127]
    ds_read_b64_tr_b16 v[40:41], v4 offset:1824
    ds_read_b64_tr_b16 v[42:43], v4 offset:1792
    ds_read_b128 v[52:55], v3 offset:128
    s_waitcnt lgkmcnt(7)
    v_mfma_f32_32x32x16_bf16 v[80:95], v[32:35], v[44:47], v[80:95]
    v_mfma_f32_32x32x16_bf16 v[96:111], v[24:27], v[44:47], v[96:111]
    ds_read_b128 v[24:27], v3 offset:1664
    s_waitcnt lgkmcnt(4)
    v_mfma_f32_32x32x16_bf16 v[112:127], v[48:51], v[44:47], v[112:127]
    ds_read_b64_tr_b16 v[44:45], v4 offset:1952
    ds_read_b64_tr_b16 v[46:47], v4 offset:1920
    ds_read_b128 v[48:51], v3 offset:0
    s_waitcnt lgkmcnt(4)
    v_mfma_f32_32x32x16_bf16 v[80:95], v[52:55], v[40:43], v[80:95]
    v_mfma_f32_32x32x16_bf16 v[96:111], v[36:39], v[40:43], v[96:111]
    ds_read_b128 v[36:39], v3 offset:1536
    s_waitcnt lgkmcnt(4)
    v_mfma_f32_32x32x16_bf16 v[112:127], v[24:27], v[40:43], v[112:127]
    ds_read_b64_tr_b16 v[40:41], v4 offset:2080
    ds_read_b64_tr_b16 v[42:43], v4 offset:2048
    s_waitcnt lgkmcnt(3)
    v_mfma_f32_32x32x16_bf16 v[80:95], v[48:51], v[44:47], v[80:95]
    ds_read_b128 v[24:27], v3 offset:1408
    v_mfma_f32_32x32x16_bf16 v[96:111], v[28:31], v[44:47], v[96:111]
    ds_read_b64_tr_b16 v[28:29], v4 offset:2208
    ds_read_b64_tr_b16 v[30:31], v4 offset:2176
    s_waitcnt lgkmcnt(5)
    v_mfma_f32_32x32x16_bf16 v[112:127], v[36:39], v[44:47], v[112:127]
    ds_read_b128 v[44:47], v3 offset:1280
    s_waitcnt lgkmcnt(4)
    v_mfma_f32_32x32x16_bf16 v[96:111], v[56:59], v[40:43], v[96:111]
    ds_read_b64_tr_b16 v[36:37], v4 offset:2336
    ds_read_b64_tr_b16 v[38:39], v4 offset:2304
    s_waitcnt lgkmcnt(5)
    v_mfma_f32_32x32x16_bf16 v[112:127], v[24:27], v[40:43], v[112:127]
    v_add_f32_dpp v60, v91, v94 wave_ror:1 row_mask:0xf bank_mask:0xf
    v_add_f32_dpp v61, v87, v90 wave_ror:1 row_mask:0xf bank_mask:0xf
    ds_read_b128 v[40:43], v3 offset:1152
    s_waitcnt lgkmcnt(4)
    v_mfma_f32_32x32x16_bf16 v[96:111], v[32:35], v[28:31], v[96:111]
    v_add_f32_dpp v62, v83, v86 wave_ror:1 row_mask:0xf bank_mask:0xf
    v_add_f32_dpp v60, v95, v94 wave_shr:1 row_mask:0xf bank_mask:0xf
    ds_read_b64_tr_b16 v[24:25], v4 offset:2464
    ds_read_b64_tr_b16 v[26:27], v4 offset:2432
    s_waitcnt lgkmcnt(5)
    v_mfma_f32_32x32x16_bf16 v[112:127], v[44:47], v[28:31], v[112:127]
    v_add_f32_dpp v61, v91, v90 wave_shr:1 row_mask:0xf bank_mask:0xf
    v_add_f32_dpp v62, v87, v86 wave_shr:1 row_mask:0xf bank_mask:0xf
    ds_read_b128 v[28:31], v3 offset:1024
    s_waitcnt lgkmcnt(4)
    v_mfma_f32_32x32x16_bf16 v[96:111], v[52:55], v[36:39], v[96:111]
    v_add_f32_dpp v82, v83, v82 wave_shr:1 row_mask:0xf bank_mask:0xf bound_ctrl:0
    v_add_f32_dpp v94, v61, v93 wave_ror:1 row_mask:0xf bank_mask:0xf
    ds_read_b64_tr_b16 v[44:45], v4 offset:2592
    ds_read_b64_tr_b16 v[46:47], v4 offset:2560
    ds_read_b128 v[52:55], v3 offset:896
    s_waitcnt lgkmcnt(6)
    v_mfma_f32_32x32x16_bf16 v[112:127], v[40:43], v[36:39], v[112:127]
    v_add_f32_dpp v90, v62, v89 wave_ror:1 row_mask:0xf bank_mask:0xf
    v_add_f32_dpp v86, v82, v85 wave_ror:1 row_mask:0xf bank_mask:0xf
    ds_read_b64_tr_b16 v[36:37], v4 offset:2720
    ds_read_b64_tr_b16 v[38:39], v4 offset:2688
    ds_read_b128 v[40:43], v3 offset:768
    s_waitcnt lgkmcnt(7)
    v_mfma_f32_32x32x16_bf16 v[96:111], v[48:51], v[24:27], v[96:111]
    v_add_f32_dpp v94, v60, v93 wave_shr:1 row_mask:0xf bank_mask:0xf
    v_add_f32_dpp v90, v61, v89 wave_shr:1 row_mask:0xf bank_mask:0xf
    ds_read_b64_tr_b16 v[48:49], v4 offset:2848
    ds_read_b64_tr_b16 v[50:51], v4 offset:2816
    ds_read_b128 v[32:35], v3 offset:640
    s_waitcnt lgkmcnt(9)
    v_mfma_f32_32x32x16_bf16 v[112:127], v[28:31], v[24:27], v[112:127]
    v_add_f32_dpp v86, v62, v85 wave_shr:1 row_mask:0xf bank_mask:0xf
    v_add_f32_dpp v81, v82, v81 wave_shr:1 row_mask:0xf bank_mask:0xf bound_ctrl:0
    ds_read_b64_tr_b16 v[24:25], v4 offset:2976
    ds_read_b64_tr_b16 v[26:27], v4 offset:2944
    ds_read_b128 v[28:31], v3 offset:512
    s_waitcnt lgkmcnt(9)
    v_mfma_f32_32x32x16_bf16 v[112:127], v[52:55], v[44:47], v[112:127]
    v_add_f32_dpp v93, v90, v92 wave_ror:1 row_mask:0xf bank_mask:0xf
    v_add_f32_dpp v89, v86, v88 wave_ror:1 row_mask:0xf bank_mask:0xf
    ds_read_b64_tr_b16 v[44:45], v4 offset:3104
    ds_read_b64_tr_b16 v[46:47], v4 offset:3072
    s_waitcnt lgkmcnt(8)
    v_mfma_f32_32x32x16_bf16 v[112:127], v[40:43], v[36:39], v[112:127]
    v_add_f32_dpp v85, v81, v84 wave_ror:1 row_mask:0xf bank_mask:0xf
    v_add_f32_dpp v93, v94, v92 wave_shr:1 row_mask:0xf bank_mask:0xf
    ds_read_b64_tr_b16 v[52:53], v4 offset:3232
    ds_read_b64_tr_b16 v[54:55], v4 offset:3200
    ds_read_b128 v[36:39], v3 offset:256
    s_waitcnt lgkmcnt(8)
    v_mfma_f32_32x32x16_bf16 v[112:127], v[32:35], v[48:51], v[112:127]
    v_add_f32_dpp v89, v90, v88 wave_shr:1 row_mask:0xf bank_mask:0xf
    v_add_f32_dpp v85, v86, v84 wave_shr:1 row_mask:0xf bank_mask:0xf
    ds_read_b64_tr_b16 v[40:41], v4 offset:3360
    ds_read_b64_tr_b16 v[42:43], v4 offset:3328
    ds_read_b128 v[48:51], v3 offset:128
    s_waitcnt lgkmcnt(8)
    v_mfma_f32_32x32x16_bf16 v[112:127], v[28:31], v[24:27], v[112:127]
    v_add_f32_dpp v80, v81, v80 wave_shr:1 row_mask:0xf bank_mask:0xf bound_ctrl:0
    ds_write_addtid_b32 v95 offset:26892
    ds_write_addtid_b32 v60 offset:26888
    ds_read_b64_tr_b16 v[32:33], v4 offset:3488
    ds_read_b64_tr_b16 v[34:35], v4 offset:3456
    ds_read_b128 v[24:27], v3 offset:0
    s_waitcnt lgkmcnt(11)
    v_mfma_f32_32x32x16_bf16 v[112:127], v[56:59], v[44:47], v[112:127]
    ds_write_addtid_b32 v94 offset:26884
    ds_write_addtid_b32 v93 offset:21440
    s_waitcnt lgkmcnt(10)
    v_mfma_f32_32x32x16_bf16 v[112:127], v[36:39], v[52:55], v[112:127]
    ds_write_addtid_b32 v89 offset:21184
    ds_write_addtid_b32 v85 offset:20928
    s_waitcnt lgkmcnt(9)
    v_mfma_f32_32x32x16_bf16 v[112:127], v[48:51], v[40:43], v[112:127]
    ds_write_addtid_b32 v80 offset:20672
    v_add_f32_dpp v60, v107, v110 wave_ror:1 row_mask:0xf bank_mask:0xf
    s_waitcnt lgkmcnt(5)
    v_mfma_f32_32x32x16_bf16 v[112:127], v[24:27], v[32:35], v[112:127]
    v_add_f32_dpp v61, v103, v106 wave_ror:1 row_mask:0xf bank_mask:0xf
    v_add_f32_dpp v62, v99, v102 wave_ror:1 row_mask:0xf bank_mask:0xf
    v_add_f32_dpp v60, v111, v110 wave_shr:1 row_mask:0xf bank_mask:0xf
    v_add_f32_dpp v61, v107, v106 wave_shr:1 row_mask:0xf bank_mask:0xf
    v_add_f32_dpp v62, v103, v102 wave_shr:1 row_mask:0xf bank_mask:0xf
    v_add_f32_dpp v98, v99, v98 wave_shr:1 row_mask:0xf bank_mask:0xf bound_ctrl:0
    v_add_f32_dpp v110, v61, v109 wave_ror:1 row_mask:0xf bank_mask:0xf
    v_add_f32_dpp v106, v62, v105 wave_ror:1 row_mask:0xf bank_mask:0xf
    v_add_f32_dpp v102, v98, v101 wave_ror:1 row_mask:0xf bank_mask:0xf
    v_add_f32_dpp v110, v60, v109 wave_shr:1 row_mask:0xf bank_mask:0xf
    v_add_f32_dpp v106, v61, v105 wave_shr:1 row_mask:0xf bank_mask:0xf
    v_add_f32_dpp v102, v62, v101 wave_shr:1 row_mask:0xf bank_mask:0xf
    v_add_f32_dpp v97, v98, v97 wave_shr:1 row_mask:0xf bank_mask:0xf bound_ctrl:0
    v_add_f32_dpp v109, v106, v108 wave_ror:1 row_mask:0xf bank_mask:0xf
    v_add_f32_dpp v105, v102, v104 wave_ror:1 row_mask:0xf bank_mask:0xf
    v_add_f32_dpp v101, v97, v100 wave_ror:1 row_mask:0xf bank_mask:0xf
    v_add_f32_dpp v109, v110, v108 wave_shr:1 row_mask:0xf bank_mask:0xf
    v_add_f32_dpp v105, v106, v104 wave_shr:1 row_mask:0xf bank_mask:0xf
    v_add_f32_dpp v101, v102, v100 wave_shr:1 row_mask:0xf bank_mask:0xf
    v_add_f32_dpp v96, v97, v96 wave_shr:1 row_mask:0xf bank_mask:0xf bound_ctrl:0
    ds_write_addtid_b32 v111 offset:27164
    ds_write_addtid_b32 v60 offset:27160
    ds_write_addtid_b32 v110 offset:27156
    ds_write_addtid_b32 v109 offset:22464
    ds_write_addtid_b32 v105 offset:22208
    ds_write_addtid_b32 v101 offset:21952
    ds_write_addtid_b32 v96 offset:21696
    v_add_f32_dpp v60, v123, v126 wave_ror:1 row_mask:0xf bank_mask:0xf
    v_add_f32_dpp v61, v119, v122 wave_ror:1 row_mask:0xf bank_mask:0xf
    v_add_f32_dpp v62, v115, v118 wave_ror:1 row_mask:0xf bank_mask:0xf
    v_add_f32_dpp v60, v127, v126 wave_shr:1 row_mask:0xf bank_mask:0xf
    v_add_f32_dpp v61, v123, v122 wave_shr:1 row_mask:0xf bank_mask:0xf
    v_add_f32_dpp v62, v119, v118 wave_shr:1 row_mask:0xf bank_mask:0xf
    v_add_f32_dpp v114, v115, v114 wave_shr:1 row_mask:0xf bank_mask:0xf bound_ctrl:0
    v_add_f32_dpp v126, v61, v125 wave_ror:1 row_mask:0xf bank_mask:0xf
    v_add_f32_dpp v122, v62, v121 wave_ror:1 row_mask:0xf bank_mask:0xf
    v_add_f32_dpp v118, v114, v117 wave_ror:1 row_mask:0xf bank_mask:0xf
    v_add_f32_dpp v126, v60, v125 wave_shr:1 row_mask:0xf bank_mask:0xf
    v_add_f32_dpp v122, v61, v121 wave_shr:1 row_mask:0xf bank_mask:0xf
    v_add_f32_dpp v118, v62, v117 wave_shr:1 row_mask:0xf bank_mask:0xf
    v_add_f32_dpp v113, v114, v113 wave_shr:1 row_mask:0xf bank_mask:0xf bound_ctrl:0
    v_add_f32_dpp v125, v122, v124 wave_ror:1 row_mask:0xf bank_mask:0xf
    v_add_f32_dpp v121, v118, v120 wave_ror:1 row_mask:0xf bank_mask:0xf
    v_add_f32_dpp v117, v113, v116 wave_ror:1 row_mask:0xf bank_mask:0xf
    v_add_f32_dpp v125, v126, v124 wave_shr:1 row_mask:0xf bank_mask:0xf
    v_add_f32_dpp v121, v122, v120 wave_shr:1 row_mask:0xf bank_mask:0xf
    v_add_f32_dpp v117, v118, v116 wave_shr:1 row_mask:0xf bank_mask:0xf
    v_add_f32_dpp v112, v113, v112 wave_shr:1 row_mask:0xf bank_mask:0xf bound_ctrl:0
    ds_write_addtid_b32 v127 offset:27708
    ds_write_addtid_b32 v60 offset:27704
    ds_write_addtid_b32 v126 offset:27700
    ds_write_addtid_b32 v125 offset:24512
    ds_write_addtid_b32 v121 offset:24256
    ds_write_addtid_b32 v117 offset:24000
    ds_write_addtid_b32 v112 offset:23744
    s_waitcnt lgkmcnt(0)
    s_barrier
    ds_read_b128 v[24:27], v5 offset:0
    ds_read_b128 v[28:31], v5 offset:16
    ds_read_b128 v[32:35], v6 offset:0
    ds_read_b128 v[36:39], v5 offset:1024
    ds_read_b128 v[40:43], v5 offset:1040
    ds_read_b128 v[44:47], v6 offset:272
    s_waitcnt lgkmcnt(3)
    s_mov_b64 exec, 5
    v_pk_add_f32 v[24:25], v[24:25], v[32:33]
    v_add_f32 v26, v26, v34
    s_mov_b64 exec, -1
    v_cvt_pk_bf16_f32 v48, v24, v25
    v_cvt_pk_bf16_f32 v49, v26, v27
    v_cvt_pk_bf16_f32 v50, v28, v29
    v_cvt_pk_bf16_f32 v51, v30, v31
    buffer_store_dwordx4 v[48:51], v7, s[4:7], s22 offen sc1
    s_waitcnt lgkmcnt(0)
    s_mov_b64 exec, 5
    v_pk_add_f32 v[36:37], v[36:37], v[44:45]
    v_add_f32 v38, v38, v46
    s_mov_b64 exec, -1
    v_cvt_pk_bf16_f32 v52, v36, v37
    v_cvt_pk_bf16_f32 v53, v38, v39
    v_cvt_pk_bf16_f32 v54, v40, v41
    v_cvt_pk_bf16_f32 v55, v42, v43
    buffer_store_dwordx4 v[52:55], v7, s[4:7], s23 offen sc1
    s_waitcnt lgkmcnt(0)
.Lcv1_join:
    v_mbcnt_lo_u32_b32 v4, -1, 0
    v_mbcnt_hi_u32_b32 v4, -1, v4
    v_lshrrev_b32 v5, 5, v4
    v_and_b32 v6, 31, v4
    v_lshlrev_b32 v1, 10, v5
    v_lshl_add_u32 v1, v6, 4, v1
    v_lshlrev_b32 v2, 2, v4
    v_and_b32 v6, 7, v4
    v_lshlrev_b32 v3, 4, v6
    v_lshl_add_u32 v3, v5, 7, v3
    v_bfe_u32 v6, v4, 3, 2
    v_lshl_add_u32 v3, v6, 8, v3
    s_lshl_b32 s22, s46, 3
    s_add_u32 s22, s22, s44
    s_lshl_b32 s22, s22, 11
    s_add_u32 s20, s22, 77070336
    s_lshl_b32 s21, s45, 8
    s_add_u32 s21, s21, s20
    s_and_b32 s42, s31, 8192
    s_add_u32 s20, s20, s42
    s_add_u32 s21, s21, s42
    s_xor_b32 s28, s21, 8192
    s_add_u32 s22, s22, s31
    s_add_u32 s23, s22, 4718592
    s_add_u32 s22, s22, 5242880
    s_mov_b32 s24, 0x11111111
    s_mov_b32 s25, s24
    s_mov_b32 s26, 0xbb000000
    s_mov_b32 s27, 0x3b000000
    v_and_b32 v6, 31, v4
    v_lshlrev_b32 v6, 5, v6
    v_lshl_add_u32 v6, v5, 4, v6
    s_mov_b32 s34, 0x3f80
    s_mov_b32 s35, 0x3f800000
    s_min_u32 s42, s48, 27
    s_lshl_b32 s42, s42, 7
    s_lshl_b32 s41, s44, 5
    s_add_u32 s42, s42, s41
    v_lshl_add_u32 v64, v5, 4, s42
    global_load_dwordx4 v[120:123], v64, s[36:37]
    s_lshl_b32 s42, s46, 7
    s_add_u32 s42, s42, s41
    v_lshl_add_u32 v65, v5, 4, s42
    global_load_dwordx4 v[124:127], v65, s[38:39]
    s_waitcnt vmcnt(2)
.Lchk14:
    buffer_load_dwordx4 v[56:59], v6, s[4:7], s23 offen sc1
    buffer_load_dwordx4 v[60:63], v6, s[4:7], s23 offen offset:1024 sc1
    s_addk_i32 s59, 0x2000
    s_cbranch_scc1 .Lend
    s_waitcnt vmcnt(1)
    v_max3_u32 v40, v56, v57, v58
    v_max_u32 v40, v40, v59
    s_waitcnt vmcnt(0)
    v_max3_u32 v40, v40, v60, v61
    v_max3_u32 v40, v40, v62, v63
    v_cmp_eq_u32 vcc, -1, v40
    s_and_b64 exec, exec, vcc
    s_cbranch_scc1 .Lchk14
    s_mov_b64 exec, -1
    v_dot2c_f32_bf16 v8, s34, v56
    v_dot2c_f32_bf16 v9, s35, v56
    v_dot2c_f32_bf16 v10, s34, v57
    v_dot2c_f32_bf16 v11, s35, v57
    v_dot2c_f32_bf16 v12, s34, v58
    v_dot2c_f32_bf16 v13, s35, v58
    v_dot2c_f32_bf16 v14, s34, v59
    v_dot2c_f32_bf16 v15, s35, v59
    v_dot2c_f32_bf16 v16, s34, v60
    v_dot2c_f32_bf16 v17, s35, v60
    v_dot2c_f32_bf16 v18, s34, v61
    v_dot2c_f32_bf16 v19, s35, v61
    v_dot2c_f32_bf16 v20, s34, v62
    v_dot2c_f32_bf16 v21, s35, v62
    v_dot2c_f32_bf16 v22, s34, v63
    v_dot2c_f32_bf16 v23, s35, v63
    v_pk_mul_f32 v[32:33], v[8:9], v[8:9]
    v_pk_mul_f32 v[34:35], v[10:11], v[10:11]
    v_pk_mul_f32 v[36:37], v[12:13], v[12:13]
    v_pk_mul_f32 v[38:39], v[14:15], v[14:15]
    v_pk_add_f32 v[24:25], v[8:9], v[16:17]
    v_pk_add_f32 v[26:27], v[10:11], v[18:19]
    v_pk_add_f32 v[28:29], v[12:13], v[20:21]
    v_pk_add_f32 v[30:31], v[14:15], v[22:23]
    v_pk_fma_f32 v[32:33], v[16:17], v[16:17], v[32:33]
    v_pk_fma_f32 v[34:35], v[18:19], v[18:19], v[34:35]
    v_pk_fma_f32 v[36:37], v[20:21], v[20:21], v[36:37]
    v_pk_fma_f32 v[38:39], v[22:23], v[22:23], v[38:39]
    v_permlane16_swap_b32 v24, v28
    v_permlane16_swap_b32 v25, v29
    v_permlane16_swap_b32 v26, v30
    v_permlane16_swap_b32 v27, v31
    v_permlane16_swap_b32 v32, v36
    v_permlane16_swap_b32 v33, v37
    v_permlane16_swap_b32 v34, v38
    v_permlane16_swap_b32 v35, v39
    v_pk_add_f32 v[24:25], v[24:25], v[28:29]
    v_pk_add_f32 v[26:27], v[26:27], v[30:31]
    v_pk_add_f32 v[32:33], v[32:33], v[36:37]
    v_pk_add_f32 v[34:35], v[34:35], v[38:39]
    v_add_f32_dpp v24, v24, v24 row_mirror row_mask:0xf bank_mask:0x3
    v_add_f32_dpp v25, v25, v25 row_mirror row_mask:0xf bank_mask:0x3
    v_add_f32_dpp v32, v32, v32 row_mirror row_mask:0xf bank_mask:0x3
    v_add_f32_dpp v33, v33, v33 row_mirror row_mask:0xf bank_mask:0x3
    v_add_f32_dpp v24, v26, v26 row_mirror row_mask:0xf bank_mask:0xc
    v_add_f32_dpp v25, v27, v27 row_mirror row_mask:0xf bank_mask:0xc
    v_add_f32_dpp v32, v34, v34 row_mirror row_mask:0xf bank_mask:0xc
    v_add_f32_dpp v33, v35, v35 row_mirror row_mask:0xf bank_mask:0xc
    v_add_f32_dpp v24, v24, v24 row_half_mirror row_mask:0xf bank_mask:0x5
    v_add_f32_dpp v32, v32, v32 row_half_mirror row_mask:0xf bank_mask:0x5
    v_add_f32_dpp v24, v25, v25 row_half_mirror row_mask:0xf bank_mask:0xa
    v_add_f32_dpp v32, v33, v33 row_half_mirror row_mask:0xf bank_mask:0xa
    v_mov_b32 v25, s47
    v_add_f32_dpp v24, v24, v24 quad_perm:[2,3,0,1] row_mask:0xf bank_mask:0xf
    v_add_f32_dpp v32, v32, v32 quad_perm:[2,3,0,1] row_mask:0xf bank_mask:0xf
    v_mov_b32 v27, s47
    v_add_f32_dpp v24, v24, v24 quad_perm:[1,0,3,2] row_mask:0xf bank_mask:0xf
    v_add_f32_dpp v26, v32, v32 quad_perm:[1,0,3,2] row_mask:0xf bank_mask:0xf
    s_mov_b64 exec, s[24:25]
    buffer_store_dwordx4 v[24:27], v2, s[4:7], s21 offen sc1
    buffer_store_dwordx4 v[24:27], v2, s[4:7], s28 offen sc1
    s_mov_b64 exec, -1
    v_mov_b64 v[4:5], v[124:125]
    v_mov_b64 v[6:7], v[126:127]
    v_lshlrev_b32 v64, 16, v120
    v_and_b32 v65, 0xffff0000, v120
    v_lshlrev_b32 v66, 16, v121
    v_and_b32 v67, 0xffff0000, v121
    v_lshlrev_b32 v68, 16, v122
    v_and_b32 v69, 0xffff0000, v122
    v_lshlrev_b32 v70, 16, v123
    v_and_b32 v71, 0xffff0000, v123
    v_mov_b64 v[72:73], 0
    v_mov_b64 v[74:75], 0
    v_mov_b64 v[76:77], 0
    v_mov_b64 v[78:79], 0
    v_lshlrev_b32 v96, 16, v120
    v_and_b32 v97, 0xffff0000, v120
    v_lshlrev_b32 v98, 16, v121
    v_and_b32 v99, 0xffff0000, v121
    v_lshlrev_b32 v100, 16, v122
    v_and_b32 v101, 0xffff0000, v122
    v_lshlrev_b32 v102, 16, v123
    v_and_b32 v103, 0xffff0000, v123
    v_mov_b64 v[104:105], 0
    v_mov_b64 v[106:107], 0
    v_mov_b64 v[108:109], 0
    v_mov_b64 v[110:111], 0
    s_branch .Lpage24
.p2alignl 12, 0xbf810000
.Lpage24:
    s_waitcnt vmcnt(0)
.Lgat15:
    buffer_load_dwordx4 v[40:43], v3, s[4:7], s20 offen sc1
    buffer_load_dwordx4 v[44:47], v3, s[4:7], s20 offen offset:1024 sc1
    s_addk_i32 s59, 0x2000
    s_cbranch_scc1 .Lend
.Lgat15_chk:
    s_waitcnt vmcnt(0)
    v_add_f32 v40, v40, v44
    v_add_f32 v42, v42, v46
    v_bitop3_b32 v41, v41, v43, s47 bitop3:0x7e
    v_bitop3_b32 v43, v45, v47, s47 bitop3:0x7e
    v_add_f32_dpp v44, v40, v40 row_ror:8 row_mask:0xf bank_mask:0xf
    v_add_f32_dpp v46, v40, v40 row_ror:8 row_mask:0xf bank_mask:0xf
    v_add_f32_dpp v45, v42, v42 row_ror:8 row_mask:0xf bank_mask:0xf
    v_add_f32_dpp v47, v42, v42 row_ror:8 row_mask:0xf bank_mask:0xf
    v_permlane16_swap_b32 v44, v46
    v_or_b32 v41, v41, v43
    v_permlane16_swap_b32 v45, v47
    v_cmp_ne_u32 vcc, 0, v41
    v_pk_add_f32 v[40:41], v[44:45], v[46:47]
    v_pk_mul_f32 v[40:41], v[40:41], s[26:27]
    v_fma_f32 v41, -v40, v40, v41
    v_max_f32 v41, 0, v41
    v_mul_f32 v41, 0x3f800054, v41
    v_add_f32 v42, 0x2edbe6ff, v41
    v_rsq_f32 v42, v42
    s_cbranch_vccnz .Lgat15
    v_mul_f32 v40, v40, v42
    v_mov_b32_dpp v24, v42 row_newbcast:0 row_mask:0xf bank_mask:0xf
    v_mov_b32_dpp v25, v42 row_newbcast:1 row_mask:0xf bank_mask:0xf
    v_mov_b32_dpp v26, v42 row_newbcast:2 row_mask:0xf bank_mask:0xf
    v_mov_b32_dpp v27, v42 row_newbcast:3 row_mask:0xf bank_mask:0xf
    v_mov_b32_dpp v28, v42 row_newbcast:4 row_mask:0xf bank_mask:0xf
    v_mov_b32_dpp v29, v42 row_newbcast:5 row_mask:0xf bank_mask:0xf
    v_mov_b32_dpp v30, v42 row_newbcast:6 row_mask:0xf bank_mask:0xf
    v_mov_b32_dpp v31, v42 row_newbcast:7 row_mask:0xf bank_mask:0xf
    v_mov_b32_dpp v32, v40 row_newbcast:0 row_mask:0xf bank_mask:0xf
    v_mov_b32_dpp v33, v40 row_newbcast:1 row_mask:0xf bank_mask:0xf
    v_mov_b32_dpp v34, v40 row_newbcast:2 row_mask:0xf bank_mask:0xf
    v_mov_b32_dpp v35, v40 row_newbcast:3 row_mask:0xf bank_mask:0xf
    v_mov_b32_dpp v36, v40 row_newbcast:4 row_mask:0xf bank_mask:0xf
    v_mov_b32_dpp v37, v40 row_newbcast:5 row_mask:0xf bank_mask:0xf
    v_mov_b32_dpp v38, v40 row_newbcast:6 row_mask:0xf bank_mask:0xf
    v_mov_b32_dpp v39, v40 row_newbcast:7 row_mask:0xf bank_mask:0xf
    v_pk_fma_f32 v[40:41], v[8:9], v[24:25], v[32:33]
    v_pk_fma_f32 v[42:43], v[10:11], v[26:27], v[34:35]
    v_pk_fma_f32 v[44:45], v[12:13], v[28:29], v[36:37]
    v_pk_fma_f32 v[46:47], v[14:15], v[30:31], v[38:39]
    v_cvt_pk_bf16_f32 v56, v40, v41
    v_cvt_pk_bf16_f32 v57, v42, v43
    v_cvt_pk_bf16_f32 v58, v44, v45
    v_cvt_pk_bf16_f32 v59, v46, v47
    buffer_store_dwordx4 v[56:59], v1, s[4:7], s22 offen offset:0 sc1
    v_pk_fma_f32 v[48:49], v[16:17], v[24:25], v[32:33]
    v_pk_fma_f32 v[50:51], v[18:19], v[26:27], v[34:35]
    v_pk_fma_f32 v[52:53], v[20:21], v[28:29], v[36:37]
    v_pk_fma_f32 v[54:55], v[22:23], v[30:31], v[38:39]
    v_cvt_pk_bf16_f32 v60, v48, v49
    v_cvt_pk_bf16_f32 v61, v50, v51
    v_cvt_pk_bf16_f32 v62, v52, v53
    v_cvt_pk_bf16_f32 v63, v54, v55
    buffer_store_dwordx4 v[60:63], v1, s[4:7], s22 offen offset:512 sc1
    v_cvt_pk_bf16_f32 v8, v8, v9
    v_cvt_pk_bf16_f32 v9, v10, v11
    v_cvt_pk_bf16_f32 v10, v12, v13
    v_cvt_pk_bf16_f32 v11, v14, v15
    v_cvt_pk_bf16_f32 v12, v16, v17
    v_cvt_pk_bf16_f32 v13, v18, v19
    v_cvt_pk_bf16_f32 v14, v20, v21
    v_cvt_pk_bf16_f32 v15, v22, v23
    v_mbcnt_lo_u32_b32 v62, -1, 0
    v_mbcnt_hi_u32_b32 v62, -1, v62
    v_bfe_u32 v63, v62, 2, 2
    v_lshrrev_b32 v2, 5, v62
    v_lshl_add_u32 v2, v2, 3, v63
    v_lshlrev_b32 v2, 7, v2
    v_and_b32 v63, 2, v63
    v_bfe_u32 v3, v62, 4, 1
    v_xor_b32 v63, v63, v3
    v_xor_b32 v63, s44, v63
    v_lshl_add_u32 v2, v63, 5, v2
    v_and_b32 v63, 1, v62
    v_lshl_add_u32 v2, v63, 4, v2
    v_bfe_u32 v63, v62, 1, 1
    v_lshl_add_u32 v2, v63, 3, v2
    v_add_u32 v2, s55, v2
    v_xor_b32 v3, 64, v2
    v_mbcnt_lo_u32_b32 v60, -1, 0
    v_mbcnt_hi_u32_b32 v60, -1, v60
    v_lshrrev_b32 v61, 5, v60
    v_lshlrev_b32 v1, 10, v61
    v_and_b32 v61, 31, v60
    v_lshl_add_u32 v1, v61, 4, v1
    s_lshl_b32 s42, s44, 11
    v_lshl_add_u32 v60, v60, 4, s42
    s_mov_b32 s34, 0xbdd2d3e8
    s_mov_b32 s35, 0xc0135761
    s_mul_i32 s21, s44, 131072
    s_add_u32 s21, s21, s31
    s_add_u32 s21, s21, 5242880
    s_add_u32 s22, s21, 131072
    s_and_b32 s20, s45, 3
    s_lshl_b32 s20, s20, 1
    s_lshr_b32 s42, s45, 2
    s_add_u32 s20, s20, s42
    s_mul_i32 s20, s20, 16384
    s_add_u32 s20, s20, s21
    s_lshl_b32 s23, s48, 3
    s_add_u32 s23, s23, s44
    s_lshl_b32 s23, s23, 11
    s_add_u32 s23, s23, s31
    s_add_u32 s23, s23, 5767168
    v_mbcnt_lo_u32_b32 v16, -1, 0
    v_mbcnt_hi_u32_b32 v16, -1, v16
    v_lshlrev_b32 v16, 10, v16
    v_mov_b32 v17, s47
    s_mov_b32 s40, s20
    s_branch .Lpage25
.p2alignl 12, 0xbf810000
.Lpage25:
    s_waitcnt vmcnt(0)
    s_barrier
    s_cmp_eq_u32 s49, 7
    s_cbranch_scc1 .Lpre
    buffer_load_dwordx4 v[24:27], v1, s[4:7], s20 offen offset:0 sc1
    buffer_load_dwordx4 v[28:31], v1, s[4:7], s20 offen offset:2048 sc1
    s_addk_i32 s20, 4096
    buffer_load_dwordx4 v[32:35], v1, s[4:7], s20 offen offset:0 sc1
    buffer_load_dwordx4 v[36:39], v1, s[4:7], s20 offen offset:2048 sc1
    s_addk_i32 s20, 12288
    s_cmp_eq_u32 s20, s22
    s_cselect_b32 s20, s21, s20
    buffer_load_dwordx4 v[40:43], v1, s[4:7], s20 offen offset:0 sc1
    buffer_load_dwordx4 v[44:47], v1, s[4:7], s20 offen offset:2048 sc1
    s_addk_i32 s20, 4096
    buffer_load_dwordx4 v[48:51], v1, s[4:7], s20 offen offset:0 sc1
    buffer_load_dwordx4 v[52:55], v1, s[4:7], s20 offen offset:2048 sc1
    s_addk_i32 s20, 12288
    s_cmp_eq_u32 s20, s22
    s_cselect_b32 s20, s21, s20
.Lpre:
    s_mov_b64 exec, 0xff
    buffer_store_dword v17, v16, s[4:7], s56 offen sc1
    s_mov_b64 exec, -1
    s_add_u32 s56, s56, 16
    s_cmp_eq_u32 s49, 7
    s_cbranch_scc1 .Lidle1
    s_branch .Lspec1
.Lrespec1:
    s_mov_b32 s20, s40
    s_addk_i32 s59, 0x2000
    s_cbranch_scc1 .Lend
    buffer_load_dwordx4 v[24:27], v1, s[4:7], s20 offen offset:0 sc1
    buffer_load_dwordx4 v[28:31], v1, s[4:7], s20 offen offset:2048 sc1
    s_addk_i32 s20, 4096
    buffer_load_dwordx4 v[32:35], v1, s[4:7], s20 offen offset:0 sc1
    buffer_load_dwordx4 v[36:39], v1, s[4:7], s20 offen offset:2048 sc1
    s_addk_i32 s20, 12288
    s_cmp_eq_u32 s20, s22
    s_cselect_b32 s20, s21, s20
    buffer_load_dwordx4 v[40:43], v1, s[4:7], s20 offen offset:0 sc1
    buffer_load_dwordx4 v[44:47], v1, s[4:7], s20 offen offset:2048 sc1
    s_addk_i32 s20, 4096
    buffer_load_dwordx4 v[48:51], v1, s[4:7], s20 offen offset:0 sc1
    buffer_load_dwordx4 v[52:55], v1, s[4:7], s20 offen offset:2048 sc1
    s_addk_i32 s20, 12288
    s_cmp_eq_u32 s20, s22
    s_cselect_b32 s20, s21, s20
    buffer_load_dword v63, v1, s[4:7], s40 offen sc1
    s_waitcnt lgkmcnt(0)
    v_lshlrev_b32 v64, 16, v120
    v_and_b32 v65, 0xffff0000, v120
    v_lshlrev_b32 v66, 16, v121
    v_and_b32 v67, 0xffff0000, v121
    v_lshlrev_b32 v68, 16, v122
    v_and_b32 v69, 0xffff0000, v122
    v_lshlrev_b32 v70, 16, v123
    v_and_b32 v71, 0xffff0000, v123
    v_mov_b64 v[72:73], 0
    v_mov_b64 v[74:75], 0
    v_mov_b64 v[76:77], 0
    v_mov_b64 v[78:79], 0
.Lspec1:
    v_mov_b32 v61, 0
    buffer_load_dwordx4 v[56:59], v1, s[4:7], s20 offen offset:0 sc1
    s_waitcnt vmcnt(9)
    v_mfma_f32_32x32x16_bf16 v[80:95], a[4:7], v[24:27], 0
    v_max3_u32 v61, v61, v24, v25
    v_max3_u32 v61, v61, v26, v27
    v_cmp_eq_u32 vcc, -1, v61
    s_cbranch_vccnz .Lrespec1
    v_mfma_f32_32x32x16_bf16 v[64:79], a[0:3], v[24:27], v[64:79]
    buffer_load_dwordx4 v[24:27], v1, s[4:7], s20 offen offset:2048 sc1
    s_waitcnt vmcnt(9)
    v_mfma_f32_32x32x16_bf16 v[80:95], a[12:15], v[28:31], v[80:95]
    v_max3_u32 v61, v61, v28, v29
    v_max3_u32 v61, v61, v30, v31
    s_addk_i32 s20, 4096
    v_mfma_f32_32x32x16_bf16 v[64:79], a[8:11], v[28:31], v[64:79]
    buffer_load_dwordx4 v[28:31], v1, s[4:7], s20 offen offset:0 sc1
    s_waitcnt vmcnt(9)
    v_mfma_f32_32x32x16_bf16 v[80:95], a[20:23], v[32:35], v[80:95]
    v_max3_u32 v61, v61, v32, v33
    v_max3_u32 v61, v61, v34, v35
    v_mfma_f32_32x32x16_bf16 v[64:79], a[16:19], v[32:35], v[64:79]
    buffer_load_dwordx4 v[32:35], v1, s[4:7], s20 offen offset:2048 sc1
    s_waitcnt vmcnt(9)
    v_mfma_f32_32x32x16_bf16 v[80:95], a[28:31], v[36:39], v[80:95]
    v_max3_u32 v61, v61, v36, v37
    v_max3_u32 v61, v61, v38, v39
    s_addk_i32 s20, 12288
    s_cmp_eq_u32 s20, s22
    s_cselect_b32 s20, s21, s20
    v_mfma_f32_32x32x16_bf16 v[64:79], a[24:27], v[36:39], v[64:79]
    buffer_load_dwordx4 v[36:39], v1, s[4:7], s20 offen offset:0 sc1
    s_waitcnt vmcnt(9)
    v_mfma_f32_32x32x16_bf16 v[80:95], a[36:39], v[40:43], v[80:95]
    v_max3_u32 v61, v61, v40, v41
    v_max3_u32 v61, v61, v42, v43
    v_cmp_eq_u32 vcc, -1, v61
    s_cbranch_vccnz .Lrespec1
    v_mfma_f32_32x32x16_bf16 v[64:79], a[32:35], v[40:43], v[64:79]
    buffer_load_dwordx4 v[40:43], v1, s[4:7], s20 offen offset:2048 sc1
    s_waitcnt vmcnt(9)
    v_mfma_f32_32x32x16_bf16 v[80:95], a[44:47], v[44:47], v[80:95]
    v_max3_u32 v61, v61, v44, v45
    v_max3_u32 v61, v61, v46, v47
    s_addk_i32 s20, 4096
    v_mfma_f32_32x32x16_bf16 v[64:79], a[40:43], v[44:47], v[64:79]
    buffer_load_dwordx4 v[44:47], v1, s[4:7], s20 offen offset:0 sc1
    s_load_dwordx4 s[60:63], s[4:5], s57 glc
    s_load_dwordx4 s[64:67], s[4:5], s57 offset:128 glc
    s_waitcnt vmcnt(9)
    v_mfma_f32_32x32x16_bf16 v[80:95], a[52:55], v[48:51], v[80:95]
    v_max3_u32 v61, v61, v48, v49
    v_max3_u32 v61, v61, v50, v51
    v_mfma_f32_32x32x16_bf16 v[64:79], a[48:51], v[48:51], v[64:79]
    buffer_load_dwordx4 v[48:51], v1, s[4:7], s20 offen offset:2048 sc1
    s_waitcnt vmcnt(9)
    v_mfma_f32_32x32x16_bf16 v[80:95], a[60:63], v[52:55], v[80:95]
    v_max3_u32 v61, v61, v52, v53
    v_max3_u32 v61, v61, v54, v55
    s_addk_i32 s20, 12288
    s_cmp_eq_u32 s20, s22
    s_cselect_b32 s20, s21, s20
    v_mfma_f32_32x32x16_bf16 v[64:79], a[56:59], v[52:55], v[64:79]
    buffer_load_dwordx4 v[52:55], v1, s[4:7], s20 offen offset:0 sc1
    s_waitcnt vmcnt(8)
    v_mfma_f32_32x32x16_bf16 v[80:95], a[68:71], v[56:59], v[80:95]
    v_max3_u32 v61, v61, v56, v57
    v_max3_u32 v61, v61, v58, v59
    v_cmp_eq_u32 vcc, -1, v61
    s_cbranch_vccnz .Lrespec1
    v_mfma_f32_32x32x16_bf16 v[64:79], a[64:67], v[56:59], v[64:79]
    buffer_load_dwordx4 v[56:59], v1, s[4:7], s20 offen offset:2048 sc1
    s_waitcnt vmcnt(8)
    v_mfma_f32_32x32x16_bf16 v[80:95], a[76:79], v[24:27], v[80:95]
    v_max3_u32 v61, v61, v24, v25
    v_max3_u32 v61, v61, v26, v27
    s_addk_i32 s20, 4096
    v_mfma_f32_32x32x16_bf16 v[64:79], a[72:75], v[24:27], v[64:79]
    buffer_load_dwordx4 v[24:27], v1, s[4:7], s20 offen offset:0 sc1
    s_waitcnt vmcnt(8)
    v_mfma_f32_32x32x16_bf16 v[80:95], a[84:87], v[28:31], v[80:95]
    v_max3_u32 v61, v61, v28, v29
    v_max3_u32 v61, v61, v30, v31
    v_mfma_f32_32x32x16_bf16 v[64:79], a[80:83], v[28:31], v[64:79]
    buffer_load_dwordx4 v[28:31], v1, s[4:7], s20 offen offset:2048 sc1
    s_waitcnt vmcnt(8)
    v_mfma_f32_32x32x16_bf16 v[80:95], a[92:95], v[32:35], v[80:95]
    v_max3_u32 v61, v61, v32, v33
    v_max3_u32 v61, v61, v34, v35
    s_addk_i32 s20, 12288
    s_cmp_eq_u32 s20, s22
    s_cselect_b32 s20, s21, s20
    v_mfma_f32_32x32x16_bf16 v[64:79], a[88:91], v[32:35], v[64:79]
    buffer_load_dwordx4 v[32:35], v1, s[4:7], s20 offen offset:0 sc1
    s_waitcnt vmcnt(8)
    v_mfma_f32_32x32x16_bf16 v[80:95], a[100:103], v[36:39], v[80:95]
    v_max3_u32 v61, v61, v36, v37
    v_max3_u32 v61, v61, v38, v39
    v_cmp_eq_u32 vcc, -1, v61
    s_cbranch_vccnz .Lrespec1
    v_mfma_f32_32x32x16_bf16 v[64:79], a[96:99], v[36:39], v[64:79]
    buffer_load_dwordx4 v[36:39], v1, s[4:7], s20 offen offset:2048 sc1
    s_waitcnt vmcnt(8)
    v_mfma_f32_32x32x16_bf16 v[80:95], a[108:111], v[40:43], v[80:95]
    v_max3_u32 v61, v61, v40, v41
    v_max3_u32 v61, v61, v42, v43
    s_addk_i32 s20, 4096
    v_mfma_f32_32x32x16_bf16 v[64:79], a[104:107], v[40:43], v[64:79]
    buffer_load_dwordx4 v[40:43], v1, s[4:7], s20 offen offset:0 sc1
    s_waitcnt vmcnt(8)
    v_mfma_f32_32x32x16_bf16 v[80:95], a[116:119], v[44:47], v[80:95]
    v_max3_u32 v61, v61, v44, v45
    v_max3_u32 v61, v61, v46, v47
    s_waitcnt lgkmcnt(0)
    s_xor_b64 s[60:61], s[60:61], s[32:33]
    s_xor_b64 s[62:63], s[62:63], s[32:33]
    s_xor_b64 s[64:65], s[64:65], s[32:33]
    s_xor_b64 s[66:67], s[66:67], s[32:33]
    v_mfma_f32_32x32x16_bf16 v[64:79], a[112:115], v[44:47], v[64:79]
    s_or_b64 s[60:61], s[60:61], s[62:63]
    s_or_b64 s[64:65], s[64:65], s[66:67]
    s_or_b64 s[60:61], s[60:61], s[64:65]
    s_cbranch_scc0 .Lgate16
.Lpoll17:
    s_load_dwordx4 s[60:63], s[4:5], s57 glc
    s_load_dwordx4 s[64:67], s[4:5], s57 offset:128 glc
    s_addk_i32 s59, 0x2000
    s_cbranch_scc1 .Lend
.Lpoll17_chk:
    s_waitcnt lgkmcnt(0)
    s_xor_b64 s[60:61], s[60:61], s[32:33]
    s_xor_b64 s[62:63], s[62:63], s[32:33]
    s_xor_b64 s[64:65], s[64:65], s[32:33]
    s_xor_b64 s[66:67], s[66:67], s[32:33]
    s_or_b64 s[60:61], s[60:61], s[62:63]
    s_or_b64 s[64:65], s[64:65], s[66:67]
    s_or_b64 s[60:61], s[60:61], s[64:65]
    s_cbranch_scc1 .Lpoll17
.Lgate16:
    s_waitcnt vmcnt(7)
    v_mfma_f32_32x32x16_bf16 v[80:95], a[124:127], v[48:51], v[80:95]
    v_max3_u32 v61, v61, v48, v49
    v_max3_u32 v61, v61, v50, v51
    buffer_load_dwordx4 v[44:47], v1, s[4:7], s20 offen offset:2048 sc1
    v_mfma_f32_32x32x16_bf16 v[64:79], a[120:123], v[48:51], v[64:79]
    s_addk_i32 s20, 12288
    s_cmp_eq_u32 s20, s22
    s_cselect_b32 s20, s21, s20
    buffer_load_dwordx4 v[48:51], v1, s[4:7], s20 offen offset:0 sc1
    s_waitcnt vmcnt(8)
    v_mfma_f32_32x32x16_bf16 v[80:95], a[132:135], v[52:55], v[80:95]
    v_max3_u32 v61, v61, v52, v53
    v_max3_u32 v61, v61, v54, v55
    v_mfma_f32_32x32x16_bf16 v[64:79], a[128:131], v[52:55], v[64:79]
    buffer_load_dwordx4 v[52:55], v1, s[4:7], s20 offen offset:2048 sc1
    s_waitcnt vmcnt(8)
    v_mfma_f32_32x32x16_bf16 v[80:95], a[140:143], v[56:59], v[80:95]
    v_max3_u32 v61, v61, v56, v57
    v_max3_u32 v61, v61, v58, v59
    s_addk_i32 s20, 4096
    v_mfma_f32_32x32x16_bf16 v[64:79], a[136:139], v[56:59], v[64:79]
    buffer_load_dwordx4 v[56:59], v1, s[4:7], s20 offen offset:0 sc1
    s_waitcnt vmcnt(8)
    v_mfma_f32_32x32x16_bf16 v[80:95], a[148:151], v[24:27], v[80:95]
    v_max3_u32 v61, v61, v24, v25
    v_max3_u32 v61, v61, v26, v27
    v_mfma_f32_32x32x16_bf16 v[64:79], a[144:147], v[24:27], v[64:79]
    buffer_load_dwordx4 v[24:27], v1, s[4:7], s20 offen offset:2048 sc1
    s_waitcnt vmcnt(8)
    v_mfma_f32_32x32x16_bf16 v[80:95], a[156:159], v[28:31], v[80:95]
    v_max3_u32 v61, v61, v28, v29
    v_max3_u32 v61, v61, v30, v31
    s_addk_i32 s20, 12288
    s_cmp_eq_u32 s20, s22
    s_cselect_b32 s20, s21, s20
    v_mfma_f32_32x32x16_bf16 v[64:79], a[152:155], v[28:31], v[64:79]
    buffer_load_dwordx4 v[28:31], v1, s[4:7], s20 offen offset:0 sc1
    s_waitcnt vmcnt(8)
    v_mfma_f32_32x32x16_bf16 v[80:95], a[164:167], v[32:35], v[80:95]
    v_max3_u32 v61, v61, v32, v33
    v_max3_u32 v61, v61, v34, v35
    v_mfma_f32_32x32x16_bf16 v[64:79], a[160:163], v[32:35], v[64:79]
    buffer_load_dwordx4 v[32:35], v1, s[4:7], s20 offen offset:2048 sc1
    s_waitcnt vmcnt(8)
    v_mfma_f32_32x32x16_bf16 v[80:95], a[172:175], v[36:39], v[80:95]
    v_max3_u32 v61, v61, v36, v37
    v_max3_u32 v61, v61, v38, v39
    s_addk_i32 s20, 4096
    v_mfma_f32_32x32x16_bf16 v[64:79], a[168:171], v[36:39], v[64:79]
    buffer_load_dwordx4 v[36:39], v1, s[4:7], s20 offen offset:0 sc1
    s_waitcnt vmcnt(8)
    v_mfma_f32_32x32x16_bf16 v[80:95], a[180:183], v[40:43], v[80:95]
    v_max3_u32 v61, v61, v40, v41
    v_max3_u32 v61, v61, v42, v43
    v_cmp_eq_u32 vcc, -1, v61
    s_cbranch_vccnz .Lrespec1
    s_add_u32 s57, s57, 16
    v_mfma_f32_32x32x16_bf16 v[64:79], a[176:179], v[40:43], v[64:79]
    buffer_load_dwordx4 v[40:43], v1, s[4:7], s20 offen offset:2048 sc1
    s_waitcnt vmcnt(8)
    v_mfma_f32_32x32x16_bf16 v[80:95], a[188:191], v[44:47], v[80:95]
    s_addk_i32 s20, 12288
    s_cmp_eq_u32 s20, s22
    s_cselect_b32 s20, s21, s20
    v_mfma_f32_32x32x16_bf16 v[64:79], a[184:187], v[44:47], v[64:79]
    buffer_load_dwordx4 v[44:47], v1, s[4:7], s20 offen offset:512 sc1
    s_waitcnt vmcnt(8)
    v_mfma_f32_32x32x16_bf16 v[80:95], a[196:199], v[48:51], v[80:95]
    v_mfma_f32_32x32x16_bf16 v[64:79], a[192:195], v[48:51], v[64:79]
    buffer_load_dwordx4 v[48:51], v1, s[4:7], s20 offen offset:2560 sc1
    s_waitcnt vmcnt(8)
    v_mfma_f32_32x32x16_bf16 v[80:95], a[204:207], v[52:55], v[80:95]
    s_addk_i32 s20, 4096
    v_mfma_f32_32x32x16_bf16 v[64:79], a[200:203], v[52:55], v[64:79]
    buffer_load_dwordx4 v[52:55], v1, s[4:7], s20 offen offset:512 sc1
    s_waitcnt vmcnt(8)
    v_mfma_f32_32x32x16_bf16 v[80:95], a[212:215], v[56:59], v[80:95]
    v_mfma_f32_32x32x16_bf16 v[64:79], a[208:211], v[56:59], v[64:79]
    buffer_load_dwordx4 v[56:59], v1, s[4:7], s20 offen offset:2560 sc1
    s_waitcnt vmcnt(8)
    v_mfma_f32_32x32x16_bf16 v[80:95], a[220:223], v[24:27], v[80:95]
    s_addk_i32 s20, 12288
    s_cmp_eq_u32 s20, s22
    s_cselect_b32 s20, s21, s20
    v_mfma_f32_32x32x16_bf16 v[64:79], a[216:219], v[24:27], v[64:79]
    buffer_load_dwordx4 v[24:27], v1, s[4:7], s20 offen offset:512 sc1
    s_waitcnt vmcnt(8)
    v_mfma_f32_32x32x16_bf16 v[80:95], a[228:231], v[28:31], v[80:95]
    v_mfma_f32_32x32x16_bf16 v[64:79], a[224:227], v[28:31], v[64:79]
    buffer_load_dwordx4 v[28:31], v1, s[4:7], s20 offen offset:2560 sc1
    s_waitcnt vmcnt(8)
    v_mfma_f32_32x32x16_bf16 v[80:95], a[236:239], v[32:35], v[80:95]
    s_addk_i32 s20, 4096
    v_mfma_f32_32x32x16_bf16 v[64:79], a[232:235], v[32:35], v[64:79]
    buffer_load_dwordx4 v[32:35], v1, s[4:7], s20 offen offset:512 sc1
    s_waitcnt vmcnt(8)
    v_mfma_f32_32x32x16_bf16 v[80:95], a[244:247], v[36:39], v[80:95]
    v_mfma_f32_32x32x16_bf16 v[64:79], a[240:243], v[36:39], v[64:79]
    buffer_load_dwordx4 v[36:39], v1, s[4:7], s20 offen offset:2560 sc1
    s_waitcnt vmcnt(8)
    v_mfma_f32_32x32x16_bf16 v[80:95], a[252:255], v[40:43], v[80:95]
    s_addk_i32 s20, 12288
    s_cmp_eq_u32 s20, s22
    s_cselect_b32 s20, s21, s20
    v_mfma_f32_32x32x16_bf16 v[64:79], a[248:251], v[40:43], v[64:79]
    buffer_load_dwordx4 v[40:43], v1, s[4:7], s20 offen offset:512 sc1
    s_waitcnt vmcnt(8)
    v_mfma_f32_32x32x16_bf16 v[112:127], a[4:7], v[44:47], 0
    v_mfma_f32_32x32x16_bf16 v[96:111], a[0:3], v[44:47], v[96:111]
    buffer_load_dwordx4 v[44:47], v1, s[4:7], s20 offen offset:2560 sc1
    s_waitcnt vmcnt(8)
    v_mfma_f32_32x32x16_bf16 v[112:127], a[12:15], v[48:51], v[112:127]
    s_addk_i32 s20, 4096
    v_mfma_f32_32x32x16_bf16 v[96:111], a[8:11], v[48:51], v[96:111]
    buffer_load_dwordx4 v[48:51], v1, s[4:7], s20 offen offset:512 sc1
    v_xor_b32 v61, 6144, v60
    s_waitcnt vmcnt(8)
    v_mfma_f32_32x32x16_bf16 v[112:127], a[20:23], v[52:55], v[112:127]
    ds_write_b128 v61, v[88:91] offset:24704
    v_mfma_f32_32x32x16_bf16 v[96:111], a[16:19], v[52:55], v[96:111]
    buffer_load_dwordx4 v[52:55], v1, s[4:7], s20 offen offset:2560 sc1
    ds_write_b128 v61, v[92:95] offset:25728
    s_waitcnt vmcnt(8)
    v_mfma_f32_32x32x16_bf16 v[112:127], a[28:31], v[56:59], v[112:127]
    s_addk_i32 s20, 12288
    s_cmp_eq_u32 s20, s22
    s_cselect_b32 s20, s21, s20
    v_xor_b32 v61, 4096, v60
    v_mfma_f32_32x32x16_bf16 v[96:111], a[24:27], v[56:59], v[96:111]
    buffer_load_dwordx4 v[56:59], v1, s[4:7], s20 offen offset:512 sc1
    ds_write_b128 v61, v[80:83] offset:16512
    s_waitcnt vmcnt(8)
    v_mfma_f32_32x32x16_bf16 v[112:127], a[36:39], v[24:27], v[112:127]
    ds_write_b128 v61, v[84:87] offset:17536
    v_mfma_f32_32x32x16_bf16 v[96:111], a[32:35], v[24:27], v[96:111]
    buffer_load_dwordx4 v[24:27], v1, s[4:7], s20 offen offset:2560 sc1
    v_xor_b32 v61, 2048, v60
    ds_write_b128 v61, v[72:75] offset:8320
    s_waitcnt vmcnt(8)
    v_mfma_f32_32x32x16_bf16 v[112:127], a[44:47], v[28:31], v[112:127]
    s_addk_i32 s20, 4096
    v_mfma_f32_32x32x16_bf16 v[96:111], a[40:43], v[28:31], v[96:111]
    buffer_load_dwordx4 v[28:31], v1, s[4:7], s20 offen offset:512 sc1
    ds_write_b128 v61, v[76:79] offset:9344
    s_waitcnt vmcnt(8)
    v_mfma_f32_32x32x16_bf16 v[112:127], a[52:55], v[32:35], v[112:127]
    v_mfma_f32_32x32x16_bf16 v[96:111], a[48:51], v[32:35], v[96:111]
    buffer_load_dwordx4 v[32:35], v1, s[4:7], s20 offen offset:2560 sc1
    s_waitcnt lgkmcnt(0)
    s_barrier
    ds_read_b128 v[72:75], v60 offset:8320
    ds_read_b128 v[76:79], v60 offset:9344
    s_waitcnt vmcnt(8)
    v_mfma_f32_32x32x16_bf16 v[112:127], a[60:63], v[36:39], v[112:127]
    s_addk_i32 s20, 12288
    s_cmp_eq_u32 s20, s22
    s_cselect_b32 s20, s21, s20
    ds_read_b128 v[80:83], v60 offset:16512
    ds_read_b128 v[84:87], v60 offset:17536
    ds_read_b128 v[88:91], v60 offset:24704
    v_mfma_f32_32x32x16_bf16 v[96:111], a[56:59], v[36:39], v[96:111]
    buffer_load_dwordx4 v[36:39], v1, s[4:7], s20 offen offset:512 sc1
    ds_read_b128 v[92:95], v60 offset:25728
    s_waitcnt vmcnt(8)
    v_mfma_f32_32x32x16_bf16 v[112:127], a[68:71], v[40:43], v[112:127]
    s_waitcnt lgkmcnt(4)
    v_add_f32 v64, v64, v72
    v_add_f32 v65, v65, v73
    v_add_f32 v66, v66, v74
    v_add_f32 v67, v67, v75
    v_add_f32 v68, v68, v76
    v_add_f32 v69, v69, v77
    v_mfma_f32_32x32x16_bf16 v[96:111], a[64:67], v[40:43], v[96:111]
    buffer_load_dwordx4 v[40:43], v1, s[4:7], s20 offen offset:2560 sc1
    v_add_f32 v70, v70, v78
    v_add_f32 v71, v71, v79
    s_waitcnt lgkmcnt(2)
    v_add_f32 v64, v64, v80
    v_add_f32 v65, v65, v81
    s_waitcnt vmcnt(8)
    v_mfma_f32_32x32x16_bf16 v[112:127], a[76:79], v[44:47], v[112:127]
    s_addk_i32 s20, 4096
    v_add_f32 v66, v66, v82
    v_add_f32 v67, v67, v83
    v_add_f32 v68, v68, v84
    v_add_f32 v69, v69, v85
    v_add_f32 v70, v70, v86
    v_add_f32 v71, v71, v87
    v_mfma_f32_32x32x16_bf16 v[96:111], a[72:75], v[44:47], v[96:111]
    buffer_load_dwordx4 v[44:47], v1, s[4:7], s20 offen offset:512 sc1
    s_waitcnt lgkmcnt(0)
    v_add_f32 v64, v64, v88
    v_add_f32 v65, v65, v89
    v_add_f32 v66, v66, v90
    v_add_f32 v67, v67, v91
    s_waitcnt vmcnt(8)
    v_mfma_f32_32x32x16_bf16 v[112:127], a[84:87], v[48:51], v[112:127]
    v_add_f32 v68, v68, v92
    v_add_f32 v69, v69, v93
    v_add_f32 v70, v70, v94
    v_add_f32 v71, v71, v95
    v_mov_b32 v80, s35
    v_mfma_f32_32x32x16_bf16 v[96:111], a[80:83], v[48:51], v[96:111]
    buffer_load_dwordx4 v[48:51], v1, s[4:7], s20 offen offset:2560 sc1
    v_mul_f32 v72, v64, v64
    v_mul_f32 v73, v65, v65
    v_mul_f32 v74, v66, v66
    v_mul_f32 v75, v67, v67
    s_waitcnt vmcnt(8)
    v_mfma_f32_32x32x16_bf16 v[112:127], a[92:95], v[52:55], v[112:127]
    s_addk_i32 s20, 12288
    s_cmp_eq_u32 s20, s22
    s_cselect_b32 s20, s21, s20
    v_mul_f32 v76, v68, v68
    v_mul_f32 v77, v69, v69
    v_mul_f32 v78, v70, v70
    v_mfma_f32_32x32x16_bf16 v[96:111], a[88:91], v[52:55], v[96:111]
    buffer_load_dwordx4 v[52:55], v1, s[4:7], s20 offen offset:512 sc1
    v_mul_f32 v79, v71, v71
    v_fma_f32 v72, v72, s34, v80
    v_fma_f32 v73, v73, s34, v80
    v_fma_f32 v74, v74, s34, v80
    s_waitcnt vmcnt(8)
    v_mfma_f32_32x32x16_bf16 v[112:127], a[100:103], v[56:59], v[112:127]
    v_fma_f32 v75, v75, s34, v80
    v_fma_f32 v76, v76, s34, v80
    v_fma_f32 v77, v77, s34, v80
    v_fma_f32 v78, v78, s34, v80
    v_fma_f32 v79, v79, s34, v80
    v_mul_f32 v72, v72, v64
    v_mul_f32 v73, v73, v65
    v_mfma_f32_32x32x16_bf16 v[96:111], a[96:99], v[56:59], v[96:111]
    buffer_load_dwordx4 v[56:59], v1, s[4:7], s20 offen offset:2560 sc1
    v_mul_f32 v74, v74, v66
    v_mul_f32 v75, v75, v67
    v_mul_f32 v76, v76, v68
    v_mul_f32 v77, v77, v69
    s_waitcnt vmcnt(8)
    v_mfma_f32_32x32x16_bf16 v[112:127], a[108:111], v[24:27], v[112:127]
    s_addk_i32 s20, 4096
    v_mul_f32 v78, v78, v70
    v_mul_f32 v79, v79, v71
    v_exp_f32 v72, v72
    v_mfma_f32_32x32x16_bf16 v[96:111], a[104:107], v[24:27], v[96:111]
    buffer_load_dwordx4 v[24:27], v1, s[4:7], s20 offen offset:512 sc1
    v_exp_f32 v73, v73
    v_exp_f32 v74, v74
    s_waitcnt vmcnt(8)
    v_mfma_f32_32x32x16_bf16 v[112:127], a[116:119], v[28:31], v[112:127]
    v_exp_f32 v75, v75
    v_exp_f32 v76, v76
    v_exp_f32 v77, v77
    v_mfma_f32_32x32x16_bf16 v[96:111], a[112:115], v[28:31], v[96:111]
    buffer_load_dwordx4 v[28:31], v1, s[4:7], s20 offen offset:2560 sc1
    v_exp_f32 v78, v78
    v_exp_f32 v79, v79
    s_waitcnt vmcnt(8)
    v_mfma_f32_32x32x16_bf16 v[112:127], a[124:127], v[32:35], v[112:127]
    s_addk_i32 s20, 12288
    s_cmp_eq_u32 s20, s22
    s_cselect_b32 s20, s21, s20
    v_add_f32 v72, 1.0, v72
    v_add_f32 v73, 1.0, v73
    v_add_f32 v74, 1.0, v74
    v_mfma_f32_32x32x16_bf16 v[96:111], a[120:123], v[32:35], v[96:111]
    buffer_load_dwordx4 v[32:35], v1, s[4:7], s20 offen offset:512 sc1
    v_add_f32 v75, 1.0, v75
    v_add_f32 v76, 1.0, v76
    v_add_f32 v77, 1.0, v77
    v_add_f32 v78, 1.0, v78
    s_waitcnt vmcnt(8)
    v_mfma_f32_32x32x16_bf16 v[112:127], a[132:135], v[36:39], v[112:127]
    v_add_f32 v79, 1.0, v79
    v_rcp_f32 v72, v72
    v_rcp_f32 v73, v73
    v_rcp_f32 v74, v74
    v_mfma_f32_32x32x16_bf16 v[96:111], a[128:131], v[36:39], v[96:111]
    buffer_load_dwordx4 v[36:39], v1, s[4:7], s20 offen offset:2560 sc1
    v_rcp_f32 v75, v75
    v_rcp_f32 v76, v76
    s_waitcnt vmcnt(8)
    v_mfma_f32_32x32x16_bf16 v[112:127], a[140:143], v[40:43], v[112:127]
    s_addk_i32 s20, 4096
    v_rcp_f32 v77, v77
    v_rcp_f32 v78, v78
    v_mfma_f32_32x32x16_bf16 v[96:111], a[136:139], v[40:43], v[96:111]
    buffer_load_dwordx4 v[40:43], v1, s[4:7], s20 offen offset:512 sc1
    v_rcp_f32 v79, v79
    v_mul_f32 v72, v72, v64
    v_mul_f32 v73, v73, v65
    s_waitcnt vmcnt(8)
    v_mfma_f32_32x32x16_bf16 v[112:127], a[148:151], v[44:47], v[112:127]
    v_mul_f32 v74, v74, v66
    v_mul_f32 v75, v75, v67
    v_mul_f32 v76, v76, v68
    v_mul_f32 v77, v77, v69
    v_mul_f32 v78, v78, v70
    v_mul_f32 v79, v79, v71
    v_mfma_f32_32x32x16_bf16 v[96:111], a[144:147], v[44:47], v[96:111]
    buffer_load_dwordx4 v[44:47], v1, s[4:7], s20 offen offset:2560 sc1
    v_cvt_pk_bf16_f32 v80, v72, v73
    v_cvt_pk_bf16_f32 v81, v74, v75
    v_cvt_pk_bf16_f32 v82, v76, v77
    v_cvt_pk_bf16_f32 v83, v78, v79
    s_waitcnt vmcnt(8)
    v_mfma_f32_32x32x16_bf16 v[112:127], a[156:159], v[48:51], v[112:127]
    s_addk_i32 s20, 12288
    s_cmp_eq_u32 s20, s22
    s_cselect_b32 s20, s21, s20
    buffer_store_dwordx4 v[80:83], v1, s[4:7], s23 offen offset:0 sc1
    v_lshlrev_b32 v64, 16, v4
    v_and_b32 v65, 0xffff0000, v4
    v_mfma_f32_32x32x16_bf16 v[96:111], a[152:155], v[48:51], v[96:111]
    buffer_load_dwordx4 v[48:51], v1, s[4:7], s20 offen offset:512 sc1
    v_lshlrev_b32 v66, 16, v5
    v_and_b32 v67, 0xffff0000, v5
    v_lshlrev_b32 v68, 16, v6
    v_and_b32 v69, 0xffff0000, v6
    s_waitcnt vmcnt(9)
    v_mfma_f32_32x32x16_bf16 v[112:127], a[164:167], v[52:55], v[112:127]
    v_lshlrev_b32 v70, 16, v7
    v_and_b32 v71, 0xffff0000, v7
    v_lshlrev_b32 v72, 16, v8
    v_and_b32 v73, 0xffff0000, v8
    v_lshlrev_b32 v74, 16, v9
    v_and_b32 v75, 0xffff0000, v9
    v_mfma_f32_32x32x16_bf16 v[96:111], a[160:163], v[52:55], v[96:111]
    buffer_load_dwordx4 v[52:55], v1, s[4:7], s20 offen offset:2560 sc1
    v_lshlrev_b32 v76, 16, v10
    v_and_b32 v77, 0xffff0000, v10
    v_lshlrev_b32 v78, 16, v11
    v_and_b32 v79, 0xffff0000, v11
    s_waitcnt vmcnt(9)
    v_mfma_f32_32x32x16_bf16 v[112:127], a[172:175], v[56:59], v[112:127]
    s_addk_i32 s20, 4096
    v_add_f32 v64, v64, v72
    v_add_f32 v65, v65, v73
    v_add_f32 v66, v66, v74
    v_add_f32 v67, v67, v75
    v_add_f32 v68, v68, v76
    v_add_f32 v69, v69, v77
    v_mfma_f32_32x32x16_bf16 v[96:111], a[168:171], v[56:59], v[96:111]
    buffer_load_dwordx4 v[56:59], v1, s[4:7], s20 offen offset:512 sc1
    v_add_f32 v70, v70, v78
    v_add_f32 v71, v71, v79
    v_mov_b32 v72, 0
    v_mov_b32 v73, 0
    s_waitcnt vmcnt(9)
    v_mfma_f32_32x32x16_bf16 v[112:127], a[180:183], v[24:27], v[112:127]
    v_mov_b32 v74, 0
    v_mov_b32 v75, 0
    v_mov_b32 v76, 0
    v_mov_b32 v77, 0
    v_mov_b32 v78, 0
    v_mov_b32 v79, 0
    v_mfma_f32_32x32x16_bf16 v[96:111], a[176:179], v[24:27], v[96:111]
    buffer_load_dwordx4 v[24:27], v1, s[4:7], s20 offen offset:2560 sc1
    v_mbcnt_lo_u32_b32 v88, -1, 0
    v_mbcnt_hi_u32_b32 v88, -1, v88
    v_lshlrev_b32 v88, 10, v88
    v_mov_b32 v89, s47
    s_waitcnt vmcnt(9)
    v_mfma_f32_32x32x16_bf16 v[112:127], a[188:191], v[28:31], v[112:127]
    s_addk_i32 s20, 12288
    s_cmp_eq_u32 s20, s22
    s_cselect_b32 s20, s21, s20
    v_mfma_f32_32x32x16_bf16 v[96:111], a[184:187], v[28:31], v[96:111]
    s_waitcnt vmcnt(8)
    v_mfma_f32_32x32x16_bf16 v[112:127], a[196:199], v[32:35], v[112:127]
    v_mfma_f32_32x32x16_bf16 v[96:111], a[192:195], v[32:35], v[96:111]
    s_waitcnt vmcnt(7)
    v_mfma_f32_32x32x16_bf16 v[112:127], a[204:207], v[36:39], v[112:127]
    v_mfma_f32_32x32x16_bf16 v[96:111], a[200:203], v[36:39], v[96:111]
    s_waitcnt vmcnt(6)
    v_mfma_f32_32x32x16_bf16 v[112:127], a[212:215], v[40:43], v[112:127]
    v_mfma_f32_32x32x16_bf16 v[96:111], a[208:211], v[40:43], v[96:111]
    s_waitcnt vmcnt(5)
    v_mfma_f32_32x32x16_bf16 v[112:127], a[220:223], v[44:47], v[112:127]
    v_mfma_f32_32x32x16_bf16 v[96:111], a[216:219], v[44:47], v[96:111]
    s_waitcnt vmcnt(3)
    v_mfma_f32_32x32x16_bf16 v[112:127], a[228:231], v[48:51], v[112:127]
    s_barrier
    s_mov_b64 exec, 0xff
    buffer_store_dword v89, v88, s[4:7], s56 offen sc1
    s_mov_b64 exec, -1
    s_add_u32 s56, s56, 16
    s_waitcnt vmcnt(3)
    v_mfma_f32_32x32x16_bf16 v[112:127], a[236:239], v[52:55], v[112:127]
    s_mul_i32 s21, s44, 114688
    s_add_u32 s21, s21, s31
    s_add_u32 s21, s21, 5767168
    s_add_u32 s22, s21, 114688
    s_lshl_b32 s20, s58, 12
    s_waitcnt vmcnt(2)
    v_mfma_f32_32x32x16_bf16 v[112:127], a[244:247], v[56:59], v[112:127]
    s_add_u32 s20, s20, s21
    s_add_u32 s20, s20, 16384
    s_cmp_eq_u32 s20, s22
    s_cselect_b32 s20, s21, s20
    s_load_dwordx4 s[60:63], s[4:5], s57 glc
    s_load_dwordx4 s[64:67], s[4:5], s57 offset:128 glc
    s_waitcnt vmcnt(1)
    v_mfma_f32_32x32x16_bf16 v[112:127], a[252:255], v[24:27], v[112:127]
    v_mfma_f32_32x32x16_bf16 v[96:111], a[224:227], v[48:51], v[96:111]
    v_xor_b32 v61, 6144, v60
    v_mfma_f32_32x32x16_bf16 v[96:111], a[232:235], v[52:55], v[96:111]
    s_nop 8
    ds_write_b128 v61, v[120:123] offset:49280
    v_mfma_f32_32x32x16_bf16 v[96:111], a[240:243], v[56:59], v[96:111]
    ds_write_b128 v61, v[124:127] offset:50304
    v_mfma_f32_32x32x16_bf16 v[96:111], a[248:251], v[24:27], v[96:111]
    v_xor_b32 v61, 4096, v60
    ds_write_b128 v61, v[112:115] offset:41088
    ds_write_b128 v61, v[116:119] offset:42112
    s_nop 7
    v_xor_b32 v61, 2048, v60
    ds_write_b128 v61, v[104:107] offset:32896
    ds_write_b128 v61, v[108:111] offset:33920
    s_waitcnt lgkmcnt(0)
    s_barrier
    ds_read_b128 v[104:107], v60 offset:32896
    ds_read_b128 v[108:111], v60 offset:33920
    ds_read_b128 v[112:115], v60 offset:41088
    ds_read_b128 v[116:119], v60 offset:42112
    ds_read_b128 v[120:123], v60 offset:49280
    ds_read_b128 v[124:127], v60 offset:50304
    s_waitcnt lgkmcnt(4)
    v_pk_add_f32 v[96:97], v[96:97], v[104:105]
    v_pk_add_f32 v[98:99], v[98:99], v[106:107]
    v_pk_add_f32 v[100:101], v[100:101], v[108:109]
    v_pk_add_f32 v[102:103], v[102:103], v[110:111]
    s_waitcnt lgkmcnt(2)
    v_pk_add_f32 v[96:97], v[96:97], v[112:113]
    v_pk_add_f32 v[98:99], v[98:99], v[114:115]
    v_pk_add_f32 v[100:101], v[100:101], v[116:117]
    v_pk_add_f32 v[102:103], v[102:103], v[118:119]
    s_waitcnt lgkmcnt(0)
    v_pk_add_f32 v[96:97], v[96:97], v[120:121]
    v_pk_add_f32 v[98:99], v[98:99], v[122:123]
    v_pk_add_f32 v[100:101], v[100:101], v[124:125]
    v_pk_add_f32 v[102:103], v[102:103], v[126:127]
    s_branch .Lpoll18_chk
.Lpoll18:
    s_load_dwordx4 s[60:63], s[4:5], s57 glc
    s_load_dwordx4 s[64:67], s[4:5], s57 offset:128 glc
    s_addk_i32 s59, 0x2000
    s_cbranch_scc1 .Lend
.Lpoll18_chk:
    s_waitcnt lgkmcnt(0)
    s_mov_b32 s67, s47
    s_xor_b64 s[60:61], s[60:61], s[32:33]
    s_xor_b64 s[62:63], s[62:63], s[32:33]
    s_xor_b64 s[64:65], s[64:65], s[32:33]
    s_xor_b64 s[66:67], s[66:67], s[32:33]
    s_or_b64 s[60:61], s[60:61], s[62:63]
    s_or_b64 s[64:65], s[64:65], s[66:67]
    s_or_b64 s[60:61], s[60:61], s[64:65]
    s_cbranch_scc1 .Lpoll18
    s_add_u32 s57, s57, 16
    buffer_load_dwordx4 v[28:31], v1, s[4:7], s20 offen offset:0 sc1
    buffer_load_dwordx4 v[32:35], v1, s[4:7], s20 offen offset:2048 sc1
    s_addk_i32 s20, 4096
    buffer_load_dwordx4 v[36:39], v1, s[4:7], s20 offen offset:0 sc1
    buffer_load_dwordx4 v[40:43], v1, s[4:7], s20 offen offset:2048 sc1
    s_addk_i32 s20, 12288
    s_cmp_eq_u32 s20, s22
    s_cselect_b32 s20, s21, s20
    buffer_load_dwordx4 v[44:47], v1, s[4:7], s20 offen offset:0 sc1
    buffer_load_dwordx4 v[48:51], v1, s[4:7], s20 offen offset:2048 sc1
    s_addk_i32 s20, 4096
    buffer_load_dwordx4 v[52:55], v1, s[4:7], s20 offen offset:0 sc1
    buffer_load_dwordx4 v[56:59], v1, s[4:7], s20 offen offset:2048 sc1
    s_addk_i32 s20, 12288
    s_cmp_eq_u32 s20, s22
    s_cselect_b32 s20, s21, s20
    v_pk_mul_f32 v[104:105], v[96:97], v[96:97]
    v_pk_mul_f32 v[106:107], v[98:99], v[98:99]
    v_pk_mul_f32 v[108:109], v[100:101], v[100:101]
    v_pk_mul_f32 v[110:111], v[102:103], v[102:103]
    v_pk_fma_f32 v[104:105], v[104:105], s[34:35], s[34:35] op_sel:[0,0,1] op_sel_hi:[1,0,1]
    v_pk_fma_f32 v[106:107], v[106:107], s[34:35], s[34:35] op_sel:[0,0,1] op_sel_hi:[1,0,1]
    v_pk_fma_f32 v[108:109], v[108:109], s[34:35], s[34:35] op_sel:[0,0,1] op_sel_hi:[1,0,1]
    v_pk_fma_f32 v[110:111], v[110:111], s[34:35], s[34:35] op_sel:[0,0,1] op_sel_hi:[1,0,1]
    v_pk_mul_f32 v[104:105], v[104:105], v[96:97]
    v_pk_mul_f32 v[106:107], v[106:107], v[98:99]
    v_pk_mul_f32 v[108:109], v[108:109], v[100:101]
    v_pk_mul_f32 v[110:111], v[110:111], v[102:103]
    v_exp_f32 v104, v104
    v_exp_f32 v105, v105
    v_exp_f32 v106, v106
    v_exp_f32 v107, v107
    v_exp_f32 v108, v108
    v_exp_f32 v109, v109
    v_exp_f32 v110, v110
    v_exp_f32 v111, v111
    v_pk_add_f32 v[104:105], v[104:105], 1.0 op_sel_hi:[1,0]
    v_pk_add_f32 v[106:107], v[106:107], 1.0 op_sel_hi:[1,0]
    v_pk_add_f32 v[108:109], v[108:109], 1.0 op_sel_hi:[1,0]
    v_pk_add_f32 v[110:111], v[110:111], 1.0 op_sel_hi:[1,0]
    v_rcp_f32 v104, v104
    v_rcp_f32 v105, v105
    v_rcp_f32 v106, v106
    v_rcp_f32 v107, v107
    v_rcp_f32 v108, v108
    v_rcp_f32 v109, v109
    v_rcp_f32 v110, v110
    v_rcp_f32 v111, v111
    v_pk_mul_f32 v[104:105], v[104:105], v[96:97]
    v_pk_mul_f32 v[106:107], v[106:107], v[98:99]
    v_pk_mul_f32 v[108:109], v[108:109], v[100:101]
    v_pk_mul_f32 v[110:111], v[110:111], v[102:103]
    v_cvt_pk_bf16_f32 v112, v104, v105
    v_cvt_pk_bf16_f32 v113, v106, v107
    v_cvt_pk_bf16_f32 v114, v108, v109
    v_cvt_pk_bf16_f32 v115, v110, v111
    buffer_store_dwordx4 v[112:115], v1, s[4:7], s23 offen offset:512 sc1
.Lg2_1:
    buffer_load_dwordx4 v[24:27], v1, s[4:7], s20 offen offset:0 sc1
    ds_read_b64_tr_b16 v[20:21], v3 offset:0
    ds_read_b64_tr_b16 v[22:23], v3 offset:512
    ds_read_b64_tr_b16 v[16:17], v2 offset:0
    ds_read_b64_tr_b16 v[18:19], v2 offset:512
    s_waitcnt vmcnt(9)
    v_mfma_f32_32x32x16_bf16 v[80:95], v[164:167], v[28:31], 0
    v_mbcnt_lo_u32_b32 v120, -1, 0
    v_mbcnt_hi_u32_b32 v120, -1, v120
    v_lshlrev_b32 v120, 10, v120
    v_mov_b32 v121, s47
    v_mfma_f32_32x32x16_bf16 v[64:79], v[160:163], v[28:31], v[64:79]
    buffer_load_dwordx4 v[28:31], v1, s[4:7], s20 offen offset:2048 sc1
    s_waitcnt vmcnt(9) lgkmcnt(2)
    v_mfma_f32_32x32x16_bf16 v[80:95], v[20:23], v[32:35], v[80:95]
    s_addk_i32 s20, 4096
    ds_read_b64_tr_b16 v[20:21], v3 offset:2048
    ds_read_b64_tr_b16 v[22:23], v3 offset:2560
    s_waitcnt lgkmcnt(2)
    v_mfma_f32_32x32x16_bf16 v[64:79], v[16:19], v[32:35], v[64:79]
    ds_read_b64_tr_b16 v[16:17], v2 offset:2048
    ds_read_b64_tr_b16 v[18:19], v2 offset:2560
    buffer_load_dwordx4 v[32:35], v1, s[4:7], s20 offen offset:0 sc1
    s_waitcnt vmcnt(9)
    v_mfma_f32_32x32x16_bf16 v[80:95], v[172:175], v[36:39], v[80:95]
    v_mfma_f32_32x32x16_bf16 v[64:79], v[168:171], v[36:39], v[64:79]
    buffer_load_dwordx4 v[36:39], v1, s[4:7], s20 offen offset:2048 sc1
    s_waitcnt vmcnt(9) lgkmcnt(2)
    v_mfma_f32_32x32x16_bf16 v[80:95], v[20:23], v[40:43], v[80:95]
    s_addk_i32 s20, 12288
    s_cmp_eq_u32 s20, s22
    s_cselect_b32 s20, s21, s20
    ds_read_b64_tr_b16 v[20:21], v3 offset:4096
    ds_read_b64_tr_b16 v[22:23], v3 offset:4608
    s_waitcnt lgkmcnt(2)
    v_mfma_f32_32x32x16_bf16 v[64:79], v[16:19], v[40:43], v[64:79]
    ds_read_b64_tr_b16 v[16:17], v2 offset:4096
    ds_read_b64_tr_b16 v[18:19], v2 offset:4608
    buffer_load_dwordx4 v[40:43], v1, s[4:7], s20 offen offset:0 sc1
    s_waitcnt vmcnt(9)
    v_mfma_f32_32x32x16_bf16 v[80:95], v[180:183], v[44:47], v[80:95]
    v_mfma_f32_32x32x16_bf16 v[64:79], v[176:179], v[44:47], v[64:79]
    buffer_load_dwordx4 v[44:47], v1, s[4:7], s20 offen offset:2048 sc1
    s_waitcnt vmcnt(9) lgkmcnt(2)
    v_mfma_f32_32x32x16_bf16 v[80:95], v[20:23], v[48:51], v[80:95]
    s_addk_i32 s20, 4096
    ds_read_b64_tr_b16 v[20:21], v3 offset:6144
    ds_read_b64_tr_b16 v[22:23], v3 offset:6656
    s_waitcnt lgkmcnt(2)
    v_mfma_f32_32x32x16_bf16 v[64:79], v[16:19], v[48:51], v[64:79]
    ds_read_b64_tr_b16 v[16:17], v2 offset:6144
    ds_read_b64_tr_b16 v[18:19], v2 offset:6656
    buffer_load_dwordx4 v[48:51], v1, s[4:7], s20 offen offset:0 sc1
    s_waitcnt vmcnt(9)
    v_mfma_f32_32x32x16_bf16 v[80:95], v[188:191], v[52:55], v[80:95]
    v_mfma_f32_32x32x16_bf16 v[64:79], v[184:187], v[52:55], v[64:79]
    buffer_load_dwordx4 v[52:55], v1, s[4:7], s20 offen offset:2048 sc1
    s_waitcnt vmcnt(9) lgkmcnt(2)
    v_mfma_f32_32x32x16_bf16 v[80:95], v[20:23], v[56:59], v[80:95]
    s_addk_i32 s20, 12288
    s_cmp_eq_u32 s20, s22
    s_cselect_b32 s20, s21, s20
    ds_read_b64_tr_b16 v[20:21], v3 offset:8192
    ds_read_b64_tr_b16 v[22:23], v3 offset:8704
    s_waitcnt lgkmcnt(2)
    v_mfma_f32_32x32x16_bf16 v[64:79], v[16:19], v[56:59], v[64:79]
    ds_read_b64_tr_b16 v[16:17], v2 offset:8192
    ds_read_b64_tr_b16 v[18:19], v2 offset:8704
    buffer_load_dwordx4 v[56:59], v1, s[4:7], s20 offen offset:0 sc1
    s_waitcnt vmcnt(8)
    v_mfma_f32_32x32x16_bf16 v[80:95], v[196:199], v[24:27], v[80:95]
    s_barrier
    s_mov_b64 exec, 0xff
    buffer_store_dword v121, v120, s[4:7], s56 offen sc1
    s_mov_b64 exec, -1
    s_add_u32 s56, s56, 16
    v_lshlrev_b32 v96, 16, v4
    v_mfma_f32_32x32x16_bf16 v[64:79], v[192:195], v[24:27], v[64:79]
    buffer_load_dwordx4 v[24:27], v1, s[4:7], s20 offen offset:2048 sc1
    v_and_b32 v97, 0xffff0000, v4
    v_lshlrev_b32 v98, 16, v5
    v_and_b32 v99, 0xffff0000, v5
    v_lshlrev_b32 v100, 16, v6
    s_waitcnt vmcnt(9) lgkmcnt(2)
    v_mfma_f32_32x32x16_bf16 v[80:95], v[20:23], v[28:31], v[80:95]
    s_addk_i32 s20, 4096
    ds_read_b64_tr_b16 v[20:21], v3 offset:10240
    ds_read_b64_tr_b16 v[22:23], v3 offset:10752
    v_and_b32 v101, 0xffff0000, v6
    v_lshlrev_b32 v102, 16, v7
    s_waitcnt lgkmcnt(2)
    v_mfma_f32_32x32x16_bf16 v[64:79], v[16:19], v[28:31], v[64:79]
    ds_read_b64_tr_b16 v[16:17], v2 offset:10240
    ds_read_b64_tr_b16 v[18:19], v2 offset:10752
    buffer_load_dwordx4 v[28:31], v1, s[4:7], s20 offen offset:0 sc1
    v_and_b32 v103, 0xffff0000, v7
    v_lshlrev_b32 v104, 16, v12
    s_waitcnt vmcnt(9)
    v_mfma_f32_32x32x16_bf16 v[80:95], v[204:207], v[32:35], v[80:95]
    v_and_b32 v105, 0xffff0000, v12
    v_lshlrev_b32 v106, 16, v13
    v_and_b32 v107, 0xffff0000, v13
    v_lshlrev_b32 v108, 16, v14
    v_and_b32 v109, 0xffff0000, v14
    v_lshlrev_b32 v110, 16, v15
    v_mfma_f32_32x32x16_bf16 v[64:79], v[200:203], v[32:35], v[64:79]
    buffer_load_dwordx4 v[32:35], v1, s[4:7], s20 offen offset:2048 sc1
    v_and_b32 v111, 0xffff0000, v15
    v_add_f32 v96, v96, v104
    v_add_f32 v97, v97, v105
    v_add_f32 v98, v98, v106
    v_add_f32 v99, v99, v107
    s_waitcnt vmcnt(9) lgkmcnt(2)
    v_mfma_f32_32x32x16_bf16 v[80:95], v[20:23], v[36:39], v[80:95]
    s_addk_i32 s20, 12288
    s_cmp_eq_u32 s20, s22
    s_cselect_b32 s20, s21, s20
    ds_read_b64_tr_b16 v[20:21], v3 offset:12288
    ds_read_b64_tr_b16 v[22:23], v3 offset:12800
    s_waitcnt lgkmcnt(2)
    v_mfma_f32_32x32x16_bf16 v[64:79], v[16:19], v[36:39], v[64:79]
    ds_read_b64_tr_b16 v[16:17], v2 offset:12288
    ds_read_b64_tr_b16 v[18:19], v2 offset:12800
    buffer_load_dwordx4 v[36:39], v1, s[4:7], s20 offen offset:0 sc1
    v_add_f32 v100, v100, v108
    v_add_f32 v101, v101, v109
    s_waitcnt vmcnt(9)
    v_mfma_f32_32x32x16_bf16 v[80:95], v[212:215], v[40:43], v[80:95]
    v_add_f32 v102, v102, v110
    v_add_f32 v103, v103, v111
    v_mov_b32 v104, 0
    v_mov_b32 v105, 0
    v_mov_b32 v106, 0
    v_mov_b32 v107, 0
    v_mfma_f32_32x32x16_bf16 v[64:79], v[208:211], v[40:43], v[64:79]
    buffer_load_dwordx4 v[40:43], v1, s[4:7], s20 offen offset:2048 sc1
    v_mov_b32 v108, 0
    v_mov_b32 v109, 0
    v_mov_b32 v110, 0
    v_mov_b32 v111, 0
    s_waitcnt vmcnt(9) lgkmcnt(2)
    v_mfma_f32_32x32x16_bf16 v[80:95], v[20:23], v[44:47], v[80:95]
    s_addk_i32 s20, 4096
    ds_read_b64_tr_b16 v[20:21], v3 offset:14336
    ds_read_b64_tr_b16 v[22:23], v3 offset:14848
    s_waitcnt lgkmcnt(2)
    v_mfma_f32_32x32x16_bf16 v[64:79], v[16:19], v[44:47], v[64:79]
    ds_read_b64_tr_b16 v[16:17], v2 offset:14336
    ds_read_b64_tr_b16 v[18:19], v2 offset:14848
    buffer_load_dwordx4 v[44:47], v1, s[4:7], s20 offen offset:0 sc1
    s_waitcnt vmcnt(9)
    v_mfma_f32_32x32x16_bf16 v[80:95], v[220:223], v[48:51], v[80:95]
    ds_read_b64_tr_b16 v[116:117], v3 offset:20480
    ds_read_b64_tr_b16 v[118:119], v3 offset:20992
    v_mfma_f32_32x32x16_bf16 v[64:79], v[216:219], v[48:51], v[64:79]
    ds_read_b64_tr_b16 v[112:113], v2 offset:20480
    ds_read_b64_tr_b16 v[114:115], v2 offset:20992
    buffer_load_dwordx4 v[48:51], v1, s[4:7], s20 offen offset:2048 sc1
    s_waitcnt vmcnt(9) lgkmcnt(6)
    v_mfma_f32_32x32x16_bf16 v[80:95], v[20:23], v[52:55], v[80:95]
    s_addk_i32 s20, 12288
    s_cmp_eq_u32 s20, s22
    s_cselect_b32 s20, s21, s20
    ds_read_b64_tr_b16 v[20:21], v3 offset:16384
    ds_read_b64_tr_b16 v[22:23], v3 offset:16896
    s_waitcnt lgkmcnt(6)
    v_mfma_f32_32x32x16_bf16 v[64:79], v[16:19], v[52:55], v[64:79]
    ds_read_b64_tr_b16 v[16:17], v2 offset:16384
    ds_read_b64_tr_b16 v[18:19], v2 offset:16896
    buffer_load_dwordx4 v[52:55], v1, s[4:7], s20 offen offset:0 sc1
    s_waitcnt vmcnt(9)
    v_mfma_f32_32x32x16_bf16 v[80:95], v[228:231], v[56:59], v[80:95]
    ds_read_b64_tr_b16 v[124:125], v3 offset:22528
    ds_read_b64_tr_b16 v[126:127], v3 offset:23040
    v_mfma_f32_32x32x16_bf16 v[64:79], v[224:227], v[56:59], v[64:79]
    ds_read_b64_tr_b16 v[120:121], v2 offset:22528
    ds_read_b64_tr_b16 v[122:123], v2 offset:23040
    buffer_load_dwordx4 v[56:59], v1, s[4:7], s20 offen offset:2048 sc1
    s_waitcnt vmcnt(8) lgkmcnt(6)
    v_mfma_f32_32x32x16_bf16 v[80:95], v[20:23], v[24:27], v[80:95]
    s_addk_i32 s20, 4096
    ds_read_b64_tr_b16 v[20:21], v3 offset:18432
    ds_read_b64_tr_b16 v[22:23], v3 offset:18944
    s_waitcnt lgkmcnt(6)
    v_mfma_f32_32x32x16_bf16 v[64:79], v[16:19], v[24:27], v[64:79]
    ds_read_b64_tr_b16 v[16:17], v2 offset:18432
    ds_read_b64_tr_b16 v[18:19], v2 offset:18944
    buffer_load_dwordx4 v[24:27], v1, s[4:7], s20 offen offset:0 sc1
    s_waitcnt vmcnt(8)
    v_mfma_f32_32x32x16_bf16 v[80:95], v[236:239], v[28:31], v[80:95]
    v_mfma_f32_32x32x16_bf16 v[64:79], v[232:235], v[28:31], v[64:79]
    buffer_load_dwordx4 v[28:31], v1, s[4:7], s20 offen offset:2048 sc1
    s_waitcnt vmcnt(8) lgkmcnt(2)
    v_mfma_f32_32x32x16_bf16 v[80:95], v[20:23], v[32:35], v[80:95]
    s_addk_i32 s20, 12288
    s_cmp_eq_u32 s20, s22
    s_cselect_b32 s20, s21, s20
    s_waitcnt lgkmcnt(0)
    v_mfma_f32_32x32x16_bf16 v[64:79], v[16:19], v[32:35], v[64:79]
    s_load_dwordx4 s[60:63], s[4:5], s57 glc
    s_load_dwordx4 s[64:67], s[4:5], s57 offset:128 glc
    s_waitcnt vmcnt(7)
    v_mfma_f32_32x32x16_bf16 v[80:95], v[244:247], v[36:39], v[80:95]
    v_mfma_f32_32x32x16_bf16 v[64:79], v[240:243], v[36:39], v[64:79]
    s_waitcnt vmcnt(6)
    v_mfma_f32_32x32x16_bf16 v[80:95], v[116:119], v[40:43], v[80:95]
    v_mfma_f32_32x32x16_bf16 v[64:79], v[112:115], v[40:43], v[64:79]
    s_waitcnt vmcnt(5)
    v_mfma_f32_32x32x16_bf16 v[80:95], v[252:255], v[44:47], v[80:95]
    v_mfma_f32_32x32x16_bf16 v[64:79], v[248:251], v[44:47], v[64:79]
    s_waitcnt vmcnt(4)
    v_mfma_f32_32x32x16_bf16 v[80:95], v[124:127], v[48:51], v[80:95]
    s_waitcnt lgkmcnt(0)
    s_xor_b64 s[60:61], s[60:61], s[32:33]
    s_xor_b64 s[62:63], s[62:63], s[32:33]
    s_xor_b64 s[64:65], s[64:65], s[32:33]
    s_xor_b64 s[66:67], s[66:67], s[32:33]
    v_mfma_f32_32x32x16_bf16 v[64:79], v[120:123], v[48:51], v[64:79]
    s_or_b64 s[60:61], s[60:61], s[62:63]
    s_or_b64 s[64:65], s[64:65], s[66:67]
    s_or_b64 s[60:61], s[60:61], s[64:65]
    s_cbranch_scc0 .Lgate20
.Lpoll21:
    s_load_dwordx4 s[60:63], s[4:5], s57 glc
    s_load_dwordx4 s[64:67], s[4:5], s57 offset:128 glc
    s_addk_i32 s59, 0x2000
    s_cbranch_scc1 .Lend
.Lpoll21_chk:
    s_waitcnt lgkmcnt(0)
    s_xor_b64 s[60:61], s[60:61], s[32:33]
    s_xor_b64 s[62:63], s[62:63], s[32:33]
    s_xor_b64 s[64:65], s[64:65], s[32:33]
    s_xor_b64 s[66:67], s[66:67], s[32:33]
    s_or_b64 s[60:61], s[60:61], s[62:63]
    s_or_b64 s[64:65], s[64:65], s[66:67]
    s_or_b64 s[60:61], s[60:61], s[64:65]
    s_cbranch_scc1 .Lpoll21
.Lgate20:
    s_waitcnt vmcnt(3)
    v_mfma_f32_32x32x16_bf16 v[80:95], v[132:135], v[52:55], v[80:95]
    s_add_u32 s57, s57, 16
    buffer_load_dwordx4 v[32:35], v1, s[4:7], s20 offen offset:512 sc1
    buffer_load_dwordx4 v[36:39], v1, s[4:7], s20 offen offset:2560 sc1
    v_mfma_f32_32x32x16_bf16 v[64:79], v[128:131], v[52:55], v[64:79]
    s_addk_i32 s20, 4096
    buffer_load_dwordx4 v[40:43], v1, s[4:7], s20 offen offset:512 sc1
    buffer_load_dwordx4 v[44:47], v1, s[4:7], s20 offen offset:2560 sc1
    s_waitcnt vmcnt(6)
    v_mfma_f32_32x32x16_bf16 v[80:95], v[140:143], v[56:59], v[80:95]
    s_addk_i32 s20, 12288
    s_cmp_eq_u32 s20, s22
    s_cselect_b32 s20, s21, s20
    buffer_load_dwordx4 v[48:51], v1, s[4:7], s20 offen offset:512 sc1
    buffer_load_dwordx4 v[52:55], v1, s[4:7], s20 offen offset:2560 sc1
    v_mfma_f32_32x32x16_bf16 v[64:79], v[136:139], v[56:59], v[64:79]
    s_addk_i32 s20, 4096
    buffer_load_dwordx4 v[56:59], v1, s[4:7], s20 offen offset:512 sc1
    s_waitcnt vmcnt(8)
    v_mfma_f32_32x32x16_bf16 v[80:95], v[148:151], v[24:27], v[80:95]
    v_mfma_f32_32x32x16_bf16 v[64:79], v[144:147], v[24:27], v[64:79]
    buffer_load_dwordx4 v[24:27], v1, s[4:7], s20 offen offset:2560 sc1
    s_waitcnt vmcnt(8)
    v_mfma_f32_32x32x16_bf16 v[80:95], v[156:159], v[28:31], v[80:95]
    s_addk_i32 s20, 12288
    s_cmp_eq_u32 s20, s22
    s_cselect_b32 s20, s21, s20
    v_mfma_f32_32x32x16_bf16 v[64:79], v[152:155], v[28:31], v[64:79]
    buffer_load_dwordx4 v[28:31], v1, s[4:7], s20 offen offset:512 sc1
    ds_read_b64_tr_b16 v[20:21], v3 offset:0
    ds_read_b64_tr_b16 v[22:23], v3 offset:512
    ds_read_b64_tr_b16 v[16:17], v2 offset:0
    ds_read_b64_tr_b16 v[18:19], v2 offset:512
    s_waitcnt vmcnt(8)
    v_mfma_f32_32x32x16_bf16 v[112:127], v[164:167], v[32:35], 0
    v_mfma_f32_32x32x16_bf16 v[96:111], v[160:163], v[32:35], v[96:111]
    buffer_load_dwordx4 v[32:35], v1, s[4:7], s20 offen offset:2560 sc1
    s_waitcnt vmcnt(8) lgkmcnt(2)
    v_mfma_f32_32x32x16_bf16 v[112:127], v[20:23], v[36:39], v[112:127]
    s_addk_i32 s20, 4096
    ds_read_b64_tr_b16 v[20:21], v3 offset:2048
    ds_read_b64_tr_b16 v[22:23], v3 offset:2560
    s_waitcnt lgkmcnt(2)
    v_mfma_f32_32x32x16_bf16 v[96:111], v[16:19], v[36:39], v[96:111]
    ds_read_b64_tr_b16 v[16:17], v2 offset:2048
    ds_read_b64_tr_b16 v[18:19], v2 offset:2560
    buffer_load_dwordx4 v[36:39], v1, s[4:7], s20 offen offset:512 sc1
    s_waitcnt vmcnt(8)
    v_mfma_f32_32x32x16_bf16 v[112:127], v[172:175], v[40:43], v[112:127]
    v_xor_b32 v61, 6144, v60
    ds_write_b128 v61, v[88:91] offset:24704
    v_mfma_f32_32x32x16_bf16 v[96:111], v[168:171], v[40:43], v[96:111]
    buffer_load_dwordx4 v[40:43], v1, s[4:7], s20 offen offset:2560 sc1
    s_waitcnt vmcnt(8) lgkmcnt(3)
    v_mfma_f32_32x32x16_bf16 v[112:127], v[20:23], v[44:47], v[112:127]
    s_addk_i32 s20, 12288
    s_cmp_eq_u32 s20, s22
    s_cselect_b32 s20, s21, s20
    ds_read_b64_tr_b16 v[20:21], v3 offset:4096
    ds_read_b64_tr_b16 v[22:23], v3 offset:4608
    s_waitcnt lgkmcnt(3)
    v_mfma_f32_32x32x16_bf16 v[96:111], v[16:19], v[44:47], v[96:111]
    ds_read_b64_tr_b16 v[16:17], v2 offset:4096
    ds_read_b64_tr_b16 v[18:19], v2 offset:4608
    buffer_load_dwordx4 v[44:47], v1, s[4:7], s20 offen offset:512 sc1
    ds_write_b128 v61, v[92:95] offset:25728
    s_waitcnt vmcnt(8)
    v_mfma_f32_32x32x16_bf16 v[112:127], v[180:183], v[48:51], v[112:127]
    v_xor_b32 v61, 4096, v60
    ds_write_b128 v61, v[80:83] offset:16512
    v_mfma_f32_32x32x16_bf16 v[96:111], v[176:179], v[48:51], v[96:111]
    buffer_load_dwordx4 v[48:51], v1, s[4:7], s20 offen offset:2560 sc1
    ds_write_b128 v61, v[84:87] offset:17536
    s_waitcnt vmcnt(8) lgkmcnt(5)
    v_mfma_f32_32x32x16_bf16 v[112:127], v[20:23], v[52:55], v[112:127]
    s_addk_i32 s20, 4096
    ds_read_b64_tr_b16 v[20:21], v3 offset:6144
    ds_read_b64_tr_b16 v[22:23], v3 offset:6656
    s_waitcnt lgkmcnt(5)
    v_mfma_f32_32x32x16_bf16 v[96:111], v[16:19], v[52:55], v[96:111]
    ds_read_b64_tr_b16 v[16:17], v2 offset:6144
    ds_read_b64_tr_b16 v[18:19], v2 offset:6656
    buffer_load_dwordx4 v[52:55], v1, s[4:7], s20 offen offset:512 sc1
    s_waitcnt vmcnt(8)
    v_mfma_f32_32x32x16_bf16 v[112:127], v[188:191], v[56:59], v[112:127]
    v_xor_b32 v61, 2048, v60
    ds_write_b128 v61, v[72:75] offset:8320
    v_mfma_f32_32x32x16_bf16 v[96:111], v[184:187], v[56:59], v[96:111]
    buffer_load_dwordx4 v[56:59], v1, s[4:7], s20 offen offset:2560 sc1
    ds_write_b128 v61, v[76:79] offset:9344
    s_waitcnt vmcnt(8) lgkmcnt(4)
    v_mfma_f32_32x32x16_bf16 v[112:127], v[20:23], v[24:27], v[112:127]
    s_addk_i32 s20, 12288
    s_cmp_eq_u32 s20, s22
    s_cselect_b32 s20, s21, s20
    ds_read_b64_tr_b16 v[20:21], v3 offset:8192
    ds_read_b64_tr_b16 v[22:23], v3 offset:8704
    s_waitcnt lgkmcnt(4)
    v_mfma_f32_32x32x16_bf16 v[96:111], v[16:19], v[24:27], v[96:111]
    ds_read_b64_tr_b16 v[16:17], v2 offset:8192
    ds_read_b64_tr_b16 v[18:19], v2 offset:8704
    buffer_load_dwordx4 v[24:27], v1, s[4:7], s20 offen offset:512 sc1
    s_waitcnt vmcnt(8)
    v_mfma_f32_32x32x16_bf16 v[112:127], v[196:199], v[28:31], v[112:127]
    s_waitcnt lgkmcnt(0)
    s_barrier
    ds_read_b128 v[72:75], v60 offset:8320
    v_mfma_f32_32x32x16_bf16 v[96:111], v[192:195], v[28:31], v[96:111]
    buffer_load_dwordx4 v[28:31], v1, s[4:7], s20 offen offset:2560 sc1
    ds_read_b128 v[76:79], v60 offset:9344
    ds_read_b128 v[80:83], v60 offset:16512
    ds_read_b128 v[84:87], v60 offset:17536
    ds_read_b128 v[88:91], v60 offset:24704
    s_waitcnt vmcnt(8)
    v_mfma_f32_32x32x16_bf16 v[112:127], v[20:23], v[32:35], v[112:127]
    s_addk_i32 s20, 4096
    ds_read_b64_tr_b16 v[20:21], v3 offset:10240
    ds_read_b64_tr_b16 v[22:23], v3 offset:10752
    ds_read_b128 v[92:95], v60 offset:25728
    v_mfma_f32_32x32x16_bf16 v[96:111], v[16:19], v[32:35], v[96:111]
    ds_read_b64_tr_b16 v[16:17], v2 offset:10240
    ds_read_b64_tr_b16 v[18:19], v2 offset:10752
    buffer_load_dwordx4 v[32:35], v1, s[4:7], s20 offen offset:512 sc1
    s_waitcnt vmcnt(8)
    v_mfma_f32_32x32x16_bf16 v[112:127], v[204:207], v[36:39], v[112:127]
    s_waitcnt lgkmcnt(8)
    v_add_f32 v64, v64, v72
    v_add_f32 v65, v65, v73
    v_add_f32 v66, v66, v74
    v_add_f32 v67, v67, v75
    v_add_f32 v68, v68, v76
    v_add_f32 v69, v69, v77
    v_mfma_f32_32x32x16_bf16 v[96:111], v[200:203], v[36:39], v[96:111]
    buffer_load_dwordx4 v[36:39], v1, s[4:7], s20 offen offset:2560 sc1
    v_add_f32 v70, v70, v78
    v_add_f32 v71, v71, v79
    s_waitcnt lgkmcnt(6)
    v_add_f32 v64, v64, v80
    v_add_f32 v65, v65, v81
    s_waitcnt vmcnt(8) lgkmcnt(3)
    v_mfma_f32_32x32x16_bf16 v[112:127], v[20:23], v[40:43], v[112:127]
    s_addk_i32 s20, 12288
    s_cmp_eq_u32 s20, s22
    s_cselect_b32 s20, s21, s20
    ds_read_b64_tr_b16 v[20:21], v3 offset:12288
    ds_read_b64_tr_b16 v[22:23], v3 offset:12800
    s_waitcnt lgkmcnt(2)
    v_mfma_f32_32x32x16_bf16 v[96:111], v[16:19], v[40:43], v[96:111]
    ds_read_b64_tr_b16 v[16:17], v2 offset:12288
    ds_read_b64_tr_b16 v[18:19], v2 offset:12800
    buffer_load_dwordx4 v[40:43], v1, s[4:7], s20 offen offset:512 sc1
    v_add_f32 v66, v66, v82
    v_add_f32 v67, v67, v83
    s_waitcnt vmcnt(8)
    v_mfma_f32_32x32x16_bf16 v[112:127], v[212:215], v[44:47], v[112:127]
    v_add_f32 v68, v68, v84
    v_add_f32 v69, v69, v85
    v_add_f32 v70, v70, v86
    v_add_f32 v71, v71, v87
    v_add_f32 v64, v64, v88
    v_add_f32 v65, v65, v89
    v_mfma_f32_32x32x16_bf16 v[96:111], v[208:211], v[44:47], v[96:111]
    buffer_load_dwordx4 v[44:47], v1, s[4:7], s20 offen offset:2560 sc1
    v_add_f32 v66, v66, v90
    v_add_f32 v67, v67, v91
    v_add_f32 v68, v68, v92
    v_add_f32 v69, v69, v93
    s_waitcnt vmcnt(8) lgkmcnt(2)
    v_mfma_f32_32x32x16_bf16 v[112:127], v[20:23], v[48:51], v[112:127]
    s_addk_i32 s20, 4096
    ds_read_b64_tr_b16 v[20:21], v3 offset:14336
    ds_read_b64_tr_b16 v[22:23], v3 offset:14848
    v_add_f32 v70, v70, v94
    v_add_f32 v71, v71, v95
    s_waitcnt lgkmcnt(2)
    v_mfma_f32_32x32x16_bf16 v[96:111], v[16:19], v[48:51], v[96:111]
    ds_read_b64_tr_b16 v[16:17], v2 offset:14336
    ds_read_b64_tr_b16 v[18:19], v2 offset:14848
    buffer_load_dwordx4 v[48:51], v1, s[4:7], s20 offen offset:512 sc1
    s_waitcnt vmcnt(8)
    v_mfma_f32_32x32x16_bf16 v[112:127], v[220:223], v[52:55], v[112:127]
    v_mfma_f32_32x32x16_bf16 v[96:111], v[216:219], v[52:55], v[96:111]
    buffer_load_dwordx4 v[52:55], v1, s[4:7], s20 offen offset:2560 sc1
    s_waitcnt vmcnt(8) lgkmcnt(2)
    v_mfma_f32_32x32x16_bf16 v[112:127], v[20:23], v[56:59], v[112:127]
    s_addk_i32 s20, 12288
    s_cmp_eq_u32 s20, s22
    s_cselect_b32 s20, s21, s20
    ds_read_b64_tr_b16 v[20:21], v3 offset:16384
    ds_read_b64_tr_b16 v[22:23], v3 offset:16896
    s_waitcnt lgkmcnt(2)
    v_mfma_f32_32x32x16_bf16 v[96:111], v[16:19], v[56:59], v[96:111]
    ds_read_b64_tr_b16 v[16:17], v2 offset:16384
    ds_read_b64_tr_b16 v[18:19], v2 offset:16896
    buffer_load_dwordx4 v[56:59], v1, s[4:7], s20 offen offset:512 sc1
    s_waitcnt vmcnt(8)
    v_mfma_f32_32x32x16_bf16 v[112:127], v[228:231], v[24:27], v[112:127]
    v_mfma_f32_32x32x16_bf16 v[96:111], v[224:227], v[24:27], v[96:111]
    buffer_load_dwordx4 v[24:27], v1, s[4:7], s20 offen offset:2560 sc1
    s_waitcnt vmcnt(8) lgkmcnt(2)
    v_mfma_f32_32x32x16_bf16 v[112:127], v[20:23], v[28:31], v[112:127]
    s_addk_i32 s20, 4096
    ds_read_b64_tr_b16 v[20:21], v3 offset:18432
    ds_read_b64_tr_b16 v[22:23], v3 offset:18944
    s_waitcnt lgkmcnt(2)
    v_mfma_f32_32x32x16_bf16 v[96:111], v[16:19], v[28:31], v[96:111]
    ds_read_b64_tr_b16 v[16:17], v2 offset:18432
    ds_read_b64_tr_b16 v[18:19], v2 offset:18944
    buffer_load_dwordx4 v[28:31], v1, s[4:7], s20 offen offset:512 sc1
    s_waitcnt vmcnt(8)
    v_mfma_f32_32x32x16_bf16 v[112:127], v[236:239], v[32:35], v[112:127]
    v_mfma_f32_32x32x16_bf16 v[96:111], v[232:235], v[32:35], v[96:111]
    buffer_load_dwordx4 v[32:35], v1, s[4:7], s20 offen offset:2560 sc1
    s_waitcnt vmcnt(8) lgkmcnt(2)
    v_mfma_f32_32x32x16_bf16 v[112:127], v[20:23], v[36:39], v[112:127]
    s_addk_i32 s20, 12288
    s_cmp_eq_u32 s20, s22
    s_cselect_b32 s20, s21, s20
    ds_read_b64_tr_b16 v[20:21], v3 offset:20480
    ds_read_b64_tr_b16 v[22:23], v3 offset:20992
    s_waitcnt lgkmcnt(2)
    v_mfma_f32_32x32x16_bf16 v[96:111], v[16:19], v[36:39], v[96:111]
    ds_read_b64_tr_b16 v[16:17], v2 offset:20480
    ds_read_b64_tr_b16 v[18:19], v2 offset:20992
    s_waitcnt vmcnt(7)
    v_mfma_f32_32x32x16_bf16 v[112:127], v[244:247], v[40:43], v[112:127]
    v_mfma_f32_32x32x16_bf16 v[96:111], v[240:243], v[40:43], v[96:111]
    s_waitcnt vmcnt(6) lgkmcnt(2)
    v_mfma_f32_32x32x16_bf16 v[112:127], v[20:23], v[44:47], v[112:127]
    ds_read_b64_tr_b16 v[20:21], v3 offset:22528
    ds_read_b64_tr_b16 v[22:23], v3 offset:23040
    s_waitcnt lgkmcnt(2)
    v_mfma_f32_32x32x16_bf16 v[96:111], v[16:19], v[44:47], v[96:111]
    ds_read_b64_tr_b16 v[16:17], v2 offset:22528
    ds_read_b64_tr_b16 v[18:19], v2 offset:23040
    s_waitcnt vmcnt(5)
    v_mfma_f32_32x32x16_bf16 v[112:127], v[252:255], v[48:51], v[112:127]
    v_mfma_f32_32x32x16_bf16 v[96:111], v[248:251], v[48:51], v[96:111]
    s_waitcnt vmcnt(4) lgkmcnt(2)
    v_mfma_f32_32x32x16_bf16 v[112:127], v[20:23], v[52:55], v[112:127]
    s_waitcnt lgkmcnt(0)
    v_mfma_f32_32x32x16_bf16 v[96:111], v[16:19], v[52:55], v[96:111]
    s_waitcnt vmcnt(3)
    v_mfma_f32_32x32x16_bf16 v[112:127], v[132:135], v[56:59], v[112:127]
    v_mbcnt_lo_u32_b32 v4, -1, 0
    v_mbcnt_hi_u32_b32 v4, -1, v4
    v_and_b32 v5, 31, v4
    v_lshlrev_b32 v3, 2, v5
    v_lshrrev_b32 v5, 5, v4
    s_waitcnt vmcnt(2)
    v_mfma_f32_32x32x16_bf16 v[112:127], v[140:143], v[24:27], v[112:127]
    v_lshl_add_u32 v3, v5, 13, v3
    s_lshl_b32 s22, s46, 2
    s_add_u32 s22, s22, s44
    s_lshl_b32 s22, s22, 14
    s_lshl_b32 s42, s45, 7
    s_waitcnt vmcnt(1)
    v_mfma_f32_32x32x16_bf16 v[112:127], v[148:151], v[28:31], v[112:127]
    s_add_u32 s22, s22, s42
    s_add_u32 s23, s22, 4096
    s_waitcnt vmcnt(0)
    v_mfma_f32_32x32x16_bf16 v[112:127], v[156:159], v[32:35], v[112:127]
    v_mfma_f32_32x32x16_bf16 v[96:111], v[128:131], v[56:59], v[96:111]
    v_xor_b32 v61, 6144, v60
    v_mfma_f32_32x32x16_bf16 v[96:111], v[136:139], v[24:27], v[96:111]
    s_nop 8
    ds_write_b128 v61, v[120:123] offset:49280
    v_mfma_f32_32x32x16_bf16 v[96:111], v[144:147], v[28:31], v[96:111]
    ds_write_b128 v61, v[124:127] offset:50304
    v_mfma_f32_32x32x16_bf16 v[96:111], v[152:155], v[32:35], v[96:111]
    v_xor_b32 v61, 4096, v60
    ds_write_b128 v61, v[112:115] offset:41088
    ds_write_b128 v61, v[116:119] offset:42112
    s_nop 7
    v_xor_b32 v61, 2048, v60
    ds_write_b128 v61, v[104:107] offset:32896
    ds_write_b128 v61, v[108:111] offset:33920
    s_waitcnt lgkmcnt(0)
    s_barrier
    ds_read_b128 v[104:107], v60 offset:32896
    ds_read_b128 v[108:111], v60 offset:33920
    ds_read_b128 v[112:115], v60 offset:41088
    ds_read_b128 v[116:119], v60 offset:42112
    ds_read_b128 v[120:123], v60 offset:49280
    ds_read_b128 v[124:127], v60 offset:50304
    s_waitcnt lgkmcnt(4)
    v_pk_add_f32 v[96:97], v[96:97], v[104:105]
    v_pk_add_f32 v[98:99], v[98:99], v[106:107]
    v_pk_add_f32 v[100:101], v[100:101], v[108:109]
    v_pk_add_f32 v[102:103], v[102:103], v[110:111]
    s_waitcnt lgkmcnt(2)
    v_pk_add_f32 v[96:97], v[96:97], v[112:113]
    v_pk_add_f32 v[98:99], v[98:99], v[114:115]
    v_pk_add_f32 v[100:101], v[100:101], v[116:117]
    v_pk_add_f32 v[102:103], v[102:103], v[118:119]
    s_waitcnt lgkmcnt(0)
    v_pk_add_f32 v[16:17], v[96:97], v[120:121]
    v_pk_add_f32 v[18:19], v[98:99], v[122:123]
    v_pk_add_f32 v[20:21], v[100:101], v[124:125]
    v_pk_add_f32 v[22:23], v[102:103], v[126:127]
    v_cvt_pk_bf16_f32 v24, v64, v16
    v_cvt_pk_bf16_f32 v25, v65, v17
    v_cvt_pk_bf16_f32 v26, v66, v18
    v_cvt_pk_bf16_f32 v27, v67, v19
    v_cvt_pk_bf16_f32 v28, v68, v20
    v_cvt_pk_bf16_f32 v29, v69, v21
    v_cvt_pk_bf16_f32 v30, v70, v22
    v_cvt_pk_bf16_f32 v31, v71, v23
    buffer_store_dword v24, v3, s[16:19], s22 offen offset:0 sc1
    buffer_store_dword v25, v3, s[16:19], s22 offen offset:1024 sc1
    buffer_store_dword v26, v3, s[16:19], s22 offen offset:2048 sc1
    buffer_store_dword v27, v3, s[16:19], s22 offen offset:3072 sc1
    buffer_store_dword v28, v3, s[16:19], s23 offen offset:0 sc1
    buffer_store_dword v29, v3, s[16:19], s23 offen offset:1024 sc1
    buffer_store_dword v30, v3, s[16:19], s23 offen offset:2048 sc1
    buffer_store_dword v31, v3, s[16:19], s23 offen offset:3072 sc1
.Lend:
    s_endpgm
.Lredo:
    s_mov_b32 s67, s41
    s_add_u32 s59, s59, 1
    v_mov_b32 v0, v128
    s_waitcnt vmcnt(0) lgkmcnt(0)
    s_branch .Lrole
.Lidle0:
    s_waitcnt lgkmcnt(0)
    s_add_u32 s56, s56, 16
    s_add_u32 s57, s57, 16
    s_add_u32 s43, s53, 983040
    s_sub_u32 s41, s43, 1835008
    s_add_u32 m0, s55, 10240
    s_cmp_ge_u32 s43, s54
    s_cselect_b32 s43, s41, s43
    buffer_load_dwordx4 v62, s[12:15], s43 offen lds
    buffer_load_dwordx4 v63, s[12:15], s43 offen offset:1024 lds
    s_add_u32 s43, s53, 1114112
    s_sub_u32 s41, s43, 1835008
    s_add_u32 m0, s55, 12288
    s_cmp_ge_u32 s43, s54
    s_cselect_b32 s43, s41, s43
    buffer_load_dwordx4 v62, s[12:15], s43 offen lds
    buffer_load_dwordx4 v63, s[12:15], s43 offen offset:1024 lds
    s_add_u32 s43, s53, 1245184
    s_sub_u32 s41, s43, 1835008
    s_add_u32 m0, s55, 14336
    s_cmp_ge_u32 s43, s54
    s_cselect_b32 s43, s41, s43
    buffer_load_dwordx4 v62, s[12:15], s43 offen lds
    buffer_load_dwordx4 v63, s[12:15], s43 offen offset:1024 lds
    s_add_u32 s43, s53, 1376256
    s_sub_u32 s41, s43, 1835008
    s_add_u32 m0, s55, 16384
    s_cmp_ge_u32 s43, s54
    s_cselect_b32 s43, s41, s43
    buffer_load_dwordx4 v62, s[12:15], s43 offen lds
    buffer_load_dwordx4 v63, s[12:15], s43 offen offset:1024 lds
    s_add_u32 s43, s53, 1507328
    s_sub_u32 s41, s43, 1835008
    s_add_u32 m0, s55, 18432
    s_cmp_ge_u32 s43, s54
    s_cselect_b32 s43, s41, s43
    buffer_load_dwordx4 v62, s[12:15], s43 offen lds
    buffer_load_dwordx4 v63, s[12:15], s43 offen offset:1024 lds
    s_add_u32 s43, s53, 1638400
    s_sub_u32 s41, s43, 1835008
    s_add_u32 m0, s55, 20480
    s_cmp_ge_u32 s43, s54
    s_cselect_b32 s43, s41, s43
    buffer_load_dwordx4 v62, s[12:15], s43 offen lds
    buffer_load_dwordx4 v63, s[12:15], s43 offen offset:1024 lds
    v_mbcnt_lo_u32_b32 v22, -1, 0
    v_mbcnt_hi_u32_b32 v22, -1, v22
    v_lshlrev_b32 v22, 4, v22
    v_mov_b32 v18, -1
    v_mov_b32 v19, -1
    v_mov_b32 v20, -1
    v_mov_b32 v21, -1
    s_lshl3_add_u32 s40, s46, s44
    s_lshl_b32 s40, s40, 11
    s_add_u32 s40, s40, s31
    s_add_u32 s40, s40, 4194304
    buffer_store_dwordx4 v[18:21], v22, s[4:7], s40 offen offset:0 sc1
    buffer_store_dwordx4 v[18:21], v22, s[4:7], s40 offen offset:1024 sc1
    s_add_u32 s43, s53, 1769472
    s_sub_u32 s41, s43, 1835008
    s_add_u32 m0, s55, 22528
    s_cmp_ge_u32 s43, s54
    s_cselect_b32 s43, s41, s43
    buffer_load_dwordx4 v62, s[12:15], s43 offen lds
    buffer_load_dwordx4 v63, s[12:15], s43 offen offset:1024 lds
    v_lshlrev_b32 v64, 16, v4
    v_and_b32 v65, 0xffff0000, v4
    v_lshlrev_b32 v66, 16, v5
    v_and_b32 v67, 0xffff0000, v5
    v_lshlrev_b32 v68, 16, v6
    v_and_b32 v69, 0xffff0000, v6
    v_lshlrev_b32 v70, 16, v7
    v_and_b32 v71, 0xffff0000, v7
    v_lshlrev_b32 v72, 16, v8
    v_and_b32 v73, 0xffff0000, v8
    v_lshlrev_b32 v74, 16, v9
    v_and_b32 v75, 0xffff0000, v9
    v_lshlrev_b32 v76, 16, v10
    v_and_b32 v77, 0xffff0000, v10
    v_lshlrev_b32 v78, 16, v11
    v_and_b32 v79, 0xffff0000, v11
    v_pk_add_f32 v[64:65], v[64:65], v[72:73]
    v_pk_add_f32 v[66:67], v[66:67], v[74:75]
    v_pk_add_f32 v[68:69], v[68:69], v[76:77]
    v_pk_add_f32 v[70:71], v[70:71], v[78:79]
    v_mov_b64 v[72:73], 0
    v_mov_b64 v[74:75], 0
    v_mov_b64 v[76:77], 0
    v_mov_b64 v[78:79], 0
    s_mul_i32 s21, s44, 114688
    s_add_u32 s21, s21, s31
    s_add_u32 s21, s21, 1572864
    s_add_u32 s22, s21, 114688
    s_lshl_b32 s20, s58, 12
    s_add_u32 s20, s20, s21
    s_add_u32 s20, s20, 16384
    s_cmp_eq_u32 s20, s22
    s_cselect_b32 s20, s21, s20
.Lpoll8:
    s_load_dwordx4 s[60:63], s[4:5], s57 glc
    s_load_dwordx4 s[64:67], s[4:5], s57 offset:128 glc
    s_addk_i32 s59, 0x2000
    s_cbranch_scc1 .Lend
.Lpoll8_chk:
    s_waitcnt lgkmcnt(0)
    s_mov_b32 s67, s47
    s_xor_b64 s[60:61], s[60:61], s[32:33]
    s_xor_b64 s[62:63], s[62:63], s[32:33]
    s_xor_b64 s[64:65], s[64:65], s[32:33]
    s_xor_b64 s[66:67], s[66:67], s[32:33]
    s_or_b64 s[60:61], s[60:61], s[62:63]
    s_or_b64 s[64:65], s[64:65], s[66:67]
    s_or_b64 s[60:61], s[60:61], s[64:65]
    s_cbranch_scc1 .Lpoll8
    s_add_u32 s57, s57, 16
    buffer_load_dwordx4 v[28:31], v1, s[4:7], s20 offen offset:0 sc1
    buffer_load_dwordx4 v[32:35], v1, s[4:7], s20 offen offset:2048 sc1
    s_addk_i32 s20, 4096
    buffer_load_dwordx4 v[36:39], v1, s[4:7], s20 offen offset:0 sc1
    buffer_load_dwordx4 v[40:43], v1, s[4:7], s20 offen offset:2048 sc1
    s_addk_i32 s20, 12288
    s_cmp_eq_u32 s20, s22
    s_cselect_b32 s20, s21, s20
    buffer_load_dwordx4 v[44:47], v1, s[4:7], s20 offen offset:0 sc1
    buffer_load_dwordx4 v[48:51], v1, s[4:7], s20 offen offset:2048 sc1
    s_addk_i32 s20, 4096
    buffer_load_dwordx4 v[52:55], v1, s[4:7], s20 offen offset:0 sc1
    buffer_load_dwordx4 v[56:59], v1, s[4:7], s20 offen offset:2048 sc1
    s_addk_i32 s20, 12288
    s_cmp_eq_u32 s20, s22
    s_cselect_b32 s20, s21, s20
    s_waitcnt vmcnt(0) lgkmcnt(0)
    s_branch .Lg2_0
.Lidle1:
    s_waitcnt lgkmcnt(0)
    s_add_u32 s56, s56, 16
    s_add_u32 s57, s57, 16
    v_lshlrev_b32 v64, 16, v4
    v_and_b32 v65, 0xffff0000, v4
    v_lshlrev_b32 v66, 16, v5
    v_and_b32 v67, 0xffff0000, v5
    v_lshlrev_b32 v68, 16, v6
    v_and_b32 v69, 0xffff0000, v6
    v_lshlrev_b32 v70, 16, v7
    v_and_b32 v71, 0xffff0000, v7
    v_lshlrev_b32 v72, 16, v8
    v_and_b32 v73, 0xffff0000, v8
    v_lshlrev_b32 v74, 16, v9
    v_and_b32 v75, 0xffff0000, v9
    v_lshlrev_b32 v76, 16, v10
    v_and_b32 v77, 0xffff0000, v10
    v_lshlrev_b32 v78, 16, v11
    v_and_b32 v79, 0xffff0000, v11
    v_pk_add_f32 v[64:65], v[64:65], v[72:73]
    v_pk_add_f32 v[66:67], v[66:67], v[74:75]
    v_pk_add_f32 v[68:69], v[68:69], v[76:77]
    v_pk_add_f32 v[70:71], v[70:71], v[78:79]
    v_mov_b64 v[72:73], 0
    v_mov_b64 v[74:75], 0
    v_mov_b64 v[76:77], 0
    v_mov_b64 v[78:79], 0
    s_mul_i32 s21, s44, 114688
    s_add_u32 s21, s21, s31
    s_add_u32 s21, s21, 5767168
    s_add_u32 s22, s21, 114688
    s_lshl_b32 s20, s58, 12
    s_add_u32 s20, s20, s21
    s_add_u32 s20, s20, 16384
    s_cmp_eq_u32 s20, s22
    s_cselect_b32 s20, s21, s20
.Lpoll19:
    s_load_dwordx4 s[60:63], s[4:5], s57 glc
    s_load_dwordx4 s[64:67], s[4:5], s57 offset:128 glc
    s_addk_i32 s59, 0x2000
    s_cbranch_scc1 .Lend
.Lpoll19_chk:
    s_waitcnt lgkmcnt(0)
    s_mov_b32 s67, s47
    s_xor_b64 s[60:61], s[60:61], s[32:33]
    s_xor_b64 s[62:63], s[62:63], s[32:33]
    s_xor_b64 s[64:65], s[64:65], s[32:33]
    s_xor_b64 s[66:67], s[66:67], s[32:33]
    s_or_b64 s[60:61], s[60:61], s[62:63]
    s_or_b64 s[64:65], s[64:65], s[66:67]
    s_or_b64 s[60:61], s[60:61], s[64:65]
    s_cbranch_scc1 .Lpoll19
    s_add_u32 s57, s57, 16
    buffer_load_dwordx4 v[28:31], v1, s[4:7], s20 offen offset:0 sc1
    buffer_load_dwordx4 v[32:35], v1, s[4:7], s20 offen offset:2048 sc1
    s_addk_i32 s20, 4096
    buffer_load_dwordx4 v[36:39], v1, s[4:7], s20 offen offset:0 sc1
    buffer_load_dwordx4 v[40:43], v1, s[4:7], s20 offen offset:2048 sc1
    s_addk_i32 s20, 12288
    s_cmp_eq_u32 s20, s22
    s_cselect_b32 s20, s21, s20
    buffer_load_dwordx4 v[44:47], v1, s[4:7], s20 offen offset:0 sc1
    buffer_load_dwordx4 v[48:51], v1, s[4:7], s20 offen offset:2048 sc1
    s_addk_i32 s20, 4096
    buffer_load_dwordx4 v[52:55], v1, s[4:7], s20 offen offset:0 sc1
    buffer_load_dwordx4 v[56:59], v1, s[4:7], s20 offen offset:2048 sc1
    s_addk_i32 s20, 12288
    s_cmp_eq_u32 s20, s22
    s_cselect_b32 s20, s21, s20
    s_waitcnt vmcnt(0) lgkmcnt(0)
    s_branch .Lg2_1
.Lcode_end:
    s_endpgm
.section .rodata,"a"
.p2align 6
.amdhsa_kernel interleave_layers__ssm_conv_s4d__mixer_token_mlp__prompt_kernel
  .amdhsa_next_free_vgpr 512
  .amdhsa_next_free_sgpr 102
  .amdhsa_accum_offset 256
  .amdhsa_group_segment_fixed_size 0
  .amdhsa_kernarg_size 120
  .amdhsa_user_sgpr_count 2
  .amdhsa_user_sgpr_kernarg_segment_ptr 1
  .amdhsa_system_sgpr_workgroup_id_x 1
.end_amdhsa_kernel
```
